```python
import torch

def _softmax(x, axis=-1):
    return torch.softmax(x, dim=axis)

def _gelu(x):
    return torch.nn.functional.gelu(x, approximate='tanh')

def _silu(x):
    return torch.nn.functional.silu(x)

def _sigmoid(x):
    return torch.sigmoid(x)

def _layernorm(x, axis=-1, eps=1e-05):
    m = x.mean(dim=axis, keepdim=True)
    v = x.var(dim=axis, keepdim=True, unbiased=False)
    return (x - m) / torch.sqrt(v + eps)

def _scatter_add(tgt, idx, src, axis=0):
    return tgt.clone().index_add_(axis, idx, src)

def _segment_sum(src, seg, n):
    out = torch.zeros((n,) + src.shape[1:], dtype=src.dtype)
    return out.index_add_(0, seg, src)

def _pad(x, pw):
    flat = tuple((v for pair in reversed(pw) for v in pair))
    return torch.nn.functional.pad(x, flat)
kernel_name = 'adaLN_cond__compressed_kv_cla__glu_gated_reglu__prompt'

def setup_inputs():

    _w = lambda a: (lambda t: t.to(torch.bfloat16) if t.is_floating_point() else t)(torch.as_tensor(a))

    def _A_setup():
        B, H, Sq, Sk, D, M = (1, 32, 2048, 2048, 128, 512)
        Dc = 4 * D
        return {'x': _w((lambda *s: torch.randn(*s, dtype=torch.bfloat16) * 0.05)(B, Sq, M)), 'c_kv': _w((lambda *s: torch.randn(*s, dtype=torch.bfloat16) * 0.8)(B, Sk, Dc)), 'w_q': _w((lambda *s: torch.randn(*s, dtype=torch.bfloat16) * 1.6)(M, H, D) * M ** (-0.5)), 'w_uk': _w((lambda *s: torch.randn(*s, dtype=torch.bfloat16) * 1.6)(Dc, H, D) * Dc ** (-0.5)), 'w_uv': _w((lambda *s: torch.randn(*s, dtype=torch.bfloat16) * 0.8)(Dc, H, D) * Dc ** (-0.5)), 'w_o': _w((lambda *s: torch.randn(*s, dtype=torch.bfloat16) * 0.8)(H, D, M) * (H * D) ** (-0.5))}
    _A_in = _A_setup()

    def _B_setup():
        B, S, D, F = (1, 2048, 512, 1792)
        return {'x': _w((lambda *s: torch.randn(*s, dtype=torch.bfloat16) * 0.05)(B, S, D)), 'W_gate': _w((lambda *s: torch.randn(*s, dtype=torch.bfloat16) * 0.4)(D, F) * (2.0 / D) ** 0.5), 'W_up': _w((lambda *s: torch.randn(*s, dtype=torch.bfloat16) * 0.4)(D, F) * (2.0 / D) ** 0.5), 'W_down': _w((lambda *s: torch.randn(*s, dtype=torch.bfloat16) * 0.4)(F, D) * (1.0 / F) ** 0.5)}
    _B_in = _B_setup()
    return {'A_x': _A_in['x'], 'A_c_kv': _A_in['c_kv'], 'A_w_q': _A_in['w_q'], 'A_w_uk': _A_in['w_uk'], 'A_w_uv': _A_in['w_uv'], 'A_w_o': _A_in['w_o'], 'B_x': _B_in['x'], 'B_W_gate': _B_in['W_gate'], 'B_W_up': _B_in['W_up'], 'B_W_down': _B_in['W_down'], 'c': _w((lambda *s: torch.randn(*s, dtype=torch.bfloat16) * 0.1)(1, 512) * 8.0), 'w_mod': _w((lambda *s: torch.randn(*s, dtype=torch.bfloat16) * 0.1)(512, 6 * 512) * 512 ** (-0.5) * 8.0)}

def reference(A_x, A_c_kv, A_w_q, A_w_uk, A_w_uv, A_w_o, B_x, B_W_gate, B_W_up, B_W_down, c, w_mod):

    def _A_ref(x, c_kv, w_q, w_uk, w_uv, w_o):
        B, Sq, M = (x.shape[0], x.shape[1], x.shape[2])
        Sk = c_kv.shape[1]
        H, D = (w_q.shape[1], w_q.shape[2])
        q = torch.einsum('bqm,mhd->bhqd', x, w_q)
        k = torch.einsum('bkc,chd->bhkd', c_kv, w_uk)
        v = torch.einsum('bkc,chd->bhkd', c_kv, w_uv)
        scores = torch.einsum('bhqd,bhkd->bhqk', q, k) * D ** (-0.5)
        off = Sk - Sq
        qi = torch.arange(Sq)[:, None]
        kj = torch.arange(Sk)[None, :]
        cmask = kj <= qi + off
        scores = torch.where(cmask[None, None], scores, -1000000000.0)
        p = _softmax(scores, axis=-1)
        ctx = torch.einsum('bhqk,bhkd->bhqd', p, v)
        return torch.einsum('bhqd,hdm->bqm', ctx, w_o)

    def _B_ref(x, W_gate, W_up, W_down):
        gate = torch.einsum('bsd,df->bsf', x, W_gate)
        up = torch.einsum('bsd,df->bsf', x, W_up)
        gate = gate * (lambda x, dt: x.to(dt))(gate > 0, gate.dtype)
        h = gate * up
        return torch.einsum('bsf,fd->bsd', h, W_down)
    x = A_x
    mod = (_silu(c) @ w_mod).reshape(c.shape[0], 6, 1, -1)
    sa, ca, ga, sb, cb, gb = (mod[:, 0].clone(), mod[:, 1].clone(), mod[:, 2].clone(), mod[:, 3].clone(), mod[:, 4].clone(), mod[:, 5].clone())
    h = _layernorm(x, axis=-1) * (1 + ca) + sa
    x = x + ga * _A_ref(h, A_c_kv, A_w_q, A_w_uk, A_w_uv, A_w_o)
    h = _layernorm(x, axis=-1) * (1 + cb) + sb
    x = x + gb * _B_ref(h, B_W_gate, B_W_up, B_W_down)
    return x
```

```asm
; @launch kernel=k_kv_kernel grid=(256,1,1) block=(512,1,1) lds=147968
; @launch kernel=k_attn_kernel grid=(256,1,1) block=(512,1,1) lds=163840
; @launch kernel=k_oproj_kernel grid=(256,1,1) block=(256,1,1) lds=131072
; @launch kernel=k_ln2_kernel grid=(512,1,1) block=(256,1,1) lds=0
; @launch kernel=k_gu_kernel grid=(224,1,1) block=(512,1,1) lds=147456
; @launch kernel=k_down_kernel grid=(256,1,1) block=(256,1,1) lds=131072
.amdgcn_target "amdgcn-amd-amdhsa--gfx950"
.text
.globl k_kv_kernel
.p2align 8
.type k_kv_kernel,@function
k_kv_kernel:
    s_cmp_ge_u32 s2, 256
    s_cbranch_scc1 .end_1
    s_load_dwordx2 s[40:41], s[0:1], 8
    s_load_dwordx2 s[42:43], s[0:1], 24
    s_load_dwordx2 s[44:45], s[0:1], 32
    s_load_dwordx2 s[46:47], s[0:1], 112
    s_load_dwordx2 s[48:49], s[0:1], 0
    s_load_dwordx2 s[72:73], s[0:1], 80
    s_load_dwordx2 s[76:77], s[0:1], 88
    s_load_dwordx2 s[92:93], s[0:1], 104
    s_load_dwordx2 s[100:101], s[0:1], 16
    s_and_b32 s35, s2, 7
    s_lshr_b32 s36, s2, 3
    s_and_b32 s37, s36, 1
    s_lshl_b32 s38, s35, 1
    s_add_u32 s37, s37, s38
    s_bfe_u32 s38, s36, 0x10001
    s_lshr_b32 s39, s36, 2
    v_and_b32 v1, 63, v0
    v_lshrrev_b32 v2, 6, v0
    s_nop 0
    v_readfirstlane_b32 s28, v2
    s_nop 2
    v_lshrrev_b32 v16, 3, v1
    s_lshl_b32 s90, s28, 3
    v_add_u32 v16, s90, v16
    v_bfe_u32 v10, v16, 1, 3
    v_and_b32 v11, 7, v1
    v_xor_b32 v10, v10, v11
    s_mov_b32 s90, 1024
    v_mul_lo_u32 v16, v16, s90
    v_lshl_add_u32 v16, v10, 4, v16
    v_lshrrev_b32 v17, 4, v1
    s_mul_i32 s90, s28, 4
    v_add_u32 v17, s90, v17
    v_and_b32 v10, 3, v17
    v_lshlrev_b32 v10, 2, v10
    s_mov_b32 s90, 8192
    v_mul_lo_u32 v17, v17, s90
    v_and_b32 v11, 15, v1
    v_xor_b32 v10, v10, v11
    v_lshl_add_u32 v17, v10, 4, v17
    s_lshl_b32 s33, s28, 10
    s_waitcnt lgkmcnt(0)
    s_mov_b32 s4, s40
    s_and_b32 s5, s41, 0xffff
    s_mov_b32 s6, 0x200000
    s_mov_b32 s7, 0x20000
    s_cmp_eq_u32 s38, 1
    s_cselect_b32 s50, s44, s42
    s_cselect_b32 s51, s45, s43
    s_mov_b32 s8, s50
    s_and_b32 s9, s51, 0xffff
    s_mov_b32 s10, 0x400000
    s_mov_b32 s11, 0x20000
    s_lshl_b32 s24, s39, 18
    s_lshl_b32 s25, s37, 9
    s_mov_b32 s56, s48
    s_and_b32 s57, s49, 0xffff
    s_mov_b32 s58, 0x200000
    s_mov_b32 s59, 0x20000
    s_mov_b32 s72, s72
    s_and_b32 s73, s73, 0xffff
    s_mov_b32 s74, 0x400
    s_mov_b32 s75, 0x20000
    s_mov_b32 s76, s76
    s_and_b32 s77, s77, 0xffff
    s_mov_b32 s78, 0x300000
    s_mov_b32 s79, 0x20000
    s_lshl_b32 s68, s2, 3
    s_add_u32 s68, s68, s28
    s_lshl_b32 s68, s68, 10
    v_lshlrev_b32 v180, 4, v1
    v_lshlrev_b32 v181, 5, v1
    buffer_load_dwordx4 v[184:187], v180, s[56:59], s68 offen
    s_min_u32 s69, s36, 23
    s_mul_i32 s70, s35, 24
    s_add_u32 s69, s69, s70
    v_lshrrev_b32 v182, 2, v0
    v_lshlrev_b32 v183, 3, v182
    buffer_load_dwordx2 v[196:197], v183, s[72:75], 0 offen
    v_mul_u32_u24 v182, 24576, v182
    v_and_b32 v183, 3, v0
    v_lshl_add_u32 v182, v183, 3, v182
    s_lshl_b32 s70, s69, 5
    buffer_load_dwordx2 v[200:201], v182, s[76:79], s70 offen
    s_add_u32 s70, s70, 6144
    buffer_load_dwordx2 v[202:203], v182, s[76:79], s70 offen
    s_add_u32 s70, s70, 6144
    buffer_load_dwordx2 v[204:205], v182, s[76:79], s70 offen
    s_add_u32 s70, s70, 6144
    buffer_load_dwordx2 v[206:207], v182, s[76:79], s70 offen
    s_add_u32 m0, s33, 0
    s_add_u32 s34, s24, 0
    buffer_load_dwordx4 v16, s[4:7], s34 offen lds
    s_add_u32 m0, s33, 8192
    s_add_u32 s34, s24, 65536
    buffer_load_dwordx4 v16, s[4:7], s34 offen lds
    s_add_u32 m0, s33, 16384
    s_add_u32 s34, s24, 131072
    buffer_load_dwordx4 v16, s[4:7], s34 offen lds
    s_add_u32 m0, s33, 24576
    s_add_u32 s34, s24, 196608
    buffer_load_dwordx4 v16, s[4:7], s34 offen lds
    s_add_u32 m0, s33, 32768
    s_add_u32 s34, s25, 0
    buffer_load_dwordx4 v17, s[8:11], s34 offen lds
    s_add_u32 m0, s33, 40960
    s_add_u32 s34, s25, 262144
    buffer_load_dwordx4 v17, s[8:11], s34 offen lds
    s_and_b32 s29, s28, 1
    s_lshr_b32 s30, s28, 1
    v_and_b32 v4, 31, v1
    v_lshrrev_b32 v5, 5, v1
    v_bfe_u32 v6, v1, 2, 2
    v_and_b32 v7, 3, v1
    v_bfe_u32 v8, v1, 4, 1
    s_mul_i32 s31, s30, 8192
    v_bfe_u32 v220, v4, 1, 3
    v_xor_b32 v220, v220, v5
    v_lshlrev_b32 v220, 4, v220
    v_lshl_add_u32 v220, v4, 7, v220
    v_add_u32 v220, s31, v220
    v_xor_b32 v221, 32, v220
    v_xor_b32 v222, 64, v220
    v_xor_b32 v223, 96, v220
    s_mul_i32 s31, s29, 2
    s_add_u32 s31, s31, 0
    s_and_b32 s32, s31, 3
    s_lshr_b32 s31, s31, 2
    s_lshl_b32 s31, s31, 8
    v_lshl_add_u32 v224, v5, 3, v6
    v_mul_u32_u24 v224, 256, v224
    v_xor_b32 v10, s32, v6
    v_lshl_add_u32 v224, v10, 6, v224
    v_lshl_add_u32 v224, v8, 5, v224
    v_lshl_add_u32 v224, v7, 3, v224
    v_add_u32 v224, 0x8000, v224
    v_add_u32 v224, s31, v224
    s_mul_i32 s31, s29, 2
    s_add_u32 s31, s31, 1
    s_and_b32 s32, s31, 3
    s_lshr_b32 s31, s31, 2
    s_lshl_b32 s31, s31, 8
    v_lshl_add_u32 v225, v5, 3, v6
    v_mul_u32_u24 v225, 256, v225
    v_xor_b32 v10, s32, v6
    v_lshl_add_u32 v225, v10, 6, v225
    v_lshl_add_u32 v225, v8, 5, v225
    v_lshl_add_u32 v225, v7, 3, v225
    v_add_u32 v225, 0x8000, v225
    v_add_u32 v225, s31, v225
    v_add_u32 v226, 0x10000, v220
    v_add_u32 v227, 0x10000, v221
    v_add_u32 v228, 0x10000, v222
    v_add_u32 v229, 0x10000, v223
    v_add_u32 v230, 0x20000, v220
    v_add_u32 v231, 0x20000, v221
    v_add_u32 v232, 0x20000, v222
    v_add_u32 v233, 0x20000, v223
    v_add_u32 v234, 0x10000, v224
    v_add_u32 v235, 0x10000, v225
    v_add_u32 v236, 0x20000, v224
    v_add_u32 v237, 0x20000, v225
    s_mul_i32 s52, s38, 16777216
    s_add_u32 s52, s46, s52
    s_addc_u32 s53, s47, 0
    s_add_u32 s16, s52, 0x400000
    s_addc_u32 s17, s53, 0
    s_and_b32 s17, s17, 0xffff
    s_mov_b32 s18, 0x1000000
    s_mov_b32 s19, 0x20000
    s_mov_b32 s60, s46
    s_and_b32 s61, s47, 0xffff
    s_mov_b32 s62, 0x3000
    s_mov_b32 s63, 0x20000
    s_add_u32 s64, s46, 0x10000
    s_addc_u32 s65, s47, 0
    s_and_b32 s65, s65, 0xffff
    s_mov_b32 s66, 0x200000
    s_mov_b32 s67, 0x20000
    s_mov_b32 s92, s92
    s_and_b32 s93, s93, 0xffff
    s_mov_b32 s94, 0x100
    s_mov_b32 s95, 0x20000
    v_lshlrev_b32 v238, 5, v4
    v_lshl_add_u32 v238, v5, 4, v238
    s_lshl_b32 s84, s39, 16
    s_lshl_b32 s54, s30, 14
    s_add_u32 s84, s84, s54
    s_lshl_b32 s54, s37, 20
    s_add_u32 s84, s84, s54
    s_lshl_b32 s54, s29, 12
    s_add_u32 s84, s84, s54
    s_add_u32 m0, s33, 49152
    s_add_u32 s34, s24, 128
    buffer_load_dwordx4 v16, s[4:7], s34 offen lds
    s_add_u32 m0, s33, 57344
    s_add_u32 s34, s24, 65664
    buffer_load_dwordx4 v16, s[4:7], s34 offen lds
    s_add_u32 m0, s33, 65536
    s_add_u32 s34, s24, 131200
    buffer_load_dwordx4 v16, s[4:7], s34 offen lds
    s_add_u32 m0, s33, 73728
    s_add_u32 s34, s24, 196736
    buffer_load_dwordx4 v16, s[4:7], s34 offen lds
    s_add_u32 m0, s33, 81920
    s_add_u32 s34, s25, 524288
    buffer_load_dwordx4 v17, s[8:11], s34 offen lds
    s_add_u32 m0, s33, 90112
    s_add_u32 s34, s25, 786432
    buffer_load_dwordx4 v17, s[8:11], s34 offen lds
    s_cmp_ge_u32 s68, 0x100000
    s_cselect_b32 s96, s44, s42
    s_cselect_b32 s97, s45, s43
    s_mov_b32 s96, s96
    s_and_b32 s97, s97, 0xffff
    s_mov_b32 s98, 0x400000
    s_mov_b32 s99, 0x20000
    s_and_b32 s70, s68, 0xfffff
    s_lshl_b32 s70, s70, 2
    v_bfe_u32 v14, v1, 1, 3
    v_lshlrev_b32 v14, 9, v14
    v_and_b32 v15, 1, v1
    v_lshl_add_u32 v14, v15, 7, v14
    buffer_load_dword v199, v14, s[96:99], s70 offen offset:0
    v_and_b32 v9, 7, v1
    v_lshlrev_b32 v9, 7, v9
    buffer_load_dword v199, v9, s[4:7], s68 offen
    s_waitcnt vmcnt(14)
    v_lshlrev_b32 v208, 16, v196
    v_and_b32 v209, 0xffff0000, v196
    v_lshlrev_b32 v210, 16, v197
    v_and_b32 v211, 0xffff0000, v197
    v_mul_f32 v216, 0xbfb8aa3b, v208
    v_exp_f32 v216, v216
    s_nop 0
    v_add_f32 v216, 1.0, v216
    v_rcp_f32 v216, v216
    s_nop 0
    v_mul_f32 v216, v216, v208
    v_cvt_pk_bf16_f32 v208, v216, v216
    v_lshlrev_b32 v208, 16, v208
    v_mul_f32 v216, 0xbfb8aa3b, v209
    v_exp_f32 v216, v216
    s_nop 0
    v_add_f32 v216, 1.0, v216
    v_rcp_f32 v216, v216
    s_nop 0
    v_mul_f32 v216, v216, v209
    v_cvt_pk_bf16_f32 v209, v216, v216
    v_lshlrev_b32 v209, 16, v209
    v_mul_f32 v216, 0xbfb8aa3b, v210
    v_exp_f32 v216, v216
    s_nop 0
    v_add_f32 v216, 1.0, v216
    v_rcp_f32 v216, v216
    s_nop 0
    v_mul_f32 v216, v216, v210
    v_cvt_pk_bf16_f32 v210, v216, v216
    v_lshlrev_b32 v210, 16, v210
    v_mul_f32 v216, 0xbfb8aa3b, v211
    v_exp_f32 v216, v216
    s_nop 0
    v_add_f32 v216, 1.0, v216
    v_rcp_f32 v216, v216
    s_nop 0
    v_mul_f32 v216, v216, v211
    v_cvt_pk_bf16_f32 v211, v216, v216
    v_lshlrev_b32 v211, 16, v211
    v_lshlrev_b32 v216, 16, v200
    v_and_b32 v217, 0xffff0000, v200
    v_mul_f32 v212, v216, v208
    v_mul_f32 v213, v217, v208
    v_lshlrev_b32 v216, 16, v201
    v_and_b32 v217, 0xffff0000, v201
    v_mul_f32 v214, v216, v208
    v_mul_f32 v215, v217, v208
    v_lshlrev_b32 v216, 16, v202
    v_and_b32 v217, 0xffff0000, v202
    v_fmac_f32 v212, v216, v209
    v_fmac_f32 v213, v217, v209
    v_lshlrev_b32 v216, 16, v203
    v_and_b32 v217, 0xffff0000, v203
    v_fmac_f32 v214, v216, v209
    v_fmac_f32 v215, v217, v209
    v_lshlrev_b32 v216, 16, v204
    v_and_b32 v217, 0xffff0000, v204
    v_fmac_f32 v212, v216, v210
    v_fmac_f32 v213, v217, v210
    v_lshlrev_b32 v216, 16, v205
    v_and_b32 v217, 0xffff0000, v205
    v_fmac_f32 v214, v216, v210
    v_fmac_f32 v215, v217, v210
    v_lshlrev_b32 v216, 16, v206
    v_and_b32 v217, 0xffff0000, v206
    v_fmac_f32 v212, v216, v211
    v_fmac_f32 v213, v217, v211
    v_lshlrev_b32 v216, 16, v207
    v_and_b32 v217, 0xffff0000, v207
    v_fmac_f32 v214, v216, v211
    v_fmac_f32 v215, v217, v211
    s_nop 1
    v_add_f32_dpp v212, v212, v212 row_ror:8 row_mask:0xf bank_mask:0xf
    v_add_f32_dpp v213, v213, v213 row_ror:8 row_mask:0xf bank_mask:0xf
    v_add_f32_dpp v214, v214, v214 row_ror:8 row_mask:0xf bank_mask:0xf
    v_add_f32_dpp v215, v215, v215 row_ror:8 row_mask:0xf bank_mask:0xf
    v_add_f32_dpp v212, v212, v212 row_ror:4 row_mask:0xf bank_mask:0xf
    v_add_f32_dpp v213, v213, v213 row_ror:4 row_mask:0xf bank_mask:0xf
    v_add_f32_dpp v214, v214, v214 row_ror:4 row_mask:0xf bank_mask:0xf
    v_add_f32_dpp v215, v215, v215 row_ror:4 row_mask:0xf bank_mask:0xf
    v_mov_b32 v216, v212
    v_mov_b32 v217, v213
    v_mov_b32 v218, v214
    v_mov_b32 v219, v215
    s_nop 1
    v_permlane16_swap_b32 v212, v216
    v_permlane16_swap_b32 v213, v217
    v_permlane16_swap_b32 v214, v218
    v_permlane16_swap_b32 v215, v219
    s_nop 1
    v_add_f32 v212, v212, v216
    v_add_f32 v213, v213, v217
    v_add_f32 v214, v214, v218
    v_add_f32 v215, v215, v219
    v_mov_b32 v216, v212
    v_mov_b32 v217, v213
    v_mov_b32 v218, v214
    v_mov_b32 v219, v215
    s_nop 1
    v_permlane32_swap_b32 v212, v216
    v_permlane32_swap_b32 v213, v217
    v_permlane32_swap_b32 v214, v218
    v_permlane32_swap_b32 v215, v219
    s_nop 1
    v_add_f32 v212, v212, v216
    v_add_f32 v213, v213, v217
    v_add_f32 v214, v214, v218
    v_add_f32 v215, v215, v219
    s_lshl_b32 s85, s28, 6
    s_add_u32 s85, s85, 147456
    v_lshlrev_b32 v183, 4, v183
    v_add_u32 v183, s85, v183
    ds_write_b128 v183, v[212:215]
    v_lshlrev_b32 v188, 16, v184
    v_and_b32 v189, 0xffff0000, v184
    v_lshlrev_b32 v190, 16, v185
    v_and_b32 v191, 0xffff0000, v185
    v_lshlrev_b32 v192, 16, v186
    v_and_b32 v193, 0xffff0000, v186
    v_lshlrev_b32 v194, 16, v187
    v_and_b32 v195, 0xffff0000, v187
    v_add_f32 v196, v188, v189
    v_add_f32 v196, v196, v190
    v_add_f32 v196, v196, v191
    v_add_f32 v196, v196, v192
    v_add_f32 v196, v196, v193
    v_add_f32 v196, v196, v194
    v_add_f32 v196, v196, v195
    s_nop 1
    v_add_f32_dpp v196, v196, v196 quad_perm:[1,0,3,2] row_mask:0xf bank_mask:0xf
    s_nop 1
    v_add_f32_dpp v196, v196, v196 quad_perm:[2,3,0,1] row_mask:0xf bank_mask:0xf
    s_nop 1
    v_add_f32_dpp v196, v196, v196 row_half_mirror row_mask:0xf bank_mask:0xf
    s_nop 1
    v_add_f32_dpp v196, v196, v196 row_mirror row_mask:0xf bank_mask:0xf
    v_mov_b32 v197, v196
    s_nop 1
    v_permlane16_swap_b32 v196, v197
    s_nop 1
    v_add_f32 v196, v196, v197
    v_mov_b32 v197, v196
    s_nop 1
    v_permlane32_swap_b32 v196, v197
    s_nop 1
    v_add_f32 v196, v196, v197
    v_mul_f32 v196, 0x3b000000, v196
    v_sub_f32 v188, v188, v196
    v_sub_f32 v189, v189, v196
    v_sub_f32 v190, v190, v196
    v_sub_f32 v191, v191, v196
    v_sub_f32 v192, v192, v196
    v_sub_f32 v193, v193, v196
    v_sub_f32 v194, v194, v196
    v_sub_f32 v195, v195, v196
    v_mul_f32 v198, v188, v188
    v_fmac_f32 v198, v189, v189
    v_fmac_f32 v198, v190, v190
    v_fmac_f32 v198, v191, v191
    v_fmac_f32 v198, v192, v192
    v_fmac_f32 v198, v193, v193
    v_fmac_f32 v198, v194, v194
    v_fmac_f32 v198, v195, v195
    s_nop 1
    v_add_f32_dpp v198, v198, v198 quad_perm:[1,0,3,2] row_mask:0xf bank_mask:0xf
    s_nop 1
    v_add_f32_dpp v198, v198, v198 quad_perm:[2,3,0,1] row_mask:0xf bank_mask:0xf
    s_nop 1
    v_add_f32_dpp v198, v198, v198 row_half_mirror row_mask:0xf bank_mask:0xf
    s_nop 1
    v_add_f32_dpp v198, v198, v198 row_mirror row_mask:0xf bank_mask:0xf
    v_mov_b32 v197, v198
    s_nop 1
    v_permlane16_swap_b32 v198, v197
    s_nop 1
    v_add_f32 v198, v198, v197
    v_mov_b32 v197, v198
    s_nop 1
    v_permlane32_swap_b32 v198, v197
    s_nop 1
    v_add_f32 v198, v198, v197
    v_mov_b32 v197, 0x3727c5ac
    v_fmac_f32 v197, 0x3b000000, v198
    v_rsq_f32 v197, v197
    s_nop 0
    v_mul_f32 v188, v188, v197
    v_mul_f32 v189, v189, v197
    v_mul_f32 v190, v190, v197
    v_mul_f32 v191, v191, v197
    v_mul_f32 v192, v192, v197
    v_mul_f32 v193, v193, v197
    v_mul_f32 v194, v194, v197
    v_mul_f32 v195, v195, v197
    s_waitcnt lgkmcnt(0)
    s_waitcnt vmcnt(8)
    s_barrier
    ds_read_b128 v[20:23], v220 offset:0
    ds_read_b128 v[24:27], v220 offset:4096
    ds_read_b64_tr_b16 v[28:29], v224 offset:0
    ds_read_b64_tr_b16 v[30:31], v224 offset:1024
    ds_read_b64_tr_b16 v[32:33], v225 offset:0
    ds_read_b64_tr_b16 v[34:35], v225 offset:1024
    s_cmp_lg_u32 s28, 0
    s_cbranch_scc1 .sk_2
    s_cmp_ge_u32 s36, 24
    s_cbranch_scc1 .sk_2
    v_and_b32 v182, 15, v1
    v_lshlrev_b32 v182, 2, v182
    v_add_u32 v183, 0x24000, v182
    ds_read_b32 v200, v183 offset:0
    ds_read_b32 v201, v183 offset:64
    ds_read_b32 v202, v183 offset:128
    ds_read_b32 v203, v183 offset:192
    ds_read_b32 v204, v183 offset:256
    ds_read_b32 v205, v183 offset:320
    ds_read_b32 v206, v183 offset:384
    ds_read_b32 v207, v183 offset:448
    s_waitcnt lgkmcnt(0)
    v_add_f32 v200, v200, v201
    v_add_f32 v200, v200, v202
    v_add_f32 v200, v200, v203
    v_add_f32 v200, v200, v204
    v_add_f32 v200, v200, v205
    v_add_f32 v200, v200, v206
    v_add_f32 v200, v200, v207
    v_cvt_pk_bf16_f32 v200, v200, v200
    v_lshlrev_b32 v200, 16, v200
    s_lshr_b32 s70, s69, 5
    s_cmp_eq_u32 s70, 1
    s_cselect_b32 s71, 1.0, 0
    s_cmp_eq_u32 s70, 4
    s_cselect_b32 s71, 1.0, s71
    v_add_f32 v200, s71, v200
    v_cvt_pk_bf16_f32 v200, v200, v200
    v_lshlrev_b32 v200, 16, v200
    s_lshl_b32 s70, s69, 6
    buffer_store_dword v200, v182, s[60:63], s70 offen sc0 sc1
.sk_2:
    s_waitcnt lgkmcnt(0)
    ds_read_b128 v[36:39], v221 offset:0
    ds_read_b128 v[40:43], v221 offset:4096
    ds_read_b64_tr_b16 v[44:45], v224 offset:4096
    ds_read_b64_tr_b16 v[46:47], v224 offset:5120
    ds_read_b64_tr_b16 v[48:49], v225 offset:4096
    ds_read_b64_tr_b16 v[50:51], v225 offset:5120
    v_mfma_f32_32x32x16_bf16 v[52:67], v[28:31], v[20:23], 0
    s_add_u32 m0, s33, 98304
    s_add_u32 s34, s24, 256
    buffer_load_dwordx4 v16, s[4:7], s34 offen lds
    v_mfma_f32_32x32x16_bf16 v[68:83], v[28:31], v[24:27], 0
    s_add_u32 m0, s33, 106496
    s_add_u32 s34, s24, 65792
    buffer_load_dwordx4 v16, s[4:7], s34 offen lds
    v_mfma_f32_32x32x16_bf16 v[84:99], v[32:35], v[20:23], 0
    s_add_u32 m0, s33, 114688
    s_add_u32 s34, s24, 131328
    buffer_load_dwordx4 v16, s[4:7], s34 offen lds
    v_mfma_f32_32x32x16_bf16 v[100:115], v[32:35], v[24:27], 0
    s_add_u32 m0, s33, 122880
    s_add_u32 s34, s24, 196864
    buffer_load_dwordx4 v16, s[4:7], s34 offen lds
    s_waitcnt lgkmcnt(0)
    ds_read_b128 v[20:23], v222 offset:0
    ds_read_b128 v[24:27], v222 offset:4096
    ds_read_b64_tr_b16 v[28:29], v224 offset:8192
    ds_read_b64_tr_b16 v[30:31], v224 offset:9216
    ds_read_b64_tr_b16 v[32:33], v225 offset:8192
    ds_read_b64_tr_b16 v[34:35], v225 offset:9216
    v_mfma_f32_32x32x16_bf16 v[52:67], v[44:47], v[36:39], v[52:67]
    s_add_u32 m0, s33, 131072
    s_add_u32 s34, s25, 1048576
    buffer_load_dwordx4 v17, s[8:11], s34 offen lds
    v_mfma_f32_32x32x16_bf16 v[68:83], v[44:47], v[40:43], v[68:83]
    s_add_u32 m0, s33, 139264
    s_add_u32 s34, s25, 1310720
    buffer_load_dwordx4 v17, s[8:11], s34 offen lds
    v_mfma_f32_32x32x16_bf16 v[84:99], v[48:51], v[36:39], v[84:99]
    v_mfma_f32_32x32x16_bf16 v[100:115], v[48:51], v[40:43], v[100:115]
    s_waitcnt lgkmcnt(0)
    ds_read_b128 v[36:39], v223 offset:0
    ds_read_b128 v[40:43], v223 offset:4096
    ds_read_b64_tr_b16 v[44:45], v224 offset:12288
    ds_read_b64_tr_b16 v[46:47], v224 offset:13312
    ds_read_b64_tr_b16 v[48:49], v225 offset:12288
    ds_read_b64_tr_b16 v[50:51], v225 offset:13312
    v_mfma_f32_32x32x16_bf16 v[52:67], v[28:31], v[20:23], v[52:67]
    v_mfma_f32_32x32x16_bf16 v[68:83], v[28:31], v[24:27], v[68:83]
    v_mfma_f32_32x32x16_bf16 v[84:99], v[32:35], v[20:23], v[84:99]
    v_mfma_f32_32x32x16_bf16 v[100:115], v[32:35], v[24:27], v[100:115]
    s_waitcnt lgkmcnt(0)
    s_waitcnt vmcnt(8)
    s_barrier
    ds_read_b128 v[20:23], v220 offset:49152
    ds_read_b128 v[24:27], v220 offset:53248
    ds_read_b64_tr_b16 v[28:29], v224 offset:49152
    ds_read_b64_tr_b16 v[30:31], v224 offset:50176
    ds_read_b64_tr_b16 v[32:33], v225 offset:49152
    ds_read_b64_tr_b16 v[34:35], v225 offset:50176
    v_mfma_f32_32x32x16_bf16 v[52:67], v[44:47], v[36:39], v[52:67]
    s_add_u32 m0, s33, 0
    s_add_u32 s34, s24, 384
    buffer_load_dwordx4 v16, s[4:7], s34 offen lds
    v_mfma_f32_32x32x16_bf16 v[68:83], v[44:47], v[40:43], v[68:83]
    s_add_u32 m0, s33, 8192
    s_add_u32 s34, s24, 65920
    buffer_load_dwordx4 v16, s[4:7], s34 offen lds
    v_mfma_f32_32x32x16_bf16 v[84:99], v[48:51], v[36:39], v[84:99]
    s_add_u32 m0, s33, 16384
    s_add_u32 s34, s24, 131456
    buffer_load_dwordx4 v16, s[4:7], s34 offen lds
    v_mfma_f32_32x32x16_bf16 v[100:115], v[48:51], v[40:43], v[100:115]
    s_add_u32 m0, s33, 24576
    s_add_u32 s34, s24, 196992
    buffer_load_dwordx4 v16, s[4:7], s34 offen lds
    s_waitcnt lgkmcnt(0)
    ds_read_b128 v[36:39], v221 offset:49152
    ds_read_b128 v[40:43], v221 offset:53248
    ds_read_b64_tr_b16 v[44:45], v224 offset:53248
    ds_read_b64_tr_b16 v[46:47], v224 offset:54272
    ds_read_b64_tr_b16 v[48:49], v225 offset:53248
    ds_read_b64_tr_b16 v[50:51], v225 offset:54272
    v_mfma_f32_32x32x16_bf16 v[52:67], v[28:31], v[20:23], v[52:67]
    s_add_u32 m0, s33, 32768
    s_add_u32 s34, s25, 1572864
    buffer_load_dwordx4 v17, s[8:11], s34 offen lds
    v_mfma_f32_32x32x16_bf16 v[68:83], v[28:31], v[24:27], v[68:83]
    s_add_u32 m0, s33, 40960
    s_add_u32 s34, s25, 1835008
    buffer_load_dwordx4 v17, s[8:11], s34 offen lds
    v_mfma_f32_32x32x16_bf16 v[84:99], v[32:35], v[20:23], v[84:99]
    v_mfma_f32_32x32x16_bf16 v[100:115], v[32:35], v[24:27], v[100:115]
    s_waitcnt lgkmcnt(0)
    ds_read_b128 v[20:23], v222 offset:49152
    ds_read_b128 v[24:27], v222 offset:53248
    ds_read_b64_tr_b16 v[28:29], v224 offset:57344
    ds_read_b64_tr_b16 v[30:31], v224 offset:58368
    ds_read_b64_tr_b16 v[32:33], v225 offset:57344
    ds_read_b64_tr_b16 v[34:35], v225 offset:58368
    v_mfma_f32_32x32x16_bf16 v[52:67], v[44:47], v[36:39], v[52:67]
    v_mfma_f32_32x32x16_bf16 v[68:83], v[44:47], v[40:43], v[68:83]
    v_mfma_f32_32x32x16_bf16 v[84:99], v[48:51], v[36:39], v[84:99]
    v_mfma_f32_32x32x16_bf16 v[100:115], v[48:51], v[40:43], v[100:115]
    s_waitcnt lgkmcnt(0)
    ds_read_b128 v[36:39], v223 offset:49152
    ds_read_b128 v[40:43], v223 offset:53248
    ds_read_b64_tr_b16 v[44:45], v224 offset:61440
    ds_read_b64_tr_b16 v[46:47], v224 offset:62464
    ds_read_b64_tr_b16 v[48:49], v225 offset:61440
    ds_read_b64_tr_b16 v[50:51], v225 offset:62464
    v_mfma_f32_32x32x16_bf16 v[52:67], v[28:31], v[20:23], v[52:67]
    v_mfma_f32_32x32x16_bf16 v[68:83], v[28:31], v[24:27], v[68:83]
    v_mfma_f32_32x32x16_bf16 v[84:99], v[32:35], v[20:23], v[84:99]
    v_mfma_f32_32x32x16_bf16 v[100:115], v[32:35], v[24:27], v[100:115]
    s_waitcnt lgkmcnt(0)
    s_waitcnt vmcnt(6)
    s_barrier
    ds_read_b128 v[20:23], v226 offset:32768
    ds_read_b128 v[24:27], v226 offset:36864
    ds_read_b64_tr_b16 v[28:29], v234 offset:32768
    ds_read_b64_tr_b16 v[30:31], v234 offset:33792
    ds_read_b64_tr_b16 v[32:33], v235 offset:32768
    ds_read_b64_tr_b16 v[34:35], v235 offset:33792
    v_mfma_f32_32x32x16_bf16 v[52:67], v[44:47], v[36:39], v[52:67]
    s_add_u32 m0, s33, 49152
    s_add_u32 s34, s24, 512
    buffer_load_dwordx4 v16, s[4:7], s34 offen lds
    v_mfma_f32_32x32x16_bf16 v[68:83], v[44:47], v[40:43], v[68:83]
    s_add_u32 m0, s33, 57344
    s_add_u32 s34, s24, 66048
    buffer_load_dwordx4 v16, s[4:7], s34 offen lds
    v_mfma_f32_32x32x16_bf16 v[84:99], v[48:51], v[36:39], v[84:99]
    s_add_u32 m0, s33, 65536
    s_add_u32 s34, s24, 131584
    buffer_load_dwordx4 v16, s[4:7], s34 offen lds
    v_mfma_f32_32x32x16_bf16 v[100:115], v[48:51], v[40:43], v[100:115]
    s_add_u32 m0, s33, 73728
    s_add_u32 s34, s24, 197120
    buffer_load_dwordx4 v16, s[4:7], s34 offen lds
    s_cmp_ge_u32 s68, 0x100000
    s_cselect_b32 s96, s44, s42
    s_cselect_b32 s97, s45, s43
    s_mov_b32 s96, s96
    s_and_b32 s97, s97, 0xffff
    s_mov_b32 s98, 0x400000
    s_mov_b32 s99, 0x20000
    s_and_b32 s70, s68, 0xfffff
    s_lshl_b32 s70, s70, 2
    v_bfe_u32 v14, v1, 1, 2
    v_lshlrev_b32 v14, 9, v14
    v_and_b32 v15, 1, v1
    v_lshl_add_u32 v14, v15, 7, v14
    buffer_load_dword v199, v14, s[96:99], s70 offen offset:256
    s_waitcnt lgkmcnt(0)
    ds_read_b128 v[36:39], v227 offset:32768
    ds_read_b128 v[40:43], v227 offset:36864
    ds_read_b64_tr_b16 v[44:45], v234 offset:36864
    ds_read_b64_tr_b16 v[46:47], v234 offset:37888
    ds_read_b64_tr_b16 v[48:49], v235 offset:36864
    ds_read_b64_tr_b16 v[50:51], v235 offset:37888
    v_mfma_f32_32x32x16_bf16 v[52:67], v[28:31], v[20:23], v[52:67]
    s_add_u32 m0, s33, 81920
    s_add_u32 s34, s25, 2097152
    buffer_load_dwordx4 v17, s[8:11], s34 offen lds
    v_mfma_f32_32x32x16_bf16 v[68:83], v[28:31], v[24:27], v[68:83]
    s_add_u32 m0, s33, 90112
    s_add_u32 s34, s25, 2359296
    buffer_load_dwordx4 v17, s[8:11], s34 offen lds
    v_mfma_f32_32x32x16_bf16 v[84:99], v[32:35], v[20:23], v[84:99]
    v_mfma_f32_32x32x16_bf16 v[100:115], v[32:35], v[24:27], v[100:115]
    s_waitcnt lgkmcnt(0)
    ds_read_b128 v[20:23], v228 offset:32768
    ds_read_b128 v[24:27], v228 offset:36864
    ds_read_b64_tr_b16 v[28:29], v234 offset:40960
    ds_read_b64_tr_b16 v[30:31], v234 offset:41984
    ds_read_b64_tr_b16 v[32:33], v235 offset:40960
    ds_read_b64_tr_b16 v[34:35], v235 offset:41984
    v_mfma_f32_32x32x16_bf16 v[52:67], v[44:47], v[36:39], v[52:67]
    v_mfma_f32_32x32x16_bf16 v[68:83], v[44:47], v[40:43], v[68:83]
    v_mfma_f32_32x32x16_bf16 v[84:99], v[48:51], v[36:39], v[84:99]
    v_mfma_f32_32x32x16_bf16 v[100:115], v[48:51], v[40:43], v[100:115]
    s_waitcnt lgkmcnt(0)
    ds_read_b128 v[36:39], v229 offset:32768
    ds_read_b128 v[40:43], v229 offset:36864
    ds_read_b64_tr_b16 v[44:45], v234 offset:45056
    ds_read_b64_tr_b16 v[46:47], v234 offset:46080
    ds_read_b64_tr_b16 v[48:49], v235 offset:45056
    ds_read_b64_tr_b16 v[50:51], v235 offset:46080
    v_mfma_f32_32x32x16_bf16 v[52:67], v[28:31], v[20:23], v[52:67]
    v_mfma_f32_32x32x16_bf16 v[68:83], v[28:31], v[24:27], v[68:83]
    v_mfma_f32_32x32x16_bf16 v[84:99], v[32:35], v[20:23], v[84:99]
    v_mfma_f32_32x32x16_bf16 v[100:115], v[32:35], v[24:27], v[100:115]
    s_waitcnt lgkmcnt(0)
    s_waitcnt vmcnt(7)
    s_barrier
    ds_read_b128 v[20:23], v220 offset:0
    ds_read_b128 v[24:27], v220 offset:4096
    ds_read_b64_tr_b16 v[28:29], v224 offset:0
    ds_read_b64_tr_b16 v[30:31], v224 offset:1024
    ds_read_b64_tr_b16 v[32:33], v225 offset:0
    ds_read_b64_tr_b16 v[34:35], v225 offset:1024
    v_mfma_f32_32x32x16_bf16 v[52:67], v[44:47], v[36:39], v[52:67]
    s_add_u32 m0, s33, 98304
    s_add_u32 s34, s24, 640
    buffer_load_dwordx4 v16, s[4:7], s34 offen lds
    v_mfma_f32_32x32x16_bf16 v[68:83], v[44:47], v[40:43], v[68:83]
    s_add_u32 m0, s33, 106496
    s_add_u32 s34, s24, 66176
    buffer_load_dwordx4 v16, s[4:7], s34 offen lds
    v_mfma_f32_32x32x16_bf16 v[84:99], v[48:51], v[36:39], v[84:99]
    s_add_u32 m0, s33, 114688
    s_add_u32 s34, s24, 131712
    buffer_load_dwordx4 v16, s[4:7], s34 offen lds
    v_mfma_f32_32x32x16_bf16 v[100:115], v[48:51], v[40:43], v[100:115]
    s_add_u32 m0, s33, 122880
    s_add_u32 s34, s24, 197248
    buffer_load_dwordx4 v16, s[4:7], s34 offen lds
    s_cmp_lg_u32 s28, 0
    s_cbranch_scc1 .sk_3
    s_cmp_ge_u32 s36, 24
    s_cbranch_scc1 .sk_3
    s_cmp_ge_u32 s69, 64
    s_cbranch_scc1 .sk_3
    v_mov_b32 v182, 0
    v_mov_b32 v183, 1
    s_mov_b64 exec, 1
    buffer_atomic_add v183, v182, s[92:95], 0 offen sc1
    s_mov_b64 exec, -1
.sk_3:
    s_cmp_ge_u32 s68, 0x100000
    s_cselect_b32 s96, s44, s42
    s_cselect_b32 s97, s45, s43
    s_mov_b32 s96, s96
    s_and_b32 s97, s97, 0xffff
    s_mov_b32 s98, 0x400000
    s_mov_b32 s99, 0x20000
    s_and_b32 s70, s68, 0xfffff
    s_lshl_b32 s70, s70, 2
    v_bfe_u32 v14, v1, 1, 2
    v_lshlrev_b32 v14, 9, v14
    v_and_b32 v15, 1, v1
    v_lshl_add_u32 v14, v15, 7, v14
    buffer_load_dword v199, v14, s[96:99], s70 offen offset:2304
    s_waitcnt lgkmcnt(0)
    ds_read_b128 v[36:39], v221 offset:0
    ds_read_b128 v[40:43], v221 offset:4096
    ds_read_b64_tr_b16 v[44:45], v224 offset:4096
    ds_read_b64_tr_b16 v[46:47], v224 offset:5120
    ds_read_b64_tr_b16 v[48:49], v225 offset:4096
    ds_read_b64_tr_b16 v[50:51], v225 offset:5120
    v_mfma_f32_32x32x16_bf16 v[52:67], v[28:31], v[20:23], v[52:67]
    s_add_u32 m0, s33, 131072
    s_add_u32 s34, s25, 2621440
    buffer_load_dwordx4 v17, s[8:11], s34 offen lds
    v_mfma_f32_32x32x16_bf16 v[68:83], v[28:31], v[24:27], v[68:83]
    s_add_u32 m0, s33, 139264
    s_add_u32 s34, s25, 2883584
    buffer_load_dwordx4 v17, s[8:11], s34 offen lds
    v_mfma_f32_32x32x16_bf16 v[84:99], v[32:35], v[20:23], v[84:99]
    v_mfma_f32_32x32x16_bf16 v[100:115], v[32:35], v[24:27], v[100:115]
    s_waitcnt lgkmcnt(0)
    ds_read_b128 v[20:23], v222 offset:0
    ds_read_b128 v[24:27], v222 offset:4096
    ds_read_b64_tr_b16 v[28:29], v224 offset:8192
    ds_read_b64_tr_b16 v[30:31], v224 offset:9216
    ds_read_b64_tr_b16 v[32:33], v225 offset:8192
    ds_read_b64_tr_b16 v[34:35], v225 offset:9216
    v_mfma_f32_32x32x16_bf16 v[52:67], v[44:47], v[36:39], v[52:67]
    v_mfma_f32_32x32x16_bf16 v[68:83], v[44:47], v[40:43], v[68:83]
    v_mfma_f32_32x32x16_bf16 v[84:99], v[48:51], v[36:39], v[84:99]
    v_mfma_f32_32x32x16_bf16 v[100:115], v[48:51], v[40:43], v[100:115]
    s_waitcnt lgkmcnt(0)
    ds_read_b128 v[36:39], v223 offset:0
    ds_read_b128 v[40:43], v223 offset:4096
    ds_read_b64_tr_b16 v[44:45], v224 offset:12288
    ds_read_b64_tr_b16 v[46:47], v224 offset:13312
    ds_read_b64_tr_b16 v[48:49], v225 offset:12288
    ds_read_b64_tr_b16 v[50:51], v225 offset:13312
    v_mfma_f32_32x32x16_bf16 v[52:67], v[28:31], v[20:23], v[52:67]
    v_mfma_f32_32x32x16_bf16 v[68:83], v[28:31], v[24:27], v[68:83]
    v_mfma_f32_32x32x16_bf16 v[84:99], v[32:35], v[20:23], v[84:99]
    v_mfma_f32_32x32x16_bf16 v[100:115], v[32:35], v[24:27], v[100:115]
    s_waitcnt lgkmcnt(0)
    s_waitcnt vmcnt(7)
    s_barrier
    ds_read_b128 v[20:23], v220 offset:49152
    ds_read_b128 v[24:27], v220 offset:53248
    ds_read_b64_tr_b16 v[28:29], v224 offset:49152
    ds_read_b64_tr_b16 v[30:31], v224 offset:50176
    ds_read_b64_tr_b16 v[32:33], v225 offset:49152
    ds_read_b64_tr_b16 v[34:35], v225 offset:50176
    v_mfma_f32_32x32x16_bf16 v[52:67], v[44:47], v[36:39], v[52:67]
    s_add_u32 m0, s33, 0
    s_add_u32 s34, s24, 768
    buffer_load_dwordx4 v16, s[4:7], s34 offen lds
    v_mfma_f32_32x32x16_bf16 v[68:83], v[44:47], v[40:43], v[68:83]
    s_add_u32 m0, s33, 8192
    s_add_u32 s34, s24, 66304
    buffer_load_dwordx4 v16, s[4:7], s34 offen lds
    v_mfma_f32_32x32x16_bf16 v[84:99], v[48:51], v[36:39], v[84:99]
    s_add_u32 m0, s33, 16384
    s_add_u32 s34, s24, 131840
    buffer_load_dwordx4 v16, s[4:7], s34 offen lds
    v_mfma_f32_32x32x16_bf16 v[100:115], v[48:51], v[40:43], v[100:115]
    s_add_u32 m0, s33, 24576
    s_add_u32 s34, s24, 197376
    buffer_load_dwordx4 v16, s[4:7], s34 offen lds
    s_waitcnt lgkmcnt(0)
    ds_read_b128 v[36:39], v221 offset:49152
    ds_read_b128 v[40:43], v221 offset:53248
    ds_read_b64_tr_b16 v[44:45], v224 offset:53248
    ds_read_b64_tr_b16 v[46:47], v224 offset:54272
    ds_read_b64_tr_b16 v[48:49], v225 offset:53248
    ds_read_b64_tr_b16 v[50:51], v225 offset:54272
    v_mfma_f32_32x32x16_bf16 v[52:67], v[28:31], v[20:23], v[52:67]
    s_add_u32 m0, s33, 32768
    s_add_u32 s34, s25, 3145728
    buffer_load_dwordx4 v17, s[8:11], s34 offen lds
    v_mfma_f32_32x32x16_bf16 v[68:83], v[28:31], v[24:27], v[68:83]
    s_add_u32 m0, s33, 40960
    s_add_u32 s34, s25, 3407872
    buffer_load_dwordx4 v17, s[8:11], s34 offen lds
    v_mfma_f32_32x32x16_bf16 v[84:99], v[32:35], v[20:23], v[84:99]
    v_mfma_f32_32x32x16_bf16 v[100:115], v[32:35], v[24:27], v[100:115]
    s_waitcnt lgkmcnt(0)
    ds_read_b128 v[20:23], v222 offset:49152
    ds_read_b128 v[24:27], v222 offset:53248
    ds_read_b64_tr_b16 v[28:29], v224 offset:57344
    ds_read_b64_tr_b16 v[30:31], v224 offset:58368
    ds_read_b64_tr_b16 v[32:33], v225 offset:57344
    ds_read_b64_tr_b16 v[34:35], v225 offset:58368
    v_mfma_f32_32x32x16_bf16 v[52:67], v[44:47], v[36:39], v[52:67]
    v_mfma_f32_32x32x16_bf16 v[68:83], v[44:47], v[40:43], v[68:83]
    v_mfma_f32_32x32x16_bf16 v[84:99], v[48:51], v[36:39], v[84:99]
    v_mfma_f32_32x32x16_bf16 v[100:115], v[48:51], v[40:43], v[100:115]
    s_waitcnt lgkmcnt(0)
    ds_read_b128 v[36:39], v223 offset:49152
    ds_read_b128 v[40:43], v223 offset:53248
    ds_read_b64_tr_b16 v[44:45], v224 offset:61440
    ds_read_b64_tr_b16 v[46:47], v224 offset:62464
    ds_read_b64_tr_b16 v[48:49], v225 offset:61440
    ds_read_b64_tr_b16 v[50:51], v225 offset:62464
    v_mfma_f32_32x32x16_bf16 v[52:67], v[28:31], v[20:23], v[52:67]
    v_mfma_f32_32x32x16_bf16 v[68:83], v[28:31], v[24:27], v[68:83]
    v_mfma_f32_32x32x16_bf16 v[84:99], v[32:35], v[20:23], v[84:99]
    v_mfma_f32_32x32x16_bf16 v[100:115], v[32:35], v[24:27], v[100:115]
    s_waitcnt lgkmcnt(0)
    s_waitcnt vmcnt(6)
    s_barrier
    ds_read_b128 v[20:23], v226 offset:32768
    ds_read_b128 v[24:27], v226 offset:36864
    ds_read_b64_tr_b16 v[28:29], v234 offset:32768
    ds_read_b64_tr_b16 v[30:31], v234 offset:33792
    ds_read_b64_tr_b16 v[32:33], v235 offset:32768
    ds_read_b64_tr_b16 v[34:35], v235 offset:33792
    v_mfma_f32_32x32x16_bf16 v[52:67], v[44:47], v[36:39], v[52:67]
    s_add_u32 m0, s33, 49152
    s_add_u32 s34, s24, 896
    buffer_load_dwordx4 v16, s[4:7], s34 offen lds
    v_mfma_f32_32x32x16_bf16 v[68:83], v[44:47], v[40:43], v[68:83]
    s_add_u32 m0, s33, 57344
    s_add_u32 s34, s24, 66432
    buffer_load_dwordx4 v16, s[4:7], s34 offen lds
    v_mfma_f32_32x32x16_bf16 v[84:99], v[48:51], v[36:39], v[84:99]
    s_add_u32 m0, s33, 65536
    s_add_u32 s34, s24, 131968
    buffer_load_dwordx4 v16, s[4:7], s34 offen lds
    v_mfma_f32_32x32x16_bf16 v[100:115], v[48:51], v[40:43], v[100:115]
    s_add_u32 m0, s33, 73728
    s_add_u32 s34, s24, 197504
    buffer_load_dwordx4 v16, s[4:7], s34 offen lds
    s_mov_b32 s96, s100
    s_and_b32 s97, s101, 0xffff
    s_mov_b32 s98, 0x400000
    s_mov_b32 s99, 0x20000
    s_lshl_b32 s70, s68, 1
    v_and_b32 v12, 7, v1
    v_lshlrev_b32 v12, 7, v12
    buffer_load_dword v199, v12, s[96:99], s70 offen offset:0
    s_waitcnt lgkmcnt(0)
    ds_read_b128 v[36:39], v227 offset:32768
    ds_read_b128 v[40:43], v227 offset:36864
    ds_read_b64_tr_b16 v[44:45], v234 offset:36864
    ds_read_b64_tr_b16 v[46:47], v234 offset:37888
    ds_read_b64_tr_b16 v[48:49], v235 offset:36864
    ds_read_b64_tr_b16 v[50:51], v235 offset:37888
    v_mfma_f32_32x32x16_bf16 v[52:67], v[28:31], v[20:23], v[52:67]
    s_add_u32 m0, s33, 81920
    s_add_u32 s34, s25, 3670016
    buffer_load_dwordx4 v17, s[8:11], s34 offen lds
    v_mfma_f32_32x32x16_bf16 v[68:83], v[28:31], v[24:27], v[68:83]
    s_add_u32 m0, s33, 90112
    s_add_u32 s34, s25, 3932160
    buffer_load_dwordx4 v17, s[8:11], s34 offen lds
    v_mfma_f32_32x32x16_bf16 v[84:99], v[32:35], v[20:23], v[84:99]
    v_mfma_f32_32x32x16_bf16 v[100:115], v[32:35], v[24:27], v[100:115]
    s_waitcnt lgkmcnt(0)
    ds_read_b128 v[20:23], v228 offset:32768
    ds_read_b128 v[24:27], v228 offset:36864
    ds_read_b64_tr_b16 v[28:29], v234 offset:40960
    ds_read_b64_tr_b16 v[30:31], v234 offset:41984
    ds_read_b64_tr_b16 v[32:33], v235 offset:40960
    ds_read_b64_tr_b16 v[34:35], v235 offset:41984
    v_mfma_f32_32x32x16_bf16 v[52:67], v[44:47], v[36:39], v[52:67]
    v_mfma_f32_32x32x16_bf16 v[68:83], v[44:47], v[40:43], v[68:83]
    v_mfma_f32_32x32x16_bf16 v[84:99], v[48:51], v[36:39], v[84:99]
    v_mfma_f32_32x32x16_bf16 v[100:115], v[48:51], v[40:43], v[100:115]
    s_waitcnt lgkmcnt(0)
    ds_read_b128 v[36:39], v229 offset:32768
    ds_read_b128 v[40:43], v229 offset:36864
    ds_read_b64_tr_b16 v[44:45], v234 offset:45056
    ds_read_b64_tr_b16 v[46:47], v234 offset:46080
    ds_read_b64_tr_b16 v[48:49], v235 offset:45056
    ds_read_b64_tr_b16 v[50:51], v235 offset:46080
    v_mfma_f32_32x32x16_bf16 v[52:67], v[28:31], v[20:23], v[52:67]
    v_mfma_f32_32x32x16_bf16 v[68:83], v[28:31], v[24:27], v[68:83]
    v_mfma_f32_32x32x16_bf16 v[84:99], v[32:35], v[20:23], v[84:99]
    v_mfma_f32_32x32x16_bf16 v[100:115], v[32:35], v[24:27], v[100:115]
    s_waitcnt lgkmcnt(0)
    s_waitcnt vmcnt(7)
    s_barrier
    ds_read_b128 v[20:23], v220 offset:0
    ds_read_b128 v[24:27], v220 offset:4096
    ds_read_b64_tr_b16 v[28:29], v224 offset:0
    ds_read_b64_tr_b16 v[30:31], v224 offset:1024
    ds_read_b64_tr_b16 v[32:33], v225 offset:0
    ds_read_b64_tr_b16 v[34:35], v225 offset:1024
    v_mfma_f32_32x32x16_bf16 v[52:67], v[44:47], v[36:39], v[52:67]
    s_add_u32 m0, s33, 98304
    s_add_u32 s34, s24, 0
    buffer_load_dwordx4 v16, s[4:7], s34 offen lds
    v_mfma_f32_32x32x16_bf16 v[68:83], v[44:47], v[40:43], v[68:83]
    s_add_u32 m0, s33, 106496
    s_add_u32 s34, s24, 65536
    buffer_load_dwordx4 v16, s[4:7], s34 offen lds
    v_mfma_f32_32x32x16_bf16 v[84:99], v[48:51], v[36:39], v[84:99]
    s_add_u32 m0, s33, 114688
    s_add_u32 s34, s24, 131072
    buffer_load_dwordx4 v16, s[4:7], s34 offen lds
    v_mfma_f32_32x32x16_bf16 v[100:115], v[48:51], v[40:43], v[100:115]
    s_add_u32 m0, s33, 122880
    s_add_u32 s34, s24, 196608
    buffer_load_dwordx4 v16, s[4:7], s34 offen lds
    s_mov_b32 s96, s100
    s_and_b32 s97, s101, 0xffff
    s_mov_b32 s98, 0x400000
    s_mov_b32 s99, 0x20000
    s_lshl_b32 s70, s68, 1
    v_and_b32 v12, 7, v1
    v_lshlrev_b32 v12, 7, v12
    buffer_load_dword v199, v12, s[96:99], s70 offen offset:1024
    s_waitcnt lgkmcnt(0)
    ds_read_b128 v[36:39], v221 offset:0
    ds_read_b128 v[40:43], v221 offset:4096
    ds_read_b64_tr_b16 v[44:45], v224 offset:4096
    ds_read_b64_tr_b16 v[46:47], v224 offset:5120
    ds_read_b64_tr_b16 v[48:49], v225 offset:4096
    ds_read_b64_tr_b16 v[50:51], v225 offset:5120
    v_mfma_f32_32x32x16_bf16 v[52:67], v[28:31], v[20:23], v[52:67]
    s_add_u32 m0, s33, 131072
    s_add_u32 s34, s25, 256
    buffer_load_dwordx4 v17, s[8:11], s34 offen lds
    v_mfma_f32_32x32x16_bf16 v[68:83], v[28:31], v[24:27], v[68:83]
    s_add_u32 m0, s33, 139264
    s_add_u32 s34, s25, 262400
    buffer_load_dwordx4 v17, s[8:11], s34 offen lds
    v_mfma_f32_32x32x16_bf16 v[84:99], v[32:35], v[20:23], v[84:99]
    v_mfma_f32_32x32x16_bf16 v[100:115], v[32:35], v[24:27], v[100:115]
    s_waitcnt lgkmcnt(0)
    ds_read_b128 v[20:23], v222 offset:0
    ds_read_b128 v[24:27], v222 offset:4096
    ds_read_b64_tr_b16 v[28:29], v224 offset:8192
    ds_read_b64_tr_b16 v[30:31], v224 offset:9216
    ds_read_b64_tr_b16 v[32:33], v225 offset:8192
    ds_read_b64_tr_b16 v[34:35], v225 offset:9216
    v_mfma_f32_32x32x16_bf16 v[52:67], v[44:47], v[36:39], v[52:67]
    v_mfma_f32_32x32x16_bf16 v[68:83], v[44:47], v[40:43], v[68:83]
    v_mfma_f32_32x32x16_bf16 v[84:99], v[48:51], v[36:39], v[84:99]
    v_mfma_f32_32x32x16_bf16 v[100:115], v[48:51], v[40:43], v[100:115]
    s_waitcnt lgkmcnt(0)
    ds_read_b128 v[36:39], v223 offset:0
    ds_read_b128 v[40:43], v223 offset:4096
    ds_read_b64_tr_b16 v[44:45], v224 offset:12288
    ds_read_b64_tr_b16 v[46:47], v224 offset:13312
    ds_read_b64_tr_b16 v[48:49], v225 offset:12288
    ds_read_b64_tr_b16 v[50:51], v225 offset:13312
    v_mfma_f32_32x32x16_bf16 v[52:67], v[28:31], v[20:23], v[52:67]
    v_mfma_f32_32x32x16_bf16 v[68:83], v[28:31], v[24:27], v[68:83]
    v_mfma_f32_32x32x16_bf16 v[84:99], v[32:35], v[20:23], v[84:99]
    v_mfma_f32_32x32x16_bf16 v[100:115], v[32:35], v[24:27], v[100:115]
    s_waitcnt lgkmcnt(0)
    s_waitcnt vmcnt(7)
    s_barrier
    ds_read_b128 v[20:23], v220 offset:49152
    ds_read_b128 v[24:27], v220 offset:53248
    ds_read_b64_tr_b16 v[28:29], v224 offset:49152
    ds_read_b64_tr_b16 v[30:31], v224 offset:50176
    ds_read_b64_tr_b16 v[32:33], v225 offset:49152
    ds_read_b64_tr_b16 v[34:35], v225 offset:50176
    v_mfma_f32_32x32x16_bf16 v[52:67], v[44:47], v[36:39], v[52:67]
    s_add_u32 m0, s33, 0
    s_add_u32 s34, s24, 128
    buffer_load_dwordx4 v16, s[4:7], s34 offen lds
    v_mfma_f32_32x32x16_bf16 v[68:83], v[44:47], v[40:43], v[68:83]
    s_add_u32 m0, s33, 8192
    s_add_u32 s34, s24, 65664
    buffer_load_dwordx4 v16, s[4:7], s34 offen lds
    v_mfma_f32_32x32x16_bf16 v[84:99], v[48:51], v[36:39], v[84:99]
    s_add_u32 m0, s33, 16384
    s_add_u32 s34, s24, 131200
    buffer_load_dwordx4 v16, s[4:7], s34 offen lds
    v_mfma_f32_32x32x16_bf16 v[100:115], v[48:51], v[40:43], v[100:115]
    s_add_u32 m0, s33, 24576
    s_add_u32 s34, s24, 196736
    buffer_load_dwordx4 v16, s[4:7], s34 offen lds
    s_waitcnt lgkmcnt(0)
    ds_read_b128 v[36:39], v221 offset:49152
    ds_read_b128 v[40:43], v221 offset:53248
    ds_read_b64_tr_b16 v[44:45], v224 offset:53248
    ds_read_b64_tr_b16 v[46:47], v224 offset:54272
    ds_read_b64_tr_b16 v[48:49], v225 offset:53248
    ds_read_b64_tr_b16 v[50:51], v225 offset:54272
    v_mfma_f32_32x32x16_bf16 v[52:67], v[28:31], v[20:23], v[52:67]
    s_add_u32 m0, s33, 32768
    s_add_u32 s34, s25, 524544
    buffer_load_dwordx4 v17, s[8:11], s34 offen lds
    v_mfma_f32_32x32x16_bf16 v[68:83], v[28:31], v[24:27], v[68:83]
    s_add_u32 m0, s33, 40960
    s_add_u32 s34, s25, 786688
    buffer_load_dwordx4 v17, s[8:11], s34 offen lds
    v_mfma_f32_32x32x16_bf16 v[84:99], v[32:35], v[20:23], v[84:99]
    v_mfma_f32_32x32x16_bf16 v[100:115], v[32:35], v[24:27], v[100:115]
    s_waitcnt lgkmcnt(0)
    ds_read_b128 v[20:23], v222 offset:49152
    ds_read_b128 v[24:27], v222 offset:53248
    ds_read_b64_tr_b16 v[28:29], v224 offset:57344
    ds_read_b64_tr_b16 v[30:31], v224 offset:58368
    ds_read_b64_tr_b16 v[32:33], v225 offset:57344
    ds_read_b64_tr_b16 v[34:35], v225 offset:58368
    v_mfma_f32_32x32x16_bf16 v[52:67], v[44:47], v[36:39], v[52:67]
    v_mfma_f32_32x32x16_bf16 v[68:83], v[44:47], v[40:43], v[68:83]
    v_mfma_f32_32x32x16_bf16 v[84:99], v[48:51], v[36:39], v[84:99]
    v_mfma_f32_32x32x16_bf16 v[100:115], v[48:51], v[40:43], v[100:115]
    s_waitcnt lgkmcnt(0)
    ds_read_b128 v[36:39], v223 offset:49152
    ds_read_b128 v[40:43], v223 offset:53248
    ds_read_b64_tr_b16 v[44:45], v224 offset:61440
    ds_read_b64_tr_b16 v[46:47], v224 offset:62464
    ds_read_b64_tr_b16 v[48:49], v225 offset:61440
    ds_read_b64_tr_b16 v[50:51], v225 offset:62464
    v_mfma_f32_32x32x16_bf16 v[52:67], v[28:31], v[20:23], v[52:67]
    v_mfma_f32_32x32x16_bf16 v[68:83], v[28:31], v[24:27], v[68:83]
    v_mfma_f32_32x32x16_bf16 v[84:99], v[32:35], v[20:23], v[84:99]
    v_mfma_f32_32x32x16_bf16 v[100:115], v[32:35], v[24:27], v[100:115]
    s_waitcnt lgkmcnt(0)
    s_waitcnt vmcnt(6)
    s_barrier
    ds_read_b128 v[20:23], v226 offset:32768
    ds_read_b128 v[24:27], v226 offset:36864
    ds_read_b64_tr_b16 v[28:29], v234 offset:32768
    ds_read_b64_tr_b16 v[30:31], v234 offset:33792
    ds_read_b64_tr_b16 v[32:33], v235 offset:32768
    ds_read_b64_tr_b16 v[34:35], v235 offset:33792
    v_mfma_f32_32x32x16_bf16 v[52:67], v[44:47], v[36:39], v[52:67]
    s_add_u32 m0, s33, 49152
    s_add_u32 s34, s24, 256
    buffer_load_dwordx4 v16, s[4:7], s34 offen lds
    v_mfma_f32_32x32x16_bf16 v[68:83], v[44:47], v[40:43], v[68:83]
    s_add_u32 m0, s33, 57344
    s_add_u32 s34, s24, 65792
    buffer_load_dwordx4 v16, s[4:7], s34 offen lds
    v_mfma_f32_32x32x16_bf16 v[84:99], v[48:51], v[36:39], v[84:99]
    s_add_u32 m0, s33, 65536
    s_add_u32 s34, s24, 131328
    buffer_load_dwordx4 v16, s[4:7], s34 offen lds
    v_mfma_f32_32x32x16_bf16 v[100:115], v[48:51], v[40:43], v[100:115]
    s_add_u32 m0, s33, 73728
    s_add_u32 s34, s24, 196864
    buffer_load_dwordx4 v16, s[4:7], s34 offen lds
    s_waitcnt lgkmcnt(0)
    ds_read_b128 v[36:39], v227 offset:32768
    ds_read_b128 v[40:43], v227 offset:36864
    ds_read_b64_tr_b16 v[44:45], v234 offset:36864
    ds_read_b64_tr_b16 v[46:47], v234 offset:37888
    ds_read_b64_tr_b16 v[48:49], v235 offset:36864
    ds_read_b64_tr_b16 v[50:51], v235 offset:37888
    v_mfma_f32_32x32x16_bf16 v[116:131], v[28:31], v[20:23], 0
    s_add_u32 m0, s33, 81920
    s_add_u32 s34, s25, 1048832
    buffer_load_dwordx4 v17, s[8:11], s34 offen lds
    v_mfma_f32_32x32x16_bf16 v[132:147], v[28:31], v[24:27], 0
    s_add_u32 m0, s33, 90112
    s_add_u32 s34, s25, 1310976
    buffer_load_dwordx4 v17, s[8:11], s34 offen lds
    v_mfma_f32_32x32x16_bf16 v[148:163], v[32:35], v[20:23], 0
    v_mfma_f32_32x32x16_bf16 v[164:179], v[32:35], v[24:27], 0
    s_waitcnt lgkmcnt(0)
    ds_read_b128 v[20:23], v228 offset:32768
    ds_read_b128 v[24:27], v228 offset:36864
    ds_read_b64_tr_b16 v[28:29], v234 offset:40960
    ds_read_b64_tr_b16 v[30:31], v234 offset:41984
    ds_read_b64_tr_b16 v[32:33], v235 offset:40960
    ds_read_b64_tr_b16 v[34:35], v235 offset:41984
    v_mfma_f32_32x32x16_bf16 v[116:131], v[44:47], v[36:39], v[116:131]
    v_mfma_f32_32x32x16_bf16 v[132:147], v[44:47], v[40:43], v[132:147]
    v_mfma_f32_32x32x16_bf16 v[148:163], v[48:51], v[36:39], v[148:163]
    v_mfma_f32_32x32x16_bf16 v[164:179], v[48:51], v[40:43], v[164:179]
    s_waitcnt lgkmcnt(0)
    ds_read_b128 v[36:39], v229 offset:32768
    ds_read_b128 v[40:43], v229 offset:36864
    ds_read_b64_tr_b16 v[44:45], v234 offset:45056
    ds_read_b64_tr_b16 v[46:47], v234 offset:46080
    ds_read_b64_tr_b16 v[48:49], v235 offset:45056
    ds_read_b64_tr_b16 v[50:51], v235 offset:46080
    v_mfma_f32_32x32x16_bf16 v[116:131], v[28:31], v[20:23], v[116:131]
    v_mfma_f32_32x32x16_bf16 v[132:147], v[28:31], v[24:27], v[132:147]
    v_mfma_f32_32x32x16_bf16 v[148:163], v[32:35], v[20:23], v[148:163]
    v_mfma_f32_32x32x16_bf16 v[164:179], v[32:35], v[24:27], v[164:179]
    s_waitcnt lgkmcnt(0)
    s_waitcnt vmcnt(6)
    s_barrier
    ds_read_b128 v[20:23], v220 offset:0
    ds_read_b128 v[24:27], v220 offset:4096
    ds_read_b64_tr_b16 v[28:29], v224 offset:0
    ds_read_b64_tr_b16 v[30:31], v224 offset:1024
    ds_read_b64_tr_b16 v[32:33], v225 offset:0
    ds_read_b64_tr_b16 v[34:35], v225 offset:1024
    v_mfma_f32_32x32x16_bf16 v[116:131], v[44:47], v[36:39], v[116:131]
    s_add_u32 m0, s33, 98304
    s_add_u32 s34, s24, 384
    buffer_load_dwordx4 v16, s[4:7], s34 offen lds
    v_mfma_f32_32x32x16_bf16 v[132:147], v[44:47], v[40:43], v[132:147]
    s_add_u32 m0, s33, 106496
    s_add_u32 s34, s24, 65920
    buffer_load_dwordx4 v16, s[4:7], s34 offen lds
    v_mfma_f32_32x32x16_bf16 v[148:163], v[48:51], v[36:39], v[148:163]
    s_add_u32 m0, s33, 114688
    s_add_u32 s34, s24, 131456
    buffer_load_dwordx4 v16, s[4:7], s34 offen lds
    v_mfma_f32_32x32x16_bf16 v[164:179], v[48:51], v[40:43], v[164:179]
    s_add_u32 m0, s33, 122880
    s_add_u32 s34, s24, 196992
    buffer_load_dwordx4 v16, s[4:7], s34 offen lds
    s_add_u32 s54, s84, 0
    v_cvt_pk_bf16_f32 v240, v52, v53
    v_cvt_pk_bf16_f32 v241, v54, v55
    v_cvt_pk_bf16_f32 v242, v56, v57
    v_cvt_pk_bf16_f32 v243, v58, v59
    buffer_store_dwordx4 v[240:243], v238, s[16:19], s54 offen offset:0
    v_cvt_pk_bf16_f32 v244, v60, v61
    v_cvt_pk_bf16_f32 v245, v62, v63
    v_cvt_pk_bf16_f32 v246, v64, v65
    v_cvt_pk_bf16_f32 v247, v66, v67
    buffer_store_dwordx4 v[244:247], v238, s[16:19], s54 offen offset:1024
    s_waitcnt lgkmcnt(0)
    ds_read_b128 v[36:39], v221 offset:0
    ds_read_b128 v[40:43], v221 offset:4096
    ds_read_b64_tr_b16 v[44:45], v224 offset:4096
    ds_read_b64_tr_b16 v[46:47], v224 offset:5120
    ds_read_b64_tr_b16 v[48:49], v225 offset:4096
    ds_read_b64_tr_b16 v[50:51], v225 offset:5120
    v_mfma_f32_32x32x16_bf16 v[116:131], v[28:31], v[20:23], v[116:131]
    s_add_u32 m0, s33, 131072
    s_add_u32 s34, s25, 1573120
    buffer_load_dwordx4 v17, s[8:11], s34 offen lds
    v_mfma_f32_32x32x16_bf16 v[132:147], v[28:31], v[24:27], v[132:147]
    s_add_u32 m0, s33, 139264
    s_add_u32 s34, s25, 1835264
    buffer_load_dwordx4 v17, s[8:11], s34 offen lds
    v_mfma_f32_32x32x16_bf16 v[148:163], v[32:35], v[20:23], v[148:163]
    v_mfma_f32_32x32x16_bf16 v[164:179], v[32:35], v[24:27], v[164:179]
    s_waitcnt lgkmcnt(0)
    ds_read_b128 v[20:23], v222 offset:0
    ds_read_b128 v[24:27], v222 offset:4096
    ds_read_b64_tr_b16 v[28:29], v224 offset:8192
    ds_read_b64_tr_b16 v[30:31], v224 offset:9216
    ds_read_b64_tr_b16 v[32:33], v225 offset:8192
    ds_read_b64_tr_b16 v[34:35], v225 offset:9216
    v_mfma_f32_32x32x16_bf16 v[116:131], v[44:47], v[36:39], v[116:131]
    v_mfma_f32_32x32x16_bf16 v[132:147], v[44:47], v[40:43], v[132:147]
    v_mfma_f32_32x32x16_bf16 v[148:163], v[48:51], v[36:39], v[148:163]
    v_mfma_f32_32x32x16_bf16 v[164:179], v[48:51], v[40:43], v[164:179]
    s_waitcnt lgkmcnt(0)
    ds_read_b128 v[36:39], v223 offset:0
    ds_read_b128 v[40:43], v223 offset:4096
    ds_read_b64_tr_b16 v[44:45], v224 offset:12288
    ds_read_b64_tr_b16 v[46:47], v224 offset:13312
    ds_read_b64_tr_b16 v[48:49], v225 offset:12288
    ds_read_b64_tr_b16 v[50:51], v225 offset:13312
    v_mfma_f32_32x32x16_bf16 v[116:131], v[28:31], v[20:23], v[116:131]
    v_mfma_f32_32x32x16_bf16 v[132:147], v[28:31], v[24:27], v[132:147]
    v_mfma_f32_32x32x16_bf16 v[148:163], v[32:35], v[20:23], v[148:163]
    v_mfma_f32_32x32x16_bf16 v[164:179], v[32:35], v[24:27], v[164:179]
    s_waitcnt lgkmcnt(0)
    s_waitcnt vmcnt(6)
    s_barrier
    ds_read_b128 v[20:23], v220 offset:49152
    ds_read_b128 v[24:27], v220 offset:53248
    ds_read_b64_tr_b16 v[28:29], v224 offset:49152
    ds_read_b64_tr_b16 v[30:31], v224 offset:50176
    ds_read_b64_tr_b16 v[32:33], v225 offset:49152
    ds_read_b64_tr_b16 v[34:35], v225 offset:50176
    v_mfma_f32_32x32x16_bf16 v[116:131], v[44:47], v[36:39], v[116:131]
    s_add_u32 m0, s33, 0
    s_add_u32 s34, s24, 512
    buffer_load_dwordx4 v16, s[4:7], s34 offen lds
    v_mfma_f32_32x32x16_bf16 v[132:147], v[44:47], v[40:43], v[132:147]
    s_add_u32 m0, s33, 8192
    s_add_u32 s34, s24, 66048
    buffer_load_dwordx4 v16, s[4:7], s34 offen lds
    v_mfma_f32_32x32x16_bf16 v[148:163], v[48:51], v[36:39], v[148:163]
    s_add_u32 m0, s33, 16384
    s_add_u32 s34, s24, 131584
    buffer_load_dwordx4 v16, s[4:7], s34 offen lds
    v_mfma_f32_32x32x16_bf16 v[164:179], v[48:51], v[40:43], v[164:179]
    s_add_u32 m0, s33, 24576
    s_add_u32 s34, s24, 197120
    buffer_load_dwordx4 v16, s[4:7], s34 offen lds
    s_add_u32 s54, s84, 0
    v_cvt_pk_bf16_f32 v248, v84, v85
    v_cvt_pk_bf16_f32 v249, v86, v87
    v_cvt_pk_bf16_f32 v250, v88, v89
    v_cvt_pk_bf16_f32 v251, v90, v91
    buffer_store_dwordx4 v[248:251], v238, s[16:19], s54 offen offset:2048
    v_cvt_pk_bf16_f32 v252, v92, v93
    v_cvt_pk_bf16_f32 v253, v94, v95
    v_cvt_pk_bf16_f32 v254, v96, v97
    v_cvt_pk_bf16_f32 v255, v98, v99
    buffer_store_dwordx4 v[252:255], v238, s[16:19], s54 offen offset:3072
    s_waitcnt lgkmcnt(0)
    ds_read_b128 v[36:39], v221 offset:49152
    ds_read_b128 v[40:43], v221 offset:53248
    ds_read_b64_tr_b16 v[44:45], v224 offset:53248
    ds_read_b64_tr_b16 v[46:47], v224 offset:54272
    ds_read_b64_tr_b16 v[48:49], v225 offset:53248
    ds_read_b64_tr_b16 v[50:51], v225 offset:54272
    v_mfma_f32_32x32x16_bf16 v[116:131], v[28:31], v[20:23], v[116:131]
    s_add_u32 m0, s33, 32768
    s_add_u32 s34, s25, 2097408
    buffer_load_dwordx4 v17, s[8:11], s34 offen lds
    v_mfma_f32_32x32x16_bf16 v[132:147], v[28:31], v[24:27], v[132:147]
    s_add_u32 m0, s33, 40960
    s_add_u32 s34, s25, 2359552
    buffer_load_dwordx4 v17, s[8:11], s34 offen lds
    v_mfma_f32_32x32x16_bf16 v[148:163], v[32:35], v[20:23], v[148:163]
    v_mfma_f32_32x32x16_bf16 v[164:179], v[32:35], v[24:27], v[164:179]
    s_waitcnt lgkmcnt(0)
    ds_read_b128 v[20:23], v222 offset:49152
    ds_read_b128 v[24:27], v222 offset:53248
    ds_read_b64_tr_b16 v[28:29], v224 offset:57344
    ds_read_b64_tr_b16 v[30:31], v224 offset:58368
    ds_read_b64_tr_b16 v[32:33], v225 offset:57344
    ds_read_b64_tr_b16 v[34:35], v225 offset:58368
    v_mfma_f32_32x32x16_bf16 v[116:131], v[44:47], v[36:39], v[116:131]
    v_mfma_f32_32x32x16_bf16 v[132:147], v[44:47], v[40:43], v[132:147]
    v_mfma_f32_32x32x16_bf16 v[148:163], v[48:51], v[36:39], v[148:163]
    v_mfma_f32_32x32x16_bf16 v[164:179], v[48:51], v[40:43], v[164:179]
    s_waitcnt lgkmcnt(0)
    ds_read_b128 v[36:39], v223 offset:49152
    ds_read_b128 v[40:43], v223 offset:53248
    ds_read_b64_tr_b16 v[44:45], v224 offset:61440
    ds_read_b64_tr_b16 v[46:47], v224 offset:62464
    ds_read_b64_tr_b16 v[48:49], v225 offset:61440
    ds_read_b64_tr_b16 v[50:51], v225 offset:62464
    v_mfma_f32_32x32x16_bf16 v[116:131], v[28:31], v[20:23], v[116:131]
    v_mfma_f32_32x32x16_bf16 v[132:147], v[28:31], v[24:27], v[132:147]
    v_mfma_f32_32x32x16_bf16 v[148:163], v[32:35], v[20:23], v[148:163]
    v_mfma_f32_32x32x16_bf16 v[164:179], v[32:35], v[24:27], v[164:179]
    s_waitcnt lgkmcnt(0)
    s_waitcnt vmcnt(6)
    s_barrier
    ds_read_b128 v[20:23], v226 offset:32768
    ds_read_b128 v[24:27], v226 offset:36864
    ds_read_b64_tr_b16 v[28:29], v234 offset:32768
    ds_read_b64_tr_b16 v[30:31], v234 offset:33792
    ds_read_b64_tr_b16 v[32:33], v235 offset:32768
    ds_read_b64_tr_b16 v[34:35], v235 offset:33792
    v_mfma_f32_32x32x16_bf16 v[116:131], v[44:47], v[36:39], v[116:131]
    s_add_u32 m0, s33, 49152
    s_add_u32 s34, s24, 640
    buffer_load_dwordx4 v16, s[4:7], s34 offen lds
    v_mfma_f32_32x32x16_bf16 v[132:147], v[44:47], v[40:43], v[132:147]
    s_add_u32 m0, s33, 57344
    s_add_u32 s34, s24, 66176
    buffer_load_dwordx4 v16, s[4:7], s34 offen lds
    v_mfma_f32_32x32x16_bf16 v[148:163], v[48:51], v[36:39], v[148:163]
    s_add_u32 m0, s33, 65536
    s_add_u32 s34, s24, 131712
    buffer_load_dwordx4 v16, s[4:7], s34 offen lds
    v_mfma_f32_32x32x16_bf16 v[164:179], v[48:51], v[40:43], v[164:179]
    s_add_u32 m0, s33, 73728
    s_add_u32 s34, s24, 197248
    buffer_load_dwordx4 v16, s[4:7], s34 offen lds
    s_add_u32 s54, s84, 8192
    v_cvt_pk_bf16_f32 v240, v68, v69
    v_cvt_pk_bf16_f32 v241, v70, v71
    v_cvt_pk_bf16_f32 v242, v72, v73
    v_cvt_pk_bf16_f32 v243, v74, v75
    buffer_store_dwordx4 v[240:243], v238, s[16:19], s54 offen offset:0
    v_cvt_pk_bf16_f32 v244, v76, v77
    v_cvt_pk_bf16_f32 v245, v78, v79
    v_cvt_pk_bf16_f32 v246, v80, v81
    v_cvt_pk_bf16_f32 v247, v82, v83
    buffer_store_dwordx4 v[244:247], v238, s[16:19], s54 offen offset:1024
    s_waitcnt lgkmcnt(0)
    ds_read_b128 v[36:39], v227 offset:32768
    ds_read_b128 v[40:43], v227 offset:36864
    ds_read_b64_tr_b16 v[44:45], v234 offset:36864
    ds_read_b64_tr_b16 v[46:47], v234 offset:37888
    ds_read_b64_tr_b16 v[48:49], v235 offset:36864
    ds_read_b64_tr_b16 v[50:51], v235 offset:37888
    v_mfma_f32_32x32x16_bf16 v[116:131], v[28:31], v[20:23], v[116:131]
    s_add_u32 m0, s33, 81920
    s_add_u32 s34, s25, 2621696
    buffer_load_dwordx4 v17, s[8:11], s34 offen lds
    v_mfma_f32_32x32x16_bf16 v[132:147], v[28:31], v[24:27], v[132:147]
    s_add_u32 m0, s33, 90112
    s_add_u32 s34, s25, 2883840
    buffer_load_dwordx4 v17, s[8:11], s34 offen lds
    v_mfma_f32_32x32x16_bf16 v[148:163], v[32:35], v[20:23], v[148:163]
    v_mfma_f32_32x32x16_bf16 v[164:179], v[32:35], v[24:27], v[164:179]
    s_waitcnt lgkmcnt(0)
    ds_read_b128 v[20:23], v228 offset:32768
    ds_read_b128 v[24:27], v228 offset:36864
    ds_read_b64_tr_b16 v[28:29], v234 offset:40960
    ds_read_b64_tr_b16 v[30:31], v234 offset:41984
    ds_read_b64_tr_b16 v[32:33], v235 offset:40960
    ds_read_b64_tr_b16 v[34:35], v235 offset:41984
    v_mfma_f32_32x32x16_bf16 v[116:131], v[44:47], v[36:39], v[116:131]
    v_mfma_f32_32x32x16_bf16 v[132:147], v[44:47], v[40:43], v[132:147]
    v_mfma_f32_32x32x16_bf16 v[148:163], v[48:51], v[36:39], v[148:163]
    v_mfma_f32_32x32x16_bf16 v[164:179], v[48:51], v[40:43], v[164:179]
    s_waitcnt lgkmcnt(0)
    ds_read_b128 v[36:39], v229 offset:32768
    ds_read_b128 v[40:43], v229 offset:36864
    ds_read_b64_tr_b16 v[44:45], v234 offset:45056
    ds_read_b64_tr_b16 v[46:47], v234 offset:46080
    ds_read_b64_tr_b16 v[48:49], v235 offset:45056
    ds_read_b64_tr_b16 v[50:51], v235 offset:46080
    v_mfma_f32_32x32x16_bf16 v[116:131], v[28:31], v[20:23], v[116:131]
    v_mfma_f32_32x32x16_bf16 v[132:147], v[28:31], v[24:27], v[132:147]
    v_mfma_f32_32x32x16_bf16 v[148:163], v[32:35], v[20:23], v[148:163]
    v_mfma_f32_32x32x16_bf16 v[164:179], v[32:35], v[24:27], v[164:179]
    s_waitcnt lgkmcnt(0)
    s_waitcnt vmcnt(6)
    s_barrier
    ds_read_b128 v[20:23], v220 offset:0
    ds_read_b128 v[24:27], v220 offset:4096
    ds_read_b64_tr_b16 v[28:29], v224 offset:0
    ds_read_b64_tr_b16 v[30:31], v224 offset:1024
    ds_read_b64_tr_b16 v[32:33], v225 offset:0
    ds_read_b64_tr_b16 v[34:35], v225 offset:1024
    v_mfma_f32_32x32x16_bf16 v[116:131], v[44:47], v[36:39], v[116:131]
    s_add_u32 m0, s33, 98304
    s_add_u32 s34, s24, 768
    buffer_load_dwordx4 v16, s[4:7], s34 offen lds
    v_mfma_f32_32x32x16_bf16 v[132:147], v[44:47], v[40:43], v[132:147]
    s_add_u32 m0, s33, 106496
    s_add_u32 s34, s24, 66304
    buffer_load_dwordx4 v16, s[4:7], s34 offen lds
    v_mfma_f32_32x32x16_bf16 v[148:163], v[48:51], v[36:39], v[148:163]
    s_add_u32 m0, s33, 114688
    s_add_u32 s34, s24, 131840
    buffer_load_dwordx4 v16, s[4:7], s34 offen lds
    v_mfma_f32_32x32x16_bf16 v[164:179], v[48:51], v[40:43], v[164:179]
    s_add_u32 m0, s33, 122880
    s_add_u32 s34, s24, 197376
    buffer_load_dwordx4 v16, s[4:7], s34 offen lds
    s_add_u32 s54, s84, 8192
    v_cvt_pk_bf16_f32 v248, v100, v101
    v_cvt_pk_bf16_f32 v249, v102, v103
    v_cvt_pk_bf16_f32 v250, v104, v105
    v_cvt_pk_bf16_f32 v251, v106, v107
    buffer_store_dwordx4 v[248:251], v238, s[16:19], s54 offen offset:2048
    v_cvt_pk_bf16_f32 v252, v108, v109
    v_cvt_pk_bf16_f32 v253, v110, v111
    v_cvt_pk_bf16_f32 v254, v112, v113
    v_cvt_pk_bf16_f32 v255, v114, v115
    buffer_store_dwordx4 v[252:255], v238, s[16:19], s54 offen offset:3072
    s_waitcnt lgkmcnt(0)
    ds_read_b128 v[36:39], v221 offset:0
    ds_read_b128 v[40:43], v221 offset:4096
    ds_read_b64_tr_b16 v[44:45], v224 offset:4096
    ds_read_b64_tr_b16 v[46:47], v224 offset:5120
    ds_read_b64_tr_b16 v[48:49], v225 offset:4096
    ds_read_b64_tr_b16 v[50:51], v225 offset:5120
    v_mfma_f32_32x32x16_bf16 v[116:131], v[28:31], v[20:23], v[116:131]
    s_add_u32 m0, s33, 131072
    s_add_u32 s34, s25, 3145984
    buffer_load_dwordx4 v17, s[8:11], s34 offen lds
    v_mfma_f32_32x32x16_bf16 v[132:147], v[28:31], v[24:27], v[132:147]
    s_add_u32 m0, s33, 139264
    s_add_u32 s34, s25, 3408128
    buffer_load_dwordx4 v17, s[8:11], s34 offen lds
    v_mfma_f32_32x32x16_bf16 v[148:163], v[32:35], v[20:23], v[148:163]
    v_mfma_f32_32x32x16_bf16 v[164:179], v[32:35], v[24:27], v[164:179]
    s_waitcnt lgkmcnt(0)
    ds_read_b128 v[20:23], v222 offset:0
    ds_read_b128 v[24:27], v222 offset:4096
    ds_read_b64_tr_b16 v[28:29], v224 offset:8192
    ds_read_b64_tr_b16 v[30:31], v224 offset:9216
    ds_read_b64_tr_b16 v[32:33], v225 offset:8192
    ds_read_b64_tr_b16 v[34:35], v225 offset:9216
    v_mfma_f32_32x32x16_bf16 v[116:131], v[44:47], v[36:39], v[116:131]
    v_mfma_f32_32x32x16_bf16 v[132:147], v[44:47], v[40:43], v[132:147]
    v_mfma_f32_32x32x16_bf16 v[148:163], v[48:51], v[36:39], v[148:163]
    v_mfma_f32_32x32x16_bf16 v[164:179], v[48:51], v[40:43], v[164:179]
    s_waitcnt lgkmcnt(0)
    ds_read_b128 v[36:39], v223 offset:0
    ds_read_b128 v[40:43], v223 offset:4096
    ds_read_b64_tr_b16 v[44:45], v224 offset:12288
    ds_read_b64_tr_b16 v[46:47], v224 offset:13312
    ds_read_b64_tr_b16 v[48:49], v225 offset:12288
    ds_read_b64_tr_b16 v[50:51], v225 offset:13312
    v_mfma_f32_32x32x16_bf16 v[116:131], v[28:31], v[20:23], v[116:131]
    v_mfma_f32_32x32x16_bf16 v[132:147], v[28:31], v[24:27], v[132:147]
    v_mfma_f32_32x32x16_bf16 v[148:163], v[32:35], v[20:23], v[148:163]
    v_mfma_f32_32x32x16_bf16 v[164:179], v[32:35], v[24:27], v[164:179]
    s_waitcnt lgkmcnt(0)
    s_waitcnt vmcnt(6)
    s_barrier
    ds_read_b128 v[20:23], v220 offset:49152
    ds_read_b128 v[24:27], v220 offset:53248
    ds_read_b64_tr_b16 v[28:29], v224 offset:49152
    ds_read_b64_tr_b16 v[30:31], v224 offset:50176
    ds_read_b64_tr_b16 v[32:33], v225 offset:49152
    ds_read_b64_tr_b16 v[34:35], v225 offset:50176
    v_mfma_f32_32x32x16_bf16 v[116:131], v[44:47], v[36:39], v[116:131]
    s_add_u32 m0, s33, 0
    s_add_u32 s34, s24, 896
    buffer_load_dwordx4 v16, s[4:7], s34 offen lds
    v_mfma_f32_32x32x16_bf16 v[132:147], v[44:47], v[40:43], v[132:147]
    s_add_u32 m0, s33, 8192
    s_add_u32 s34, s24, 66432
    buffer_load_dwordx4 v16, s[4:7], s34 offen lds
    v_mfma_f32_32x32x16_bf16 v[148:163], v[48:51], v[36:39], v[148:163]
    s_add_u32 m0, s33, 16384
    s_add_u32 s34, s24, 131968
    buffer_load_dwordx4 v16, s[4:7], s34 offen lds
    v_mfma_f32_32x32x16_bf16 v[164:179], v[48:51], v[40:43], v[164:179]
    s_add_u32 m0, s33, 24576
    s_add_u32 s34, s24, 197504
    buffer_load_dwordx4 v16, s[4:7], s34 offen lds
    s_waitcnt lgkmcnt(0)
    ds_read_b128 v[36:39], v221 offset:49152
    ds_read_b128 v[40:43], v221 offset:53248
    ds_read_b64_tr_b16 v[44:45], v224 offset:53248
    ds_read_b64_tr_b16 v[46:47], v224 offset:54272
    ds_read_b64_tr_b16 v[48:49], v225 offset:53248
    ds_read_b64_tr_b16 v[50:51], v225 offset:54272
    v_mfma_f32_32x32x16_bf16 v[116:131], v[28:31], v[20:23], v[116:131]
    s_add_u32 m0, s33, 32768
    s_add_u32 s34, s25, 3670272
    buffer_load_dwordx4 v17, s[8:11], s34 offen lds
    v_mfma_f32_32x32x16_bf16 v[132:147], v[28:31], v[24:27], v[132:147]
    s_add_u32 m0, s33, 40960
    s_add_u32 s34, s25, 3932416
    buffer_load_dwordx4 v17, s[8:11], s34 offen lds
    v_mfma_f32_32x32x16_bf16 v[148:163], v[32:35], v[20:23], v[148:163]
    v_mfma_f32_32x32x16_bf16 v[164:179], v[32:35], v[24:27], v[164:179]
    s_waitcnt lgkmcnt(0)
    ds_read_b128 v[20:23], v222 offset:49152
    ds_read_b128 v[24:27], v222 offset:53248
    ds_read_b64_tr_b16 v[28:29], v224 offset:57344
    ds_read_b64_tr_b16 v[30:31], v224 offset:58368
    ds_read_b64_tr_b16 v[32:33], v225 offset:57344
    ds_read_b64_tr_b16 v[34:35], v225 offset:58368
    v_mfma_f32_32x32x16_bf16 v[116:131], v[44:47], v[36:39], v[116:131]
    v_mfma_f32_32x32x16_bf16 v[132:147], v[44:47], v[40:43], v[132:147]
    v_mfma_f32_32x32x16_bf16 v[148:163], v[48:51], v[36:39], v[148:163]
    v_mfma_f32_32x32x16_bf16 v[164:179], v[48:51], v[40:43], v[164:179]
    v_mov_b32 v182, 0
    buffer_load_dword v183, v182, s[92:95], 0 offen sc0 sc1
    s_waitcnt lgkmcnt(0)
    ds_read_b128 v[36:39], v223 offset:49152
    ds_read_b128 v[40:43], v223 offset:53248
    ds_read_b64_tr_b16 v[44:45], v224 offset:61440
    ds_read_b64_tr_b16 v[46:47], v224 offset:62464
    ds_read_b64_tr_b16 v[48:49], v225 offset:61440
    ds_read_b64_tr_b16 v[50:51], v225 offset:62464
    v_mfma_f32_32x32x16_bf16 v[116:131], v[28:31], v[20:23], v[116:131]
    v_mfma_f32_32x32x16_bf16 v[132:147], v[28:31], v[24:27], v[132:147]
    v_mfma_f32_32x32x16_bf16 v[148:163], v[32:35], v[20:23], v[148:163]
    v_mfma_f32_32x32x16_bf16 v[164:179], v[32:35], v[24:27], v[164:179]
    s_waitcnt lgkmcnt(0)
    s_waitcnt vmcnt(7)
    s_barrier
    ds_read_b128 v[20:23], v226 offset:32768
    ds_read_b128 v[24:27], v226 offset:36864
    ds_read_b64_tr_b16 v[28:29], v234 offset:32768
    ds_read_b64_tr_b16 v[30:31], v234 offset:33792
    ds_read_b64_tr_b16 v[32:33], v235 offset:32768
    ds_read_b64_tr_b16 v[34:35], v235 offset:33792
    v_mfma_f32_32x32x16_bf16 v[116:131], v[44:47], v[36:39], v[116:131]
    v_mfma_f32_32x32x16_bf16 v[132:147], v[44:47], v[40:43], v[132:147]
    v_mfma_f32_32x32x16_bf16 v[148:163], v[48:51], v[36:39], v[148:163]
    v_mfma_f32_32x32x16_bf16 v[164:179], v[48:51], v[40:43], v[164:179]
    s_waitcnt lgkmcnt(0)
    ds_read_b128 v[36:39], v227 offset:32768
    ds_read_b128 v[40:43], v227 offset:36864
    ds_read_b64_tr_b16 v[44:45], v234 offset:36864
    ds_read_b64_tr_b16 v[46:47], v234 offset:37888
    ds_read_b64_tr_b16 v[48:49], v235 offset:36864
    ds_read_b64_tr_b16 v[50:51], v235 offset:37888
    v_mfma_f32_32x32x16_bf16 v[116:131], v[28:31], v[20:23], v[116:131]
    v_mfma_f32_32x32x16_bf16 v[132:147], v[28:31], v[24:27], v[132:147]
    v_mfma_f32_32x32x16_bf16 v[148:163], v[32:35], v[20:23], v[148:163]
    v_mfma_f32_32x32x16_bf16 v[164:179], v[32:35], v[24:27], v[164:179]
    s_waitcnt lgkmcnt(0)
    ds_read_b128 v[20:23], v228 offset:32768
    ds_read_b128 v[24:27], v228 offset:36864
    ds_read_b64_tr_b16 v[28:29], v234 offset:40960
    ds_read_b64_tr_b16 v[30:31], v234 offset:41984
    ds_read_b64_tr_b16 v[32:33], v235 offset:40960
    ds_read_b64_tr_b16 v[34:35], v235 offset:41984
    v_mfma_f32_32x32x16_bf16 v[116:131], v[44:47], v[36:39], v[116:131]
    v_mfma_f32_32x32x16_bf16 v[132:147], v[44:47], v[40:43], v[132:147]
    v_mfma_f32_32x32x16_bf16 v[148:163], v[48:51], v[36:39], v[148:163]
    v_mfma_f32_32x32x16_bf16 v[164:179], v[48:51], v[40:43], v[164:179]
    s_waitcnt lgkmcnt(0)
    ds_read_b128 v[36:39], v229 offset:32768
    ds_read_b128 v[40:43], v229 offset:36864
    ds_read_b64_tr_b16 v[44:45], v234 offset:45056
    ds_read_b64_tr_b16 v[46:47], v234 offset:46080
    ds_read_b64_tr_b16 v[48:49], v235 offset:45056
    ds_read_b64_tr_b16 v[50:51], v235 offset:46080
    v_mfma_f32_32x32x16_bf16 v[116:131], v[28:31], v[20:23], v[116:131]
    v_mfma_f32_32x32x16_bf16 v[132:147], v[28:31], v[24:27], v[132:147]
    v_mfma_f32_32x32x16_bf16 v[148:163], v[32:35], v[20:23], v[148:163]
    v_mfma_f32_32x32x16_bf16 v[164:179], v[32:35], v[24:27], v[164:179]
    s_waitcnt lgkmcnt(0)
    s_waitcnt vmcnt(1)
    s_barrier
    ds_read_b128 v[20:23], v220 offset:0
    ds_read_b128 v[24:27], v220 offset:4096
    ds_read_b64_tr_b16 v[28:29], v224 offset:0
    ds_read_b64_tr_b16 v[30:31], v224 offset:1024
    ds_read_b64_tr_b16 v[32:33], v225 offset:0
    ds_read_b64_tr_b16 v[34:35], v225 offset:1024
    v_mfma_f32_32x32x16_bf16 v[116:131], v[44:47], v[36:39], v[116:131]
    v_mfma_f32_32x32x16_bf16 v[132:147], v[44:47], v[40:43], v[132:147]
    v_mfma_f32_32x32x16_bf16 v[148:163], v[48:51], v[36:39], v[148:163]
    v_mfma_f32_32x32x16_bf16 v[164:179], v[48:51], v[40:43], v[164:179]
    s_waitcnt lgkmcnt(0)
    ds_read_b128 v[36:39], v221 offset:0
    ds_read_b128 v[40:43], v221 offset:4096
    ds_read_b64_tr_b16 v[44:45], v224 offset:4096
    ds_read_b64_tr_b16 v[46:47], v224 offset:5120
    ds_read_b64_tr_b16 v[48:49], v225 offset:4096
    ds_read_b64_tr_b16 v[50:51], v225 offset:5120
    v_mfma_f32_32x32x16_bf16 v[116:131], v[28:31], v[20:23], v[116:131]
    v_mfma_f32_32x32x16_bf16 v[132:147], v[28:31], v[24:27], v[132:147]
    v_mfma_f32_32x32x16_bf16 v[148:163], v[32:35], v[20:23], v[148:163]
    v_mfma_f32_32x32x16_bf16 v[164:179], v[32:35], v[24:27], v[164:179]
    s_waitcnt lgkmcnt(0)
    ds_read_b128 v[20:23], v222 offset:0
    ds_read_b128 v[24:27], v222 offset:4096
    ds_read_b64_tr_b16 v[28:29], v224 offset:8192
    ds_read_b64_tr_b16 v[30:31], v224 offset:9216
    ds_read_b64_tr_b16 v[32:33], v225 offset:8192
    ds_read_b64_tr_b16 v[34:35], v225 offset:9216
    v_mfma_f32_32x32x16_bf16 v[116:131], v[44:47], v[36:39], v[116:131]
    v_mfma_f32_32x32x16_bf16 v[132:147], v[44:47], v[40:43], v[132:147]
    v_mfma_f32_32x32x16_bf16 v[148:163], v[48:51], v[36:39], v[148:163]
    v_mfma_f32_32x32x16_bf16 v[164:179], v[48:51], v[40:43], v[164:179]
    s_movk_i32 s71, 0x2000
    s_waitcnt vmcnt(0)
.lp_5:
    v_readfirstlane_b32 s70, v183
    s_nop 3
    s_cmp_ge_u32 s70, 64
    s_cbranch_scc1 .ok_4
    s_sleep 4
    buffer_load_dword v183, v182, s[92:95], 0 offen sc0 sc1
    s_waitcnt vmcnt(0)
    s_sub_u32 s71, s71, 1
    s_cmp_lg_u32 s71, 0
    s_cbranch_scc1 .lp_5
    v_mov_b32 v200, 0
    v_mov_b32 v201, 0
    v_mov_b32 v202, 0
    v_mov_b32 v203, 0
    v_mov_b32 v204, 0
    v_mov_b32 v205, 0
    v_mov_b32 v206, 0
    v_mov_b32 v207, 0
    v_mov_b32 v208, 0
    v_mov_b32 v209, 0
    v_mov_b32 v210, 0
    v_mov_b32 v211, 0
    v_mov_b32 v212, 0
    v_mov_b32 v213, 0
    v_mov_b32 v214, 0
    v_mov_b32 v215, 0
    s_mov_b32 s70, 0
    s_mov_b32 s71, 0
.fl_7:
    buffer_load_ushort v196, v182, s[72:75], s70 offen
    buffer_load_dwordx4 v[216:219], v180, s[76:79], s71 offen offset:0
    s_waitcnt vmcnt(0)
    v_lshlrev_b32 v196, 16, v196
    v_mul_f32 v197, 0xbfb8aa3b, v196
    v_exp_f32 v197, v197
    s_nop 0
    v_add_f32 v197, 1.0, v197
    v_rcp_f32 v197, v197
    s_nop 0
    v_mul_f32 v197, v197, v196
    v_cvt_pk_bf16_f32 v196, v197, v197
    v_lshlrev_b32 v196, 16, v196
    v_lshlrev_b32 v197, 16, v216
    v_and_b32 v198, 0xffff0000, v216
    v_fmac_f32 v208, v197, v196
    v_fmac_f32 v209, v198, v196
    v_lshlrev_b32 v197, 16, v217
    v_and_b32 v198, 0xffff0000, v217
    v_fmac_f32 v210, v197, v196
    v_fmac_f32 v211, v198, v196
    v_lshlrev_b32 v197, 16, v218
    v_and_b32 v198, 0xffff0000, v218
    v_fmac_f32 v212, v197, v196
    v_fmac_f32 v213, v198, v196
    v_lshlrev_b32 v197, 16, v219
    v_and_b32 v198, 0xffff0000, v219
    v_fmac_f32 v214, v197, v196
    v_fmac_f32 v215, v198, v196
    buffer_load_dwordx4 v[216:219], v180, s[76:79], s71 offen offset:1024
    s_waitcnt vmcnt(0)
    v_lshlrev_b32 v197, 16, v216
    v_and_b32 v198, 0xffff0000, v216
    v_fmac_f32 v200, v197, v196
    v_fmac_f32 v201, v198, v196
    v_lshlrev_b32 v197, 16, v217
    v_and_b32 v198, 0xffff0000, v217
    v_fmac_f32 v202, v197, v196
    v_fmac_f32 v203, v198, v196
    v_lshlrev_b32 v197, 16, v218
    v_and_b32 v198, 0xffff0000, v218
    v_fmac_f32 v204, v197, v196
    v_fmac_f32 v205, v198, v196
    v_lshlrev_b32 v197, 16, v219
    v_and_b32 v198, 0xffff0000, v219
    v_fmac_f32 v206, v197, v196
    v_fmac_f32 v207, v198, v196
    s_add_u32 s70, s70, 2
    s_add_u32 s71, s71, 6144
    s_cmp_lt_u32 s70, 1024
    s_cbranch_scc1 .fl_7
    v_cvt_pk_bf16_f32 v200, v200, v200
    v_lshlrev_b32 v200, 16, v200
    v_cvt_pk_bf16_f32 v201, v201, v201
    v_lshlrev_b32 v201, 16, v201
    v_cvt_pk_bf16_f32 v202, v202, v202
    v_lshlrev_b32 v202, 16, v202
    v_cvt_pk_bf16_f32 v203, v203, v203
    v_lshlrev_b32 v203, 16, v203
    v_cvt_pk_bf16_f32 v204, v204, v204
    v_lshlrev_b32 v204, 16, v204
    v_cvt_pk_bf16_f32 v205, v205, v205
    v_lshlrev_b32 v205, 16, v205
    v_cvt_pk_bf16_f32 v206, v206, v206
    v_lshlrev_b32 v206, 16, v206
    v_cvt_pk_bf16_f32 v207, v207, v207
    v_lshlrev_b32 v207, 16, v207
    v_cvt_pk_bf16_f32 v208, v208, v208
    v_lshlrev_b32 v208, 16, v208
    v_cvt_pk_bf16_f32 v209, v209, v209
    v_lshlrev_b32 v209, 16, v209
    v_cvt_pk_bf16_f32 v210, v210, v210
    v_lshlrev_b32 v210, 16, v210
    v_cvt_pk_bf16_f32 v211, v211, v211
    v_lshlrev_b32 v211, 16, v211
    v_cvt_pk_bf16_f32 v212, v212, v212
    v_lshlrev_b32 v212, 16, v212
    v_cvt_pk_bf16_f32 v213, v213, v213
    v_lshlrev_b32 v213, 16, v213
    v_cvt_pk_bf16_f32 v214, v214, v214
    v_lshlrev_b32 v214, 16, v214
    v_cvt_pk_bf16_f32 v215, v215, v215
    v_lshlrev_b32 v215, 16, v215
    v_add_f32 v200, 1.0, v200
    v_cvt_pk_bf16_f32 v200, v200, v200
    v_lshlrev_b32 v200, 16, v200
    v_add_f32 v201, 1.0, v201
    v_cvt_pk_bf16_f32 v201, v201, v201
    v_lshlrev_b32 v201, 16, v201
    v_add_f32 v202, 1.0, v202
    v_cvt_pk_bf16_f32 v202, v202, v202
    v_lshlrev_b32 v202, 16, v202
    v_add_f32 v203, 1.0, v203
    v_cvt_pk_bf16_f32 v203, v203, v203
    v_lshlrev_b32 v203, 16, v203
    v_add_f32 v204, 1.0, v204
    v_cvt_pk_bf16_f32 v204, v204, v204
    v_lshlrev_b32 v204, 16, v204
    v_add_f32 v205, 1.0, v205
    v_cvt_pk_bf16_f32 v205, v205, v205
    v_lshlrev_b32 v205, 16, v205
    v_add_f32 v206, 1.0, v206
    v_cvt_pk_bf16_f32 v206, v206, v206
    v_lshlrev_b32 v206, 16, v206
    v_add_f32 v207, 1.0, v207
    v_cvt_pk_bf16_f32 v207, v207, v207
    v_lshlrev_b32 v207, 16, v207
    s_branch .dn_6
.ok_4:
    buffer_load_dwordx4 v[200:203], v181, s[60:63], 0 offen offset:2048 sc0 sc1
    buffer_load_dwordx4 v[204:207], v181, s[60:63], 0 offen offset:2064 sc0 sc1
    buffer_load_dwordx4 v[208:211], v181, s[60:63], 0 offen sc0 sc1
    buffer_load_dwordx4 v[212:215], v181, s[60:63], 0 offen offset:16 sc0 sc1
.dn_6:
    s_waitcnt lgkmcnt(0)
    ds_read_b128 v[36:39], v223 offset:0
    ds_read_b128 v[40:43], v223 offset:4096
    ds_read_b64_tr_b16 v[44:45], v224 offset:12288
    ds_read_b64_tr_b16 v[46:47], v224 offset:13312
    ds_read_b64_tr_b16 v[48:49], v225 offset:12288
    ds_read_b64_tr_b16 v[50:51], v225 offset:13312
    v_mfma_f32_32x32x16_bf16 v[116:131], v[28:31], v[20:23], v[116:131]
    v_mfma_f32_32x32x16_bf16 v[132:147], v[28:31], v[24:27], v[132:147]
    v_mfma_f32_32x32x16_bf16 v[148:163], v[32:35], v[20:23], v[148:163]
    v_mfma_f32_32x32x16_bf16 v[164:179], v[32:35], v[24:27], v[164:179]
    s_waitcnt lgkmcnt(0)
    v_mfma_f32_32x32x16_bf16 v[116:131], v[44:47], v[36:39], v[116:131]
    v_mfma_f32_32x32x16_bf16 v[132:147], v[44:47], v[40:43], v[132:147]
    v_mfma_f32_32x32x16_bf16 v[148:163], v[48:51], v[36:39], v[148:163]
    v_mfma_f32_32x32x16_bf16 v[164:179], v[48:51], v[40:43], v[164:179]
    s_nop 15
    s_add_u32 s54, s84, 524288
    v_cvt_pk_bf16_f32 v240, v116, v117
    v_cvt_pk_bf16_f32 v241, v118, v119
    v_cvt_pk_bf16_f32 v242, v120, v121
    v_cvt_pk_bf16_f32 v243, v122, v123
    buffer_store_dwordx4 v[240:243], v238, s[16:19], s54 offen offset:0
    v_cvt_pk_bf16_f32 v244, v124, v125
    v_cvt_pk_bf16_f32 v245, v126, v127
    v_cvt_pk_bf16_f32 v246, v128, v129
    v_cvt_pk_bf16_f32 v247, v130, v131
    buffer_store_dwordx4 v[244:247], v238, s[16:19], s54 offen offset:1024
    s_add_u32 s54, s84, 524288
    v_cvt_pk_bf16_f32 v248, v148, v149
    v_cvt_pk_bf16_f32 v249, v150, v151
    v_cvt_pk_bf16_f32 v250, v152, v153
    v_cvt_pk_bf16_f32 v251, v154, v155
    buffer_store_dwordx4 v[248:251], v238, s[16:19], s54 offen offset:2048
    v_cvt_pk_bf16_f32 v252, v156, v157
    v_cvt_pk_bf16_f32 v253, v158, v159
    v_cvt_pk_bf16_f32 v254, v160, v161
    v_cvt_pk_bf16_f32 v255, v162, v163
    buffer_store_dwordx4 v[252:255], v238, s[16:19], s54 offen offset:3072
    s_add_u32 s54, s84, 532480
    v_cvt_pk_bf16_f32 v240, v132, v133
    v_cvt_pk_bf16_f32 v241, v134, v135
    v_cvt_pk_bf16_f32 v242, v136, v137
    v_cvt_pk_bf16_f32 v243, v138, v139
    buffer_store_dwordx4 v[240:243], v238, s[16:19], s54 offen offset:0
    v_cvt_pk_bf16_f32 v244, v140, v141
    v_cvt_pk_bf16_f32 v245, v142, v143
    v_cvt_pk_bf16_f32 v246, v144, v145
    v_cvt_pk_bf16_f32 v247, v146, v147
    buffer_store_dwordx4 v[244:247], v238, s[16:19], s54 offen offset:1024
    s_add_u32 s54, s84, 532480
    v_cvt_pk_bf16_f32 v248, v164, v165
    v_cvt_pk_bf16_f32 v249, v166, v167
    v_cvt_pk_bf16_f32 v250, v168, v169
    v_cvt_pk_bf16_f32 v251, v170, v171
    buffer_store_dwordx4 v[248:251], v238, s[16:19], s54 offen offset:2048
    v_cvt_pk_bf16_f32 v252, v172, v173
    v_cvt_pk_bf16_f32 v253, v174, v175
    v_cvt_pk_bf16_f32 v254, v176, v177
    v_cvt_pk_bf16_f32 v255, v178, v179
    buffer_store_dwordx4 v[252:255], v238, s[16:19], s54 offen offset:3072
    s_waitcnt vmcnt(8)
    v_fma_f32 v188, v188, v200, v208
    v_fma_f32 v189, v189, v201, v209
    v_fma_f32 v190, v190, v202, v210
    v_fma_f32 v191, v191, v203, v211
    v_fma_f32 v192, v192, v204, v212
    v_fma_f32 v193, v193, v205, v213
    v_fma_f32 v194, v194, v206, v214
    v_fma_f32 v195, v195, v207, v215
    v_cvt_pk_bf16_f32 v184, v188, v189
    v_cvt_pk_bf16_f32 v185, v190, v191
    v_cvt_pk_bf16_f32 v186, v192, v193
    v_cvt_pk_bf16_f32 v187, v194, v195
    buffer_store_dwordx4 v[184:187], v180, s[64:67], s68 offen
.end_1:
    s_endpgm
.globl k_attn_kernel
.p2align 8
.type k_attn_kernel,@function
k_attn_kernel:
    s_cmp_ge_u32 s2, 256
    s_cbranch_scc1 .end_8
    s_load_dwordx2 s[40:41], s[0:1], 16
    s_load_dwordx2 s[46:47], s[0:1], 112
    s_and_b32 s35, s2, 7
    s_lshr_b32 s36, s2, 3
    s_and_b32 s37, s36, 3
    s_lshl_b32 s38, s35, 2
    s_add_u32 s37, s37, s38
    s_lshr_b32 s38, s36, 2
    s_sub_u32 s39, 15, s38
    v_and_b32 v1, 63, v0
    v_lshrrev_b32 v2, 6, v0
    s_nop 0
    v_readfirstlane_b32 s28, v2
    s_nop 2
    v_lshrrev_b32 v16, 3, v1
    s_lshl_b32 s90, s28, 3
    v_add_u32 v16, s90, v16
    v_bfe_u32 v10, v16, 1, 3
    v_and_b32 v11, 7, v1
    v_xor_b32 v10, v10, v11
    s_mov_b32 s90, 1024
    v_mul_lo_u32 v16, v16, s90
    v_lshl_add_u32 v16, v10, 4, v16
    v_lshrrev_b32 v17, 4, v1
    s_mul_i32 s90, s28, 4
    v_add_u32 v17, s90, v17
    v_and_b32 v10, 3, v17
    v_lshlrev_b32 v10, 2, v10
    s_mov_b32 s90, 8192
    v_mul_lo_u32 v17, v17, s90
    v_and_b32 v11, 15, v1
    v_xor_b32 v10, v10, v11
    v_lshl_add_u32 v17, v10, 4, v17
    s_lshl_b32 s33, s28, 10
    s_lshl_b32 s24, s38, 17
    s_lshl_b32 s25, s39, 17
    s_lshl_b32 s26, s37, 8
    s_waitcnt lgkmcnt(0)
    s_add_u32 s4, s46, 0x10000
    s_addc_u32 s5, s47, 0
    s_and_b32 s5, s5, 0xffff
    s_mov_b32 s6, 0x200000
    s_mov_b32 s7, 0x20000
    s_mov_b32 s8, s40
    s_and_b32 s9, s41, 0xffff
    s_mov_b32 s10, 0x400000
    s_mov_b32 s11, 0x20000
    s_add_u32 m0, s33, 0
    s_add_u32 s34, s24, 0
    buffer_load_dwordx4 v16, s[4:7], s34 offen lds
    s_add_u32 m0, s33, 8192
    s_add_u32 s34, s24, 65536
    buffer_load_dwordx4 v16, s[4:7], s34 offen lds
    s_add_u32 m0, s33, 16384
    s_add_u32 s34, s25, 0
    buffer_load_dwordx4 v16, s[4:7], s34 offen lds
    s_add_u32 m0, s33, 24576
    s_add_u32 s34, s25, 65536
    buffer_load_dwordx4 v16, s[4:7], s34 offen lds
    s_add_u32 m0, s33, 32768
    s_add_u32 s34, s26, 0
    buffer_load_dwordx4 v17, s[8:11], s34 offen lds
    s_add_u32 m0, s33, 40960
    s_add_u32 s34, s26, 262144
    buffer_load_dwordx4 v17, s[8:11], s34 offen lds
    s_lshr_b32 s29, s28, 2
    s_and_b32 s30, s28, 3
    s_lshl_b32 s50, s37, 19
    s_add_u32 s52, s46, s50
    s_addc_u32 s53, s47, 0
    s_add_u32 s12, s52, 0x400000
    s_addc_u32 s13, s53, 0
    s_and_b32 s13, s13, 0xffff
    s_mov_b32 s14, 0x80000
    s_mov_b32 s15, 0x20000
    s_add_u32 s16, s52, 0x1400000
    s_addc_u32 s17, s53, 0
    s_and_b32 s17, s17, 0xffff
    s_mov_b32 s18, 0x80000
    s_mov_b32 s19, 0x20000
    s_add_u32 s20, s46, 0x2400000
    s_addc_u32 s21, s47, 0
    s_and_b32 s21, s21, 0xffff
    s_mov_b32 s22, 0x1000000
    s_mov_b32 s23, 0x20000
    v_and_b32 v4, 31, v1
    v_lshrrev_b32 v5, 5, v1
    v_bfe_u32 v6, v1, 2, 2
    v_and_b32 v7, 3, v1
    v_bfe_u32 v8, v1, 4, 1
    v_lshrrev_b32 v19, 4, v1
    s_mul_i32 s90, s30, 4
    v_add_u32 v19, s90, v19
    v_and_b32 v10, 3, v19
    v_lshlrev_b32 v10, 2, v10
    s_mov_b32 s90, 256
    v_mul_lo_u32 v19, v19, s90
    v_and_b32 v11, 15, v1
    v_xor_b32 v10, v10, v11
    v_lshl_add_u32 v19, v10, 4, v19
    v_lshrrev_b32 v18, 4, v1
    s_lshl_b32 s50, s30, 2
    v_add_u32 v18, s50, v18
    v_xor_b32 v10, v18, v1
    v_and_b32 v10, 15, v10
    v_lshlrev_b32 v18, 8, v18
    v_lshl_add_u32 v18, v10, 4, v18
    v_bfe_u32 v10, v18, 5, 3
    v_lshrrev_b32 v11, 8, v18
    v_and_b32 v18, 16, v18
    v_lshl_add_u32 v18, v10, 10, v18
    v_lshl_add_u32 v18, v11, 5, v18
    v_bfe_u32 v10, v19, 5, 3
    v_lshrrev_b32 v11, 8, v19
    v_and_b32 v19, 16, v19
    v_lshl_add_u32 v19, v10, 10, v19
    v_lshl_add_u32 v19, v11, 5, v19
    v_and_b32 v10, 15, v4
    v_xor_b32 v10, v10, v5
    v_lshlrev_b32 v10, 4, v10
    v_lshl_add_u32 v10, v4, 8, v10
    s_lshl_b32 s50, s29, 16
    s_add_u32 s51, s50, 32768
    v_add_u32 v20, s51, v10
    v_xor_b32 v21, 32, v20
    v_xor_b32 v22, 64, v20
    v_xor_b32 v23, 96, v20
    v_xor_b32 v24, 128, v20
    v_xor_b32 v25, 160, v20
    v_xor_b32 v26, 192, v20
    v_xor_b32 v27, 224, v20
    v_lshl_add_u32 v28, v5, 2, v6
    v_mul_u32_u24 v28, 256, v28
    v_xor_b32 v10, 0, v6
    v_lshl_add_u32 v28, v10, 6, v28
    v_lshl_add_u32 v28, v8, 5, v28
    v_lshl_add_u32 v28, v7, 3, v28
    v_add_u32 v28, s50, v28
    v_lshl_add_u32 v29, v5, 2, v6
    v_mul_u32_u24 v29, 256, v29
    v_xor_b32 v10, 1, v6
    v_lshl_add_u32 v29, v10, 6, v29
    v_lshl_add_u32 v29, v8, 5, v29
    v_lshl_add_u32 v29, v7, 3, v29
    v_add_u32 v29, s50, v29
    v_lshl_add_u32 v30, v5, 2, v6
    v_mul_u32_u24 v30, 256, v30
    v_xor_b32 v10, 2, v6
    v_lshl_add_u32 v30, v10, 6, v30
    v_lshl_add_u32 v30, v8, 5, v30
    v_lshl_add_u32 v30, v7, 3, v30
    v_add_u32 v30, s50, v30
    v_lshl_add_u32 v31, v5, 2, v6
    v_mul_u32_u24 v31, 256, v31
    v_xor_b32 v10, 3, v6
    v_lshl_add_u32 v31, v10, 6, v31
    v_lshl_add_u32 v31, v8, 5, v31
    v_lshl_add_u32 v31, v7, 3, v31
    v_add_u32 v31, s50, v31
    s_lshl_b32 s51, s30, 10
    s_add_u32 s31, s50, s51
    s_add_u32 s32, s31, 32768
    s_lshl_b32 s50, s28, 12
    v_bfe_u32 v80, v4, 1, 3
    v_xor_b32 v80, v80, v5
    v_lshlrev_b32 v80, 4, v80
    v_lshl_add_u32 v80, v4, 7, v80
    v_add_u32 v80, s50, v80
    v_xor_b32 v81, 32, v80
    v_xor_b32 v82, 64, v80
    v_xor_b32 v83, 96, v80
    v_lshl_add_u32 v84, v5, 3, v6
    v_mul_u32_u24 v84, 256, v84
    v_xor_b32 v10, 0, v6
    v_lshl_add_u32 v84, v10, 6, v84
    v_lshl_add_u32 v84, v8, 5, v84
    v_lshl_add_u32 v84, v7, 3, v84
    v_add_u32 v84, 0x8000, v84
    v_lshl_add_u32 v85, v5, 3, v6
    v_mul_u32_u24 v85, 256, v85
    v_xor_b32 v10, 1, v6
    v_lshl_add_u32 v85, v10, 6, v85
    v_lshl_add_u32 v85, v8, 5, v85
    v_lshl_add_u32 v85, v7, 3, v85
    v_add_u32 v85, 0x8000, v85
    v_lshl_add_u32 v86, v5, 3, v6
    v_mul_u32_u24 v86, 256, v86
    v_xor_b32 v10, 2, v6
    v_lshl_add_u32 v86, v10, 6, v86
    v_lshl_add_u32 v86, v8, 5, v86
    v_lshl_add_u32 v86, v7, 3, v86
    v_add_u32 v86, 0x8000, v86
    v_lshl_add_u32 v87, v5, 3, v6
    v_mul_u32_u24 v87, 256, v87
    v_xor_b32 v10, 3, v6
    v_lshl_add_u32 v87, v10, 6, v87
    v_lshl_add_u32 v87, v8, 5, v87
    v_lshl_add_u32 v87, v7, 3, v87
    v_add_u32 v87, 0x8000, v87
    v_add_u32 v88, 0xc000, v80
    v_add_u32 v89, 0xc000, v81
    v_add_u32 v90, 0xc000, v82
    v_add_u32 v91, 0xc000, v83
    v_add_u32 v92, 0xc000, v84
    v_add_u32 v93, 0xc000, v85
    v_add_u32 v94, 0xc000, v86
    v_add_u32 v95, 0xc000, v87
    v_add_u32 v96, 0x18000, v80
    v_add_u32 v97, 0x18000, v81
    v_add_u32 v98, 0x18000, v82
    v_add_u32 v99, 0x18000, v83
    v_add_u32 v100, 0x18000, v84
    v_add_u32 v101, 0x18000, v85
    v_add_u32 v102, 0x18000, v86
    v_add_u32 v103, 0x18000, v87
    s_add_u32 m0, s33, 49152
    s_add_u32 s34, s24, 128
    buffer_load_dwordx4 v16, s[4:7], s34 offen lds
    s_add_u32 m0, s33, 57344
    s_add_u32 s34, s24, 65664
    buffer_load_dwordx4 v16, s[4:7], s34 offen lds
    s_add_u32 m0, s33, 65536
    s_add_u32 s34, s25, 128
    buffer_load_dwordx4 v16, s[4:7], s34 offen lds
    s_add_u32 m0, s33, 73728
    s_add_u32 s34, s25, 65664
    buffer_load_dwordx4 v16, s[4:7], s34 offen lds
    s_add_u32 m0, s33, 81920
    s_add_u32 s34, s26, 524288
    buffer_load_dwordx4 v17, s[8:11], s34 offen lds
    s_add_u32 m0, s33, 90112
    s_add_u32 s34, s26, 786432
    buffer_load_dwordx4 v17, s[8:11], s34 offen lds
    s_lshl_b32 s50, s38, 1
    s_add_u32 s57, s50, 2
    s_sub_u32 s55, 15, s50
    s_cmp_eq_u32 s29, 0
    s_cselect_b32 s57, s57, 99
    s_cselect_b32 s55, 0, s55
    s_cselect_b32 s59, s38, s39
    s_lshl_b32 s59, s59, 7
    s_lshl_b32 s50, s30, 5
    s_add_u32 s59, s59, s50
    s_mov_b32 s54, 0
    s_mov_b32 s64, 0
    s_lshl_b32 s66, -1, 0
    s_lshl_b32 s67, -1, 4
    s_lshl_b32 s68, -1, 1
    s_lshl_b32 s69, -1, 5
    s_lshl_b32 s72, -1, 2
    s_lshl_b32 s73, -1, 6
    s_lshl_b32 s74, -1, 3
    s_lshl_b32 s75, -1, 7
    s_lshl_b32 s76, -1, 8
    s_lshl_b32 s77, -1, 12
    s_lshl_b32 s78, -1, 9
    s_lshl_b32 s79, -1, 13
    s_lshl_b32 s84, -1, 10
    s_lshl_b32 s85, -1, 14
    s_lshl_b32 s86, -1, 11
    s_lshl_b32 s87, -1, 15
    s_lshl_b32 s88, -1, 16
    s_lshl_b32 s89, -1, 20
    s_lshl_b32 s92, -1, 17
    s_lshl_b32 s93, -1, 21
    s_lshl_b32 s94, -1, 18
    s_lshl_b32 s95, -1, 22
    s_lshl_b32 s96, -1, 19
    s_lshl_b32 s97, -1, 23
    s_lshl_b32 s98, -1, 24
    s_lshl_b32 s99, -1, 28
    s_lshl_b32 s100, -1, 25
    s_lshl_b32 s101, -1, 29
    s_lshl_b32 s40, -1, 26
    s_lshl_b32 s41, -1, 30
    s_lshl_b32 s42, -1, 27
    s_lshl_b32 s43, -1, 31
    s_mov_b32 s60, 0x3e0293ee
    s_mov_b32 s61, 0x3e0293ee
    s_mov_b32 s58, 0xf149f2ca
    s_mov_b32 s70, 0x41000000
    v_lshlrev_b32 v10, 2, v5
    v_sub_u32 v44, v4, v10
    s_lshl_b32 s27, s55, 14
    s_waitcnt vmcnt(6)
    s_barrier
    ds_read_b128 v[192:195], v80
    ds_read_b64_tr_b16 v[196:197], v84 offset:0
    ds_read_b64_tr_b16 v[198:199], v84 offset:1024
    ds_read_b64_tr_b16 v[200:201], v85 offset:0
    ds_read_b64_tr_b16 v[202:203], v85 offset:1024
    ds_read_b64_tr_b16 v[204:205], v86 offset:0
    ds_read_b64_tr_b16 v[206:207], v86 offset:1024
    ds_read_b64_tr_b16 v[208:209], v87 offset:0
    ds_read_b64_tr_b16 v[210:211], v87 offset:1024
    s_waitcnt lgkmcnt(0)
    ds_read_b128 v[212:215], v81
    ds_read_b64_tr_b16 v[216:217], v84 offset:4096
    ds_read_b64_tr_b16 v[218:219], v84 offset:5120
    ds_read_b64_tr_b16 v[220:221], v85 offset:4096
    ds_read_b64_tr_b16 v[222:223], v85 offset:5120
    ds_read_b64_tr_b16 v[224:225], v86 offset:4096
    ds_read_b64_tr_b16 v[226:227], v86 offset:5120
    ds_read_b64_tr_b16 v[228:229], v87 offset:4096
    ds_read_b64_tr_b16 v[230:231], v87 offset:5120
    v_mfma_f32_32x32x16_bf16 v[128:143], v[196:199], v[192:195], 0
    s_add_u32 m0, s33, 98304
    s_add_u32 s34, s24, 256
    buffer_load_dwordx4 v16, s[4:7], s34 offen lds
    v_mfma_f32_32x32x16_bf16 v[144:159], v[200:203], v[192:195], 0
    s_add_u32 m0, s33, 106496
    s_add_u32 s34, s24, 65792
    buffer_load_dwordx4 v16, s[4:7], s34 offen lds
    v_mfma_f32_32x32x16_bf16 v[160:175], v[204:207], v[192:195], 0
    s_add_u32 m0, s33, 114688
    s_add_u32 s34, s25, 256
    buffer_load_dwordx4 v16, s[4:7], s34 offen lds
    v_mfma_f32_32x32x16_bf16 v[176:191], v[208:211], v[192:195], 0
    s_add_u32 m0, s33, 122880
    s_add_u32 s34, s25, 65792
    buffer_load_dwordx4 v16, s[4:7], s34 offen lds
    s_waitcnt lgkmcnt(0)
    ds_read_b128 v[192:195], v82
    ds_read_b64_tr_b16 v[196:197], v84 offset:8192
    ds_read_b64_tr_b16 v[198:199], v84 offset:9216
    ds_read_b64_tr_b16 v[200:201], v85 offset:8192
    ds_read_b64_tr_b16 v[202:203], v85 offset:9216
    ds_read_b64_tr_b16 v[204:205], v86 offset:8192
    ds_read_b64_tr_b16 v[206:207], v86 offset:9216
    ds_read_b64_tr_b16 v[208:209], v87 offset:8192
    ds_read_b64_tr_b16 v[210:211], v87 offset:9216
    v_mfma_f32_32x32x16_bf16 v[128:143], v[216:219], v[212:215], v[128:143]
    s_add_u32 m0, s33, 131072
    s_add_u32 s34, s26, 1048576
    buffer_load_dwordx4 v17, s[8:11], s34 offen lds
    v_mfma_f32_32x32x16_bf16 v[144:159], v[220:223], v[212:215], v[144:159]
    s_add_u32 m0, s33, 139264
    s_add_u32 s34, s26, 1310720
    buffer_load_dwordx4 v17, s[8:11], s34 offen lds
    v_mfma_f32_32x32x16_bf16 v[160:175], v[224:227], v[212:215], v[160:175]
    v_mfma_f32_32x32x16_bf16 v[176:191], v[228:231], v[212:215], v[176:191]
    s_waitcnt lgkmcnt(0)
    ds_read_b128 v[212:215], v83
    ds_read_b64_tr_b16 v[216:217], v84 offset:12288
    ds_read_b64_tr_b16 v[218:219], v84 offset:13312
    ds_read_b64_tr_b16 v[220:221], v85 offset:12288
    ds_read_b64_tr_b16 v[222:223], v85 offset:13312
    ds_read_b64_tr_b16 v[224:225], v86 offset:12288
    ds_read_b64_tr_b16 v[226:227], v86 offset:13312
    ds_read_b64_tr_b16 v[228:229], v87 offset:12288
    ds_read_b64_tr_b16 v[230:231], v87 offset:13312
    v_mfma_f32_32x32x16_bf16 v[128:143], v[196:199], v[192:195], v[128:143]
    v_mfma_f32_32x32x16_bf16 v[144:159], v[200:203], v[192:195], v[144:159]
    v_mfma_f32_32x32x16_bf16 v[160:175], v[204:207], v[192:195], v[160:175]
    v_mfma_f32_32x32x16_bf16 v[176:191], v[208:211], v[192:195], v[176:191]
    s_waitcnt lgkmcnt(0)
    s_waitcnt vmcnt(6)
    s_barrier
    ds_read_b128 v[192:195], v88
    ds_read_b64_tr_b16 v[196:197], v92 offset:0
    ds_read_b64_tr_b16 v[198:199], v92 offset:1024
    ds_read_b64_tr_b16 v[200:201], v93 offset:0
    ds_read_b64_tr_b16 v[202:203], v93 offset:1024
    ds_read_b64_tr_b16 v[204:205], v94 offset:0
    ds_read_b64_tr_b16 v[206:207], v94 offset:1024
    ds_read_b64_tr_b16 v[208:209], v95 offset:0
    ds_read_b64_tr_b16 v[210:211], v95 offset:1024
    v_mfma_f32_32x32x16_bf16 v[128:143], v[216:219], v[212:215], v[128:143]
    s_add_u32 m0, s33, 0
    s_add_u32 s34, s24, 384
    buffer_load_dwordx4 v16, s[4:7], s34 offen lds
    v_mfma_f32_32x32x16_bf16 v[144:159], v[220:223], v[212:215], v[144:159]
    s_add_u32 m0, s33, 8192
    s_add_u32 s34, s24, 65920
    buffer_load_dwordx4 v16, s[4:7], s34 offen lds
    v_mfma_f32_32x32x16_bf16 v[160:175], v[224:227], v[212:215], v[160:175]
    s_add_u32 m0, s33, 16384
    s_add_u32 s34, s25, 384
    buffer_load_dwordx4 v16, s[4:7], s34 offen lds
    v_mfma_f32_32x32x16_bf16 v[176:191], v[228:231], v[212:215], v[176:191]
    s_add_u32 m0, s33, 24576
    s_add_u32 s34, s25, 65920
    buffer_load_dwordx4 v16, s[4:7], s34 offen lds
    s_waitcnt lgkmcnt(0)
    ds_read_b128 v[212:215], v89
    ds_read_b64_tr_b16 v[216:217], v92 offset:4096
    ds_read_b64_tr_b16 v[218:219], v92 offset:5120
    ds_read_b64_tr_b16 v[220:221], v93 offset:4096
    ds_read_b64_tr_b16 v[222:223], v93 offset:5120
    ds_read_b64_tr_b16 v[224:225], v94 offset:4096
    ds_read_b64_tr_b16 v[226:227], v94 offset:5120
    ds_read_b64_tr_b16 v[228:229], v95 offset:4096
    ds_read_b64_tr_b16 v[230:231], v95 offset:5120
    v_mfma_f32_32x32x16_bf16 v[128:143], v[196:199], v[192:195], v[128:143]
    s_add_u32 m0, s33, 32768
    s_add_u32 s34, s26, 1572864
    buffer_load_dwordx4 v17, s[8:11], s34 offen lds
    v_mfma_f32_32x32x16_bf16 v[144:159], v[200:203], v[192:195], v[144:159]
    s_add_u32 m0, s33, 40960
    s_add_u32 s34, s26, 1835008
    buffer_load_dwordx4 v17, s[8:11], s34 offen lds
    v_mfma_f32_32x32x16_bf16 v[160:175], v[204:207], v[192:195], v[160:175]
    v_mfma_f32_32x32x16_bf16 v[176:191], v[208:211], v[192:195], v[176:191]
    s_waitcnt lgkmcnt(0)
    ds_read_b128 v[192:195], v90
    ds_read_b64_tr_b16 v[196:197], v92 offset:8192
    ds_read_b64_tr_b16 v[198:199], v92 offset:9216
    ds_read_b64_tr_b16 v[200:201], v93 offset:8192
    ds_read_b64_tr_b16 v[202:203], v93 offset:9216
    ds_read_b64_tr_b16 v[204:205], v94 offset:8192
    ds_read_b64_tr_b16 v[206:207], v94 offset:9216
    ds_read_b64_tr_b16 v[208:209], v95 offset:8192
    ds_read_b64_tr_b16 v[210:211], v95 offset:9216
    v_mfma_f32_32x32x16_bf16 v[128:143], v[216:219], v[212:215], v[128:143]
    v_mfma_f32_32x32x16_bf16 v[144:159], v[220:223], v[212:215], v[144:159]
    v_mfma_f32_32x32x16_bf16 v[160:175], v[224:227], v[212:215], v[160:175]
    v_mfma_f32_32x32x16_bf16 v[176:191], v[228:231], v[212:215], v[176:191]
    s_waitcnt lgkmcnt(0)
    ds_read_b128 v[212:215], v91
    ds_read_b64_tr_b16 v[216:217], v92 offset:12288
    ds_read_b64_tr_b16 v[218:219], v92 offset:13312
    ds_read_b64_tr_b16 v[220:221], v93 offset:12288
    ds_read_b64_tr_b16 v[222:223], v93 offset:13312
    ds_read_b64_tr_b16 v[224:225], v94 offset:12288
    ds_read_b64_tr_b16 v[226:227], v94 offset:13312
    ds_read_b64_tr_b16 v[228:229], v95 offset:12288
    ds_read_b64_tr_b16 v[230:231], v95 offset:13312
    v_mfma_f32_32x32x16_bf16 v[128:143], v[196:199], v[192:195], v[128:143]
    v_mfma_f32_32x32x16_bf16 v[144:159], v[200:203], v[192:195], v[144:159]
    v_mfma_f32_32x32x16_bf16 v[160:175], v[204:207], v[192:195], v[160:175]
    v_mfma_f32_32x32x16_bf16 v[176:191], v[208:211], v[192:195], v[176:191]
    s_waitcnt lgkmcnt(0)
    s_waitcnt vmcnt(6)
    s_barrier
    ds_read_b128 v[192:195], v96
    ds_read_b64_tr_b16 v[196:197], v100 offset:0
    ds_read_b64_tr_b16 v[198:199], v100 offset:1024
    ds_read_b64_tr_b16 v[200:201], v101 offset:0
    ds_read_b64_tr_b16 v[202:203], v101 offset:1024
    ds_read_b64_tr_b16 v[204:205], v102 offset:0
    ds_read_b64_tr_b16 v[206:207], v102 offset:1024
    ds_read_b64_tr_b16 v[208:209], v103 offset:0
    ds_read_b64_tr_b16 v[210:211], v103 offset:1024
    v_mfma_f32_32x32x16_bf16 v[128:143], v[216:219], v[212:215], v[128:143]
    s_add_u32 m0, s33, 49152
    s_add_u32 s34, s24, 512
    buffer_load_dwordx4 v16, s[4:7], s34 offen lds
    v_mfma_f32_32x32x16_bf16 v[144:159], v[220:223], v[212:215], v[144:159]
    s_add_u32 m0, s33, 57344
    s_add_u32 s34, s24, 66048
    buffer_load_dwordx4 v16, s[4:7], s34 offen lds
    v_mfma_f32_32x32x16_bf16 v[160:175], v[224:227], v[212:215], v[160:175]
    s_add_u32 m0, s33, 65536
    s_add_u32 s34, s25, 512
    buffer_load_dwordx4 v16, s[4:7], s34 offen lds
    v_mfma_f32_32x32x16_bf16 v[176:191], v[228:231], v[212:215], v[176:191]
    s_add_u32 m0, s33, 73728
    s_add_u32 s34, s25, 66048
    buffer_load_dwordx4 v16, s[4:7], s34 offen lds
    s_waitcnt lgkmcnt(0)
    ds_read_b128 v[212:215], v97
    ds_read_b64_tr_b16 v[216:217], v100 offset:4096
    ds_read_b64_tr_b16 v[218:219], v100 offset:5120
    ds_read_b64_tr_b16 v[220:221], v101 offset:4096
    ds_read_b64_tr_b16 v[222:223], v101 offset:5120
    ds_read_b64_tr_b16 v[224:225], v102 offset:4096
    ds_read_b64_tr_b16 v[226:227], v102 offset:5120
    ds_read_b64_tr_b16 v[228:229], v103 offset:4096
    ds_read_b64_tr_b16 v[230:231], v103 offset:5120
    v_mfma_f32_32x32x16_bf16 v[128:143], v[196:199], v[192:195], v[128:143]
    s_add_u32 m0, s33, 81920
    s_add_u32 s34, s26, 2097152
    buffer_load_dwordx4 v17, s[8:11], s34 offen lds
    v_mfma_f32_32x32x16_bf16 v[144:159], v[200:203], v[192:195], v[144:159]
    s_add_u32 m0, s33, 90112
    s_add_u32 s34, s26, 2359296
    buffer_load_dwordx4 v17, s[8:11], s34 offen lds
    v_mfma_f32_32x32x16_bf16 v[160:175], v[204:207], v[192:195], v[160:175]
    v_mfma_f32_32x32x16_bf16 v[176:191], v[208:211], v[192:195], v[176:191]
    s_waitcnt lgkmcnt(0)
    ds_read_b128 v[192:195], v98
    ds_read_b64_tr_b16 v[196:197], v100 offset:8192
    ds_read_b64_tr_b16 v[198:199], v100 offset:9216
    ds_read_b64_tr_b16 v[200:201], v101 offset:8192
    ds_read_b64_tr_b16 v[202:203], v101 offset:9216
    ds_read_b64_tr_b16 v[204:205], v102 offset:8192
    ds_read_b64_tr_b16 v[206:207], v102 offset:9216
    ds_read_b64_tr_b16 v[208:209], v103 offset:8192
    ds_read_b64_tr_b16 v[210:211], v103 offset:9216
    v_mfma_f32_32x32x16_bf16 v[128:143], v[216:219], v[212:215], v[128:143]
    v_mfma_f32_32x32x16_bf16 v[144:159], v[220:223], v[212:215], v[144:159]
    v_mfma_f32_32x32x16_bf16 v[160:175], v[224:227], v[212:215], v[160:175]
    v_mfma_f32_32x32x16_bf16 v[176:191], v[228:231], v[212:215], v[176:191]
    s_waitcnt lgkmcnt(0)
    ds_read_b128 v[212:215], v99
    ds_read_b64_tr_b16 v[216:217], v100 offset:12288
    ds_read_b64_tr_b16 v[218:219], v100 offset:13312
    ds_read_b64_tr_b16 v[220:221], v101 offset:12288
    ds_read_b64_tr_b16 v[222:223], v101 offset:13312
    ds_read_b64_tr_b16 v[224:225], v102 offset:12288
    ds_read_b64_tr_b16 v[226:227], v102 offset:13312
    ds_read_b64_tr_b16 v[228:229], v103 offset:12288
    ds_read_b64_tr_b16 v[230:231], v103 offset:13312
    v_mfma_f32_32x32x16_bf16 v[128:143], v[196:199], v[192:195], v[128:143]
    v_mfma_f32_32x32x16_bf16 v[144:159], v[200:203], v[192:195], v[144:159]
    v_mfma_f32_32x32x16_bf16 v[160:175], v[204:207], v[192:195], v[160:175]
    v_mfma_f32_32x32x16_bf16 v[176:191], v[208:211], v[192:195], v[176:191]
    s_waitcnt lgkmcnt(0)
    s_waitcnt vmcnt(6)
    s_barrier
    ds_read_b128 v[192:195], v80
    ds_read_b64_tr_b16 v[196:197], v84 offset:0
    ds_read_b64_tr_b16 v[198:199], v84 offset:1024
    ds_read_b64_tr_b16 v[200:201], v85 offset:0
    ds_read_b64_tr_b16 v[202:203], v85 offset:1024
    ds_read_b64_tr_b16 v[204:205], v86 offset:0
    ds_read_b64_tr_b16 v[206:207], v86 offset:1024
    ds_read_b64_tr_b16 v[208:209], v87 offset:0
    ds_read_b64_tr_b16 v[210:211], v87 offset:1024
    v_mfma_f32_32x32x16_bf16 v[128:143], v[216:219], v[212:215], v[128:143]
    s_add_u32 m0, s33, 98304
    s_add_u32 s34, s24, 640
    buffer_load_dwordx4 v16, s[4:7], s34 offen lds
    v_mfma_f32_32x32x16_bf16 v[144:159], v[220:223], v[212:215], v[144:159]
    s_add_u32 m0, s33, 106496
    s_add_u32 s34, s24, 66176
    buffer_load_dwordx4 v16, s[4:7], s34 offen lds
    v_mfma_f32_32x32x16_bf16 v[160:175], v[224:227], v[212:215], v[160:175]
    s_add_u32 m0, s33, 114688
    s_add_u32 s34, s25, 640
    buffer_load_dwordx4 v16, s[4:7], s34 offen lds
    v_mfma_f32_32x32x16_bf16 v[176:191], v[228:231], v[212:215], v[176:191]
    s_add_u32 m0, s33, 122880
    s_add_u32 s34, s25, 66176
    buffer_load_dwordx4 v16, s[4:7], s34 offen lds
    s_waitcnt lgkmcnt(0)
    ds_read_b128 v[212:215], v81
    ds_read_b64_tr_b16 v[216:217], v84 offset:4096
    ds_read_b64_tr_b16 v[218:219], v84 offset:5120
    ds_read_b64_tr_b16 v[220:221], v85 offset:4096
    ds_read_b64_tr_b16 v[222:223], v85 offset:5120
    ds_read_b64_tr_b16 v[224:225], v86 offset:4096
    ds_read_b64_tr_b16 v[226:227], v86 offset:5120
    ds_read_b64_tr_b16 v[228:229], v87 offset:4096
    ds_read_b64_tr_b16 v[230:231], v87 offset:5120
    v_mfma_f32_32x32x16_bf16 v[128:143], v[196:199], v[192:195], v[128:143]
    s_add_u32 m0, s33, 131072
    s_add_u32 s34, s26, 2621440
    buffer_load_dwordx4 v17, s[8:11], s34 offen lds
    v_mfma_f32_32x32x16_bf16 v[144:159], v[200:203], v[192:195], v[144:159]
    s_add_u32 m0, s33, 139264
    s_add_u32 s34, s26, 2883584
    buffer_load_dwordx4 v17, s[8:11], s34 offen lds
    v_mfma_f32_32x32x16_bf16 v[160:175], v[204:207], v[192:195], v[160:175]
    v_mfma_f32_32x32x16_bf16 v[176:191], v[208:211], v[192:195], v[176:191]
    s_waitcnt lgkmcnt(0)
    ds_read_b128 v[192:195], v82
    ds_read_b64_tr_b16 v[196:197], v84 offset:8192
    ds_read_b64_tr_b16 v[198:199], v84 offset:9216
    ds_read_b64_tr_b16 v[200:201], v85 offset:8192
    ds_read_b64_tr_b16 v[202:203], v85 offset:9216
    ds_read_b64_tr_b16 v[204:205], v86 offset:8192
    ds_read_b64_tr_b16 v[206:207], v86 offset:9216
    ds_read_b64_tr_b16 v[208:209], v87 offset:8192
    ds_read_b64_tr_b16 v[210:211], v87 offset:9216
    v_mfma_f32_32x32x16_bf16 v[128:143], v[216:219], v[212:215], v[128:143]
    v_mfma_f32_32x32x16_bf16 v[144:159], v[220:223], v[212:215], v[144:159]
    v_mfma_f32_32x32x16_bf16 v[160:175], v[224:227], v[212:215], v[160:175]
    v_mfma_f32_32x32x16_bf16 v[176:191], v[228:231], v[212:215], v[176:191]
    s_waitcnt lgkmcnt(0)
    ds_read_b128 v[212:215], v83
    ds_read_b64_tr_b16 v[216:217], v84 offset:12288
    ds_read_b64_tr_b16 v[218:219], v84 offset:13312
    ds_read_b64_tr_b16 v[220:221], v85 offset:12288
    ds_read_b64_tr_b16 v[222:223], v85 offset:13312
    ds_read_b64_tr_b16 v[224:225], v86 offset:12288
    ds_read_b64_tr_b16 v[226:227], v86 offset:13312
    ds_read_b64_tr_b16 v[228:229], v87 offset:12288
    ds_read_b64_tr_b16 v[230:231], v87 offset:13312
    v_mfma_f32_32x32x16_bf16 v[128:143], v[196:199], v[192:195], v[128:143]
    v_mfma_f32_32x32x16_bf16 v[144:159], v[200:203], v[192:195], v[144:159]
    v_mfma_f32_32x32x16_bf16 v[160:175], v[204:207], v[192:195], v[160:175]
    v_mfma_f32_32x32x16_bf16 v[176:191], v[208:211], v[192:195], v[176:191]
    s_waitcnt lgkmcnt(0)
    s_waitcnt vmcnt(6)
    s_barrier
    ds_read_b128 v[192:195], v88
    ds_read_b64_tr_b16 v[196:197], v92 offset:0
    ds_read_b64_tr_b16 v[198:199], v92 offset:1024
    ds_read_b64_tr_b16 v[200:201], v93 offset:0
    ds_read_b64_tr_b16 v[202:203], v93 offset:1024
    ds_read_b64_tr_b16 v[204:205], v94 offset:0
    ds_read_b64_tr_b16 v[206:207], v94 offset:1024
    ds_read_b64_tr_b16 v[208:209], v95 offset:0
    ds_read_b64_tr_b16 v[210:211], v95 offset:1024
    v_mfma_f32_32x32x16_bf16 v[128:143], v[216:219], v[212:215], v[128:143]
    s_add_u32 m0, s33, 0
    s_add_u32 s34, s24, 768
    buffer_load_dwordx4 v16, s[4:7], s34 offen lds
    v_mfma_f32_32x32x16_bf16 v[144:159], v[220:223], v[212:215], v[144:159]
    s_add_u32 m0, s33, 8192
    s_add_u32 s34, s24, 66304
    buffer_load_dwordx4 v16, s[4:7], s34 offen lds
    v_mfma_f32_32x32x16_bf16 v[160:175], v[224:227], v[212:215], v[160:175]
    s_add_u32 m0, s33, 16384
    s_add_u32 s34, s25, 768
    buffer_load_dwordx4 v16, s[4:7], s34 offen lds
    v_mfma_f32_32x32x16_bf16 v[176:191], v[228:231], v[212:215], v[176:191]
    s_add_u32 m0, s33, 24576
    s_add_u32 s34, s25, 66304
    buffer_load_dwordx4 v16, s[4:7], s34 offen lds
    s_waitcnt lgkmcnt(0)
    ds_read_b128 v[212:215], v89
    ds_read_b64_tr_b16 v[216:217], v92 offset:4096
    ds_read_b64_tr_b16 v[218:219], v92 offset:5120
    ds_read_b64_tr_b16 v[220:221], v93 offset:4096
    ds_read_b64_tr_b16 v[222:223], v93 offset:5120
    ds_read_b64_tr_b16 v[224:225], v94 offset:4096
    ds_read_b64_tr_b16 v[226:227], v94 offset:5120
    ds_read_b64_tr_b16 v[228:229], v95 offset:4096
    ds_read_b64_tr_b16 v[230:231], v95 offset:5120
    v_mfma_f32_32x32x16_bf16 v[128:143], v[196:199], v[192:195], v[128:143]
    s_add_u32 m0, s33, 32768
    s_add_u32 s34, s26, 3145728
    buffer_load_dwordx4 v17, s[8:11], s34 offen lds
    v_mfma_f32_32x32x16_bf16 v[144:159], v[200:203], v[192:195], v[144:159]
    s_add_u32 m0, s33, 40960
    s_add_u32 s34, s26, 3407872
    buffer_load_dwordx4 v17, s[8:11], s34 offen lds
    v_mfma_f32_32x32x16_bf16 v[160:175], v[204:207], v[192:195], v[160:175]
    v_mfma_f32_32x32x16_bf16 v[176:191], v[208:211], v[192:195], v[176:191]
    s_waitcnt lgkmcnt(0)
    ds_read_b128 v[192:195], v90
    ds_read_b64_tr_b16 v[196:197], v92 offset:8192
    ds_read_b64_tr_b16 v[198:199], v92 offset:9216
    ds_read_b64_tr_b16 v[200:201], v93 offset:8192
    ds_read_b64_tr_b16 v[202:203], v93 offset:9216
    ds_read_b64_tr_b16 v[204:205], v94 offset:8192
    ds_read_b64_tr_b16 v[206:207], v94 offset:9216
    ds_read_b64_tr_b16 v[208:209], v95 offset:8192
    ds_read_b64_tr_b16 v[210:211], v95 offset:9216
    v_mfma_f32_32x32x16_bf16 v[128:143], v[216:219], v[212:215], v[128:143]
    v_mfma_f32_32x32x16_bf16 v[144:159], v[220:223], v[212:215], v[144:159]
    v_mfma_f32_32x32x16_bf16 v[160:175], v[224:227], v[212:215], v[160:175]
    v_mfma_f32_32x32x16_bf16 v[176:191], v[228:231], v[212:215], v[176:191]
    s_waitcnt lgkmcnt(0)
    ds_read_b128 v[212:215], v91
    ds_read_b64_tr_b16 v[216:217], v92 offset:12288
    ds_read_b64_tr_b16 v[218:219], v92 offset:13312
    ds_read_b64_tr_b16 v[220:221], v93 offset:12288
    ds_read_b64_tr_b16 v[222:223], v93 offset:13312
    ds_read_b64_tr_b16 v[224:225], v94 offset:12288
    ds_read_b64_tr_b16 v[226:227], v94 offset:13312
    ds_read_b64_tr_b16 v[228:229], v95 offset:12288
    ds_read_b64_tr_b16 v[230:231], v95 offset:13312
    v_mfma_f32_32x32x16_bf16 v[128:143], v[196:199], v[192:195], v[128:143]
    v_mfma_f32_32x32x16_bf16 v[144:159], v[200:203], v[192:195], v[144:159]
    v_mfma_f32_32x32x16_bf16 v[160:175], v[204:207], v[192:195], v[160:175]
    v_mfma_f32_32x32x16_bf16 v[176:191], v[208:211], v[192:195], v[176:191]
    s_waitcnt lgkmcnt(0)
    s_waitcnt vmcnt(6)
    s_barrier
    ds_read_b128 v[192:195], v96
    ds_read_b64_tr_b16 v[196:197], v100 offset:0
    ds_read_b64_tr_b16 v[198:199], v100 offset:1024
    ds_read_b64_tr_b16 v[200:201], v101 offset:0
    ds_read_b64_tr_b16 v[202:203], v101 offset:1024
    ds_read_b64_tr_b16 v[204:205], v102 offset:0
    ds_read_b64_tr_b16 v[206:207], v102 offset:1024
    ds_read_b64_tr_b16 v[208:209], v103 offset:0
    ds_read_b64_tr_b16 v[210:211], v103 offset:1024
    v_mfma_f32_32x32x16_bf16 v[128:143], v[216:219], v[212:215], v[128:143]
    s_add_u32 m0, s33, 49152
    s_add_u32 s34, s24, 896
    buffer_load_dwordx4 v16, s[4:7], s34 offen lds
    v_mfma_f32_32x32x16_bf16 v[144:159], v[220:223], v[212:215], v[144:159]
    s_add_u32 m0, s33, 57344
    s_add_u32 s34, s24, 66432
    buffer_load_dwordx4 v16, s[4:7], s34 offen lds
    v_mfma_f32_32x32x16_bf16 v[160:175], v[224:227], v[212:215], v[160:175]
    s_add_u32 m0, s33, 65536
    s_add_u32 s34, s25, 896
    buffer_load_dwordx4 v16, s[4:7], s34 offen lds
    v_mfma_f32_32x32x16_bf16 v[176:191], v[228:231], v[212:215], v[176:191]
    s_add_u32 m0, s33, 73728
    s_add_u32 s34, s25, 66432
    buffer_load_dwordx4 v16, s[4:7], s34 offen lds
    s_waitcnt lgkmcnt(0)
    ds_read_b128 v[212:215], v97
    ds_read_b64_tr_b16 v[216:217], v100 offset:4096
    ds_read_b64_tr_b16 v[218:219], v100 offset:5120
    ds_read_b64_tr_b16 v[220:221], v101 offset:4096
    ds_read_b64_tr_b16 v[222:223], v101 offset:5120
    ds_read_b64_tr_b16 v[224:225], v102 offset:4096
    ds_read_b64_tr_b16 v[226:227], v102 offset:5120
    ds_read_b64_tr_b16 v[228:229], v103 offset:4096
    ds_read_b64_tr_b16 v[230:231], v103 offset:5120
    v_mfma_f32_32x32x16_bf16 v[128:143], v[196:199], v[192:195], v[128:143]
    s_add_u32 m0, s33, 81920
    s_add_u32 s34, s26, 3670016
    buffer_load_dwordx4 v17, s[8:11], s34 offen lds
    v_mfma_f32_32x32x16_bf16 v[144:159], v[200:203], v[192:195], v[144:159]
    s_add_u32 m0, s33, 90112
    s_add_u32 s34, s26, 3932160
    buffer_load_dwordx4 v17, s[8:11], s34 offen lds
    v_mfma_f32_32x32x16_bf16 v[160:175], v[204:207], v[192:195], v[160:175]
    v_mfma_f32_32x32x16_bf16 v[176:191], v[208:211], v[192:195], v[176:191]
    s_waitcnt lgkmcnt(0)
    ds_read_b128 v[192:195], v98
    ds_read_b64_tr_b16 v[196:197], v100 offset:8192
    ds_read_b64_tr_b16 v[198:199], v100 offset:9216
    ds_read_b64_tr_b16 v[200:201], v101 offset:8192
    ds_read_b64_tr_b16 v[202:203], v101 offset:9216
    ds_read_b64_tr_b16 v[204:205], v102 offset:8192
    ds_read_b64_tr_b16 v[206:207], v102 offset:9216
    ds_read_b64_tr_b16 v[208:209], v103 offset:8192
    ds_read_b64_tr_b16 v[210:211], v103 offset:9216
    v_mfma_f32_32x32x16_bf16 v[128:143], v[216:219], v[212:215], v[128:143]
    v_mfma_f32_32x32x16_bf16 v[144:159], v[220:223], v[212:215], v[144:159]
    v_mfma_f32_32x32x16_bf16 v[160:175], v[224:227], v[212:215], v[160:175]
    v_mfma_f32_32x32x16_bf16 v[176:191], v[228:231], v[212:215], v[176:191]
    s_waitcnt lgkmcnt(0)
    ds_read_b128 v[212:215], v99
    ds_read_b64_tr_b16 v[216:217], v100 offset:12288
    ds_read_b64_tr_b16 v[218:219], v100 offset:13312
    ds_read_b64_tr_b16 v[220:221], v101 offset:12288
    ds_read_b64_tr_b16 v[222:223], v101 offset:13312
    ds_read_b64_tr_b16 v[224:225], v102 offset:12288
    ds_read_b64_tr_b16 v[226:227], v102 offset:13312
    ds_read_b64_tr_b16 v[228:229], v103 offset:12288
    ds_read_b64_tr_b16 v[230:231], v103 offset:13312
    v_mfma_f32_32x32x16_bf16 v[128:143], v[196:199], v[192:195], v[128:143]
    v_mfma_f32_32x32x16_bf16 v[144:159], v[200:203], v[192:195], v[144:159]
    v_mfma_f32_32x32x16_bf16 v[160:175], v[204:207], v[192:195], v[160:175]
    v_mfma_f32_32x32x16_bf16 v[176:191], v[208:211], v[192:195], v[176:191]
    s_waitcnt lgkmcnt(0)
    s_waitcnt vmcnt(6)
    s_barrier
    ds_read_b128 v[192:195], v80
    ds_read_b64_tr_b16 v[196:197], v84 offset:0
    ds_read_b64_tr_b16 v[198:199], v84 offset:1024
    ds_read_b64_tr_b16 v[200:201], v85 offset:0
    ds_read_b64_tr_b16 v[202:203], v85 offset:1024
    ds_read_b64_tr_b16 v[204:205], v86 offset:0
    ds_read_b64_tr_b16 v[206:207], v86 offset:1024
    ds_read_b64_tr_b16 v[208:209], v87 offset:0
    ds_read_b64_tr_b16 v[210:211], v87 offset:1024
    v_mfma_f32_32x32x16_bf16 v[128:143], v[216:219], v[212:215], v[128:143]
    v_mfma_f32_32x32x16_bf16 v[144:159], v[220:223], v[212:215], v[144:159]
    v_mfma_f32_32x32x16_bf16 v[160:175], v[224:227], v[212:215], v[160:175]
    v_mfma_f32_32x32x16_bf16 v[176:191], v[228:231], v[212:215], v[176:191]
    s_waitcnt lgkmcnt(0)
    ds_read_b128 v[212:215], v81
    ds_read_b64_tr_b16 v[216:217], v84 offset:4096
    ds_read_b64_tr_b16 v[218:219], v84 offset:5120
    ds_read_b64_tr_b16 v[220:221], v85 offset:4096
    ds_read_b64_tr_b16 v[222:223], v85 offset:5120
    ds_read_b64_tr_b16 v[224:225], v86 offset:4096
    ds_read_b64_tr_b16 v[226:227], v86 offset:5120
    ds_read_b64_tr_b16 v[228:229], v87 offset:4096
    ds_read_b64_tr_b16 v[230:231], v87 offset:5120
    v_mfma_f32_32x32x16_bf16 v[128:143], v[196:199], v[192:195], v[128:143]
    v_mfma_f32_32x32x16_bf16 v[144:159], v[200:203], v[192:195], v[144:159]
    v_mfma_f32_32x32x16_bf16 v[160:175], v[204:207], v[192:195], v[160:175]
    v_mfma_f32_32x32x16_bf16 v[176:191], v[208:211], v[192:195], v[176:191]
    s_waitcnt lgkmcnt(0)
    ds_read_b128 v[192:195], v82
    ds_read_b64_tr_b16 v[196:197], v84 offset:8192
    ds_read_b64_tr_b16 v[198:199], v84 offset:9216
    ds_read_b64_tr_b16 v[200:201], v85 offset:8192
    ds_read_b64_tr_b16 v[202:203], v85 offset:9216
    ds_read_b64_tr_b16 v[204:205], v86 offset:8192
    ds_read_b64_tr_b16 v[206:207], v86 offset:9216
    ds_read_b64_tr_b16 v[208:209], v87 offset:8192
    ds_read_b64_tr_b16 v[210:211], v87 offset:9216
    v_mfma_f32_32x32x16_bf16 v[128:143], v[216:219], v[212:215], v[128:143]
    v_mfma_f32_32x32x16_bf16 v[144:159], v[220:223], v[212:215], v[144:159]
    v_mfma_f32_32x32x16_bf16 v[160:175], v[224:227], v[212:215], v[160:175]
    v_mfma_f32_32x32x16_bf16 v[176:191], v[228:231], v[212:215], v[176:191]
    s_waitcnt lgkmcnt(0)
    ds_read_b128 v[212:215], v83
    ds_read_b64_tr_b16 v[216:217], v84 offset:12288
    ds_read_b64_tr_b16 v[218:219], v84 offset:13312
    ds_read_b64_tr_b16 v[220:221], v85 offset:12288
    ds_read_b64_tr_b16 v[222:223], v85 offset:13312
    ds_read_b64_tr_b16 v[224:225], v86 offset:12288
    ds_read_b64_tr_b16 v[226:227], v86 offset:13312
    ds_read_b64_tr_b16 v[228:229], v87 offset:12288
    ds_read_b64_tr_b16 v[230:231], v87 offset:13312
    v_mfma_f32_32x32x16_bf16 v[128:143], v[196:199], v[192:195], v[128:143]
    v_mfma_f32_32x32x16_bf16 v[144:159], v[200:203], v[192:195], v[144:159]
    v_mfma_f32_32x32x16_bf16 v[160:175], v[204:207], v[192:195], v[160:175]
    v_mfma_f32_32x32x16_bf16 v[176:191], v[208:211], v[192:195], v[176:191]
    s_waitcnt lgkmcnt(0)
    s_waitcnt vmcnt(0)
    s_barrier
    ds_read_b128 v[192:195], v88
    ds_read_b64_tr_b16 v[196:197], v92 offset:0
    ds_read_b64_tr_b16 v[198:199], v92 offset:1024
    ds_read_b64_tr_b16 v[200:201], v93 offset:0
    ds_read_b64_tr_b16 v[202:203], v93 offset:1024
    ds_read_b64_tr_b16 v[204:205], v94 offset:0
    ds_read_b64_tr_b16 v[206:207], v94 offset:1024
    ds_read_b64_tr_b16 v[208:209], v95 offset:0
    ds_read_b64_tr_b16 v[210:211], v95 offset:1024
    v_mfma_f32_32x32x16_bf16 v[128:143], v[216:219], v[212:215], v[128:143]
    s_add_u32 m0, s32, 0
    s_add_u32 s34, s27, 0
    buffer_load_dwordx4 v18, s[12:15], s34 offen lds
    v_mfma_f32_32x32x16_bf16 v[144:159], v[220:223], v[212:215], v[144:159]
    s_add_u32 m0, s32, 4096
    s_add_u32 s34, s27, 512
    buffer_load_dwordx4 v18, s[12:15], s34 offen lds
    v_mfma_f32_32x32x16_bf16 v[160:175], v[224:227], v[212:215], v[160:175]
    s_add_u32 m0, s32, 8192
    s_add_u32 s34, s27, 8192
    buffer_load_dwordx4 v18, s[12:15], s34 offen lds
    v_mfma_f32_32x32x16_bf16 v[176:191], v[228:231], v[212:215], v[176:191]
    s_add_u32 m0, s32, 12288
    s_add_u32 s34, s27, 8704
    buffer_load_dwordx4 v18, s[12:15], s34 offen lds
    s_waitcnt lgkmcnt(0)
    ds_read_b128 v[212:215], v89
    ds_read_b64_tr_b16 v[216:217], v92 offset:4096
    ds_read_b64_tr_b16 v[218:219], v92 offset:5120
    ds_read_b64_tr_b16 v[220:221], v93 offset:4096
    ds_read_b64_tr_b16 v[222:223], v93 offset:5120
    ds_read_b64_tr_b16 v[224:225], v94 offset:4096
    ds_read_b64_tr_b16 v[226:227], v94 offset:5120
    ds_read_b64_tr_b16 v[228:229], v95 offset:4096
    ds_read_b64_tr_b16 v[230:231], v95 offset:5120
    v_mfma_f32_32x32x16_bf16 v[128:143], v[196:199], v[192:195], v[128:143]
    v_mfma_f32_32x32x16_bf16 v[144:159], v[200:203], v[192:195], v[144:159]
    v_mfma_f32_32x32x16_bf16 v[160:175], v[204:207], v[192:195], v[160:175]
    v_mfma_f32_32x32x16_bf16 v[176:191], v[208:211], v[192:195], v[176:191]
    s_waitcnt lgkmcnt(0)
    ds_read_b128 v[192:195], v90
    ds_read_b64_tr_b16 v[196:197], v92 offset:8192
    ds_read_b64_tr_b16 v[198:199], v92 offset:9216
    ds_read_b64_tr_b16 v[200:201], v93 offset:8192
    ds_read_b64_tr_b16 v[202:203], v93 offset:9216
    ds_read_b64_tr_b16 v[204:205], v94 offset:8192
    ds_read_b64_tr_b16 v[206:207], v94 offset:9216
    ds_read_b64_tr_b16 v[208:209], v95 offset:8192
    ds_read_b64_tr_b16 v[210:211], v95 offset:9216
    v_mfma_f32_32x32x16_bf16 v[128:143], v[216:219], v[212:215], v[128:143]
    v_mfma_f32_32x32x16_bf16 v[144:159], v[220:223], v[212:215], v[144:159]
    v_mfma_f32_32x32x16_bf16 v[160:175], v[224:227], v[212:215], v[160:175]
    v_mfma_f32_32x32x16_bf16 v[176:191], v[228:231], v[212:215], v[176:191]
    s_waitcnt lgkmcnt(0)
    ds_read_b128 v[212:215], v91
    ds_read_b64_tr_b16 v[216:217], v92 offset:12288
    ds_read_b64_tr_b16 v[218:219], v92 offset:13312
    ds_read_b64_tr_b16 v[220:221], v93 offset:12288
    ds_read_b64_tr_b16 v[222:223], v93 offset:13312
    ds_read_b64_tr_b16 v[224:225], v94 offset:12288
    ds_read_b64_tr_b16 v[226:227], v94 offset:13312
    ds_read_b64_tr_b16 v[228:229], v95 offset:12288
    ds_read_b64_tr_b16 v[230:231], v95 offset:13312
    v_mfma_f32_32x32x16_bf16 v[128:143], v[196:199], v[192:195], v[128:143]
    v_mfma_f32_32x32x16_bf16 v[144:159], v[200:203], v[192:195], v[144:159]
    v_mfma_f32_32x32x16_bf16 v[160:175], v[204:207], v[192:195], v[160:175]
    v_mfma_f32_32x32x16_bf16 v[176:191], v[208:211], v[192:195], v[176:191]
    s_waitcnt lgkmcnt(0)
    v_mfma_f32_32x32x16_bf16 v[128:143], v[216:219], v[212:215], v[128:143]
    v_mfma_f32_32x32x16_bf16 v[144:159], v[220:223], v[212:215], v[144:159]
    v_mfma_f32_32x32x16_bf16 v[160:175], v[224:227], v[212:215], v[160:175]
    v_mfma_f32_32x32x16_bf16 v[176:191], v[228:231], v[212:215], v[176:191]
    s_load_dwordx4 s[8:11], s[0:1], 56
    s_load_dwordx2 s[48:49], s[0:1], 72
    v_and_b32 v38, 7, v1
    v_min_u32 v38, 6, v38
    v_lshlrev_b32 v38, 7, v38
    s_load_dwordx2 s[44:45], s[0:1], 40
    v_and_b32 v36, 15, v1
    v_lshlrev_b32 v36, 7, v36
    v_lshlrev_b32 v11, 4, v1
    s_lshl_b32 s50, s30, 13
    s_add_u32 s50, s50, 131072
    v_add_u32 v11, s50, v11
    v_mov_b32 v34, 0
    v_mov_b32 v35, 0
    v_mov_b32 v240, 0
    v_mov_b32 v241, 0
    v_mov_b32 v242, 0
    v_mov_b32 v243, 0
    v_mov_b32 v244, 0
    v_mov_b32 v245, 0
    v_mov_b32 v246, 0
    v_mov_b32 v247, 0
    v_mov_b32 v248, 0
    v_mov_b32 v249, 0
    v_mov_b32 v250, 0
    v_mov_b32 v251, 0
    v_mov_b32 v252, 0
    v_mov_b32 v253, 0
    v_mov_b32 v254, 0
    v_mov_b32 v255, 0
    s_mov_b32 s70, s58
    s_mov_b32 s71, 0
    v_mul_f32 v128, s60, v128
    v_mul_f32 v129, s60, v129
    v_cvt_pk_bf16_f32 v48, v128, v129
    v_mul_f32 v130, s60, v130
    v_mul_f32 v131, s60, v131
    v_cvt_pk_bf16_f32 v49, v130, v131
    v_mul_f32 v132, s60, v132
    v_mul_f32 v133, s60, v133
    v_cvt_pk_bf16_f32 v50, v132, v133
    v_mul_f32 v134, s60, v134
    v_mul_f32 v135, s60, v135
    v_cvt_pk_bf16_f32 v51, v134, v135
    v_mul_f32 v136, s60, v136
    v_mul_f32 v137, s60, v137
    v_cvt_pk_bf16_f32 v52, v136, v137
    v_mul_f32 v138, s60, v138
    v_mul_f32 v139, s60, v139
    v_cvt_pk_bf16_f32 v53, v138, v139
    v_mul_f32 v140, s60, v140
    v_mul_f32 v141, s60, v141
    v_cvt_pk_bf16_f32 v54, v140, v141
    v_mul_f32 v142, s60, v142
    v_mul_f32 v143, s60, v143
    v_cvt_pk_bf16_f32 v55, v142, v143
    v_mul_f32 v144, s60, v144
    v_mul_f32 v145, s60, v145
    v_cvt_pk_bf16_f32 v56, v144, v145
    v_mul_f32 v146, s60, v146
    v_mul_f32 v147, s60, v147
    v_cvt_pk_bf16_f32 v57, v146, v147
    v_mul_f32 v148, s60, v148
    v_mul_f32 v149, s60, v149
    v_cvt_pk_bf16_f32 v58, v148, v149
    v_mul_f32 v150, s60, v150
    v_mul_f32 v151, s60, v151
    v_cvt_pk_bf16_f32 v59, v150, v151
    v_mul_f32 v152, s60, v152
    v_mul_f32 v153, s60, v153
    v_cvt_pk_bf16_f32 v60, v152, v153
    v_mul_f32 v154, s60, v154
    v_mul_f32 v155, s60, v155
    v_cvt_pk_bf16_f32 v61, v154, v155
    v_mul_f32 v156, s60, v156
    v_mul_f32 v157, s60, v157
    v_cvt_pk_bf16_f32 v62, v156, v157
    v_mul_f32 v158, s60, v158
    v_mul_f32 v159, s60, v159
    v_cvt_pk_bf16_f32 v63, v158, v159
    v_mul_f32 v160, s60, v160
    v_mul_f32 v161, s60, v161
    v_cvt_pk_bf16_f32 v64, v160, v161
    v_mul_f32 v162, s60, v162
    v_mul_f32 v163, s60, v163
    v_cvt_pk_bf16_f32 v65, v162, v163
    v_mul_f32 v164, s60, v164
    v_mul_f32 v165, s60, v165
    v_cvt_pk_bf16_f32 v66, v164, v165
    v_mul_f32 v166, s60, v166
    v_mul_f32 v167, s60, v167
    v_cvt_pk_bf16_f32 v67, v166, v167
    v_mul_f32 v168, s60, v168
    v_mul_f32 v169, s60, v169
    v_cvt_pk_bf16_f32 v68, v168, v169
    v_mul_f32 v170, s60, v170
    v_mul_f32 v171, s60, v171
    v_cvt_pk_bf16_f32 v69, v170, v171
    v_mul_f32 v172, s60, v172
    v_mul_f32 v173, s60, v173
    v_cvt_pk_bf16_f32 v70, v172, v173
    v_mul_f32 v174, s60, v174
    v_mul_f32 v175, s60, v175
    v_cvt_pk_bf16_f32 v71, v174, v175
    v_mul_f32 v176, s60, v176
    v_mul_f32 v177, s60, v177
    v_cvt_pk_bf16_f32 v72, v176, v177
    v_mul_f32 v178, s60, v178
    v_mul_f32 v179, s60, v179
    v_cvt_pk_bf16_f32 v73, v178, v179
    v_mul_f32 v180, s60, v180
    v_mul_f32 v181, s60, v181
    v_cvt_pk_bf16_f32 v74, v180, v181
    v_mul_f32 v182, s60, v182
    v_mul_f32 v183, s60, v183
    v_cvt_pk_bf16_f32 v75, v182, v183
    v_mul_f32 v184, s60, v184
    v_mul_f32 v185, s60, v185
    v_cvt_pk_bf16_f32 v76, v184, v185
    v_mul_f32 v186, s60, v186
    v_mul_f32 v187, s60, v187
    v_cvt_pk_bf16_f32 v77, v186, v187
    v_mul_f32 v188, s60, v188
    v_mul_f32 v189, s60, v189
    v_cvt_pk_bf16_f32 v78, v188, v189
    v_mul_f32 v190, s60, v190
    v_mul_f32 v191, s60, v191
    v_cvt_pk_bf16_f32 v79, v190, v191
    s_cmp_eq_u32 s29, 0
    s_cbranch_scc1 .ng1_9
    ds_write_b128 v11, v[48:51] offset:0
    ds_write_b128 v11, v[52:55] offset:1024
    ds_write_b128 v11, v[56:59] offset:2048
    ds_write_b128 v11, v[60:63] offset:3072
    ds_write_b128 v11, v[64:67] offset:4096
    ds_write_b128 v11, v[68:71] offset:5120
    ds_write_b128 v11, v[72:75] offset:6144
    ds_write_b128 v11, v[76:79] offset:7168
    s_waitcnt vmcnt(0) lgkmcnt(0)
    s_barrier
.ng1_9:
    s_waitcnt vmcnt(0) lgkmcnt(0)
    s_barrier
    s_lshl_b32 s27, s55, 14
    s_add_u32 s56, s55, 1
    s_add_u32 s50, s54, 1
    s_cmp_eq_u32 s50, s57
    s_cselect_b32 s56, 0, s56
    s_lshl_b32 s62, s56, 14
    ds_read_b128 v[208:211], v20 offset:0
    ds_read_b128 v[212:215], v20 offset:8192
    ds_read_b128 v[216:219], v21 offset:0
    ds_read_b128 v[220:223], v21 offset:8192
    ds_read_b128 v[224:227], v22 offset:0
    ds_read_b128 v[228:231], v22 offset:8192
    s_mov_b32 s4, s44
    s_and_b32 s5, s45, 0xffff
    s_mov_b32 s6, 0x400000
    s_mov_b32 s7, 0x20000
    s_lshl_b32 s65, s2, 3
    s_add_u32 s65, s65, s28
    s_mul_i32 s91, s65, 896
    s_lshl_b32 s65, s65, 11
    s_add_u32 m0, s31, 0
    s_add_u32 s34, s27, 0
    buffer_load_dwordx4 v19, s[16:19], s34 offen lds
    s_add_u32 m0, s31, 4096
    s_add_u32 s34, s27, 512
    buffer_load_dwordx4 v19, s[16:19], s34 offen lds
    s_add_u32 m0, s31, 8192
    s_add_u32 s34, s27, 8192
    buffer_load_dwordx4 v19, s[16:19], s34 offen lds
    s_add_u32 m0, s31, 12288
    s_add_u32 s34, s27, 8704
    buffer_load_dwordx4 v19, s[16:19], s34 offen lds
    s_add_u32 m0, s32, 16384
    s_add_u32 s34, s62, 0
    buffer_load_dwordx4 v18, s[12:15], s34 offen lds
    s_add_u32 m0, s32, 20480
    s_add_u32 s34, s62, 512
    buffer_load_dwordx4 v18, s[12:15], s34 offen lds
    s_add_u32 m0, s32, 24576
    s_add_u32 s34, s62, 8192
    buffer_load_dwordx4 v18, s[12:15], s34 offen lds
    s_add_u32 m0, s32, 28672
    s_add_u32 s34, s62, 8704
    buffer_load_dwordx4 v18, s[12:15], s34 offen lds
    s_branch .qk_11
.loop_10:
    s_cmp_lg_u32 s64, 0
    s_cbranch_scc1 .lz_12
    s_waitcnt lgkmcnt(10)
    v_mfma_f32_32x32x16_bf16 v[128:143], v[192:195], v[112:115], v[128:143]
    ds_read_b64_tr_b16 v[216:217], v30 offset:20480
    ds_read_b64_tr_b16 v[218:219], v30 offset:22528
    s_add_u32 m0, s31, 0
    s_add_u32 s34, s27, 0
    buffer_load_dwordx4 v19, s[16:19], s34 offen lds
    s_waitcnt lgkmcnt(10)
    v_mfma_f32_32x32x16_bf16 v[144:159], v[196:199], v[112:115], v[144:159]
    ds_read_b64_tr_b16 v[220:221], v31 offset:20480
    ds_read_b64_tr_b16 v[222:223], v31 offset:22528
    s_add_u32 m0, s31, 4096
    s_add_u32 s34, s27, 512
    buffer_load_dwordx4 v19, s[16:19], s34 offen lds
    s_waitcnt lgkmcnt(10)
    v_mfma_f32_32x32x16_bf16 v[160:175], v[200:203], v[112:115], v[160:175]
    ds_read_b64_tr_b16 v[224:225], v28 offset:24576
    ds_read_b64_tr_b16 v[226:227], v28 offset:26624
    s_add_u32 m0, s31, 8192
    s_add_u32 s34, s27, 8192
    buffer_load_dwordx4 v19, s[16:19], s34 offen lds
    s_waitcnt lgkmcnt(10)
    v_mfma_f32_32x32x16_bf16 v[176:191], v[204:207], v[112:115], v[176:191]
    ds_read_b64_tr_b16 v[228:229], v29 offset:24576
    ds_read_b64_tr_b16 v[230:231], v29 offset:26624
    s_add_u32 m0, s31, 12288
    s_add_u32 s34, s27, 8704
    buffer_load_dwordx4 v19, s[16:19], s34 offen lds
.lj_13:
    s_waitcnt lgkmcnt(10)
    v_mfma_f32_32x32x16_bf16 v[128:143], v[208:211], v[116:119], v[128:143]
    ds_read_b64_tr_b16 v[232:233], v30 offset:24576
    ds_read_b64_tr_b16 v[234:235], v30 offset:26624
    s_add_u32 m0, s32, 16384
    s_add_u32 s34, s62, 0
    buffer_load_dwordx4 v18, s[12:15], s34 offen lds
    s_waitcnt lgkmcnt(10)
    v_mfma_f32_32x32x16_bf16 v[144:159], v[212:215], v[116:119], v[144:159]
    ds_read_b64_tr_b16 v[236:237], v31 offset:24576
    ds_read_b64_tr_b16 v[238:239], v31 offset:26624
    s_add_u32 m0, s32, 20480
    s_add_u32 s34, s62, 512
    buffer_load_dwordx4 v18, s[12:15], s34 offen lds
    s_waitcnt lgkmcnt(10)
    v_mfma_f32_32x32x16_bf16 v[160:175], v[216:219], v[116:119], v[160:175]
    ds_read_b64_tr_b16 v[192:193], v28 offset:28672
    ds_read_b64_tr_b16 v[194:195], v28 offset:30720
    s_add_u32 m0, s32, 24576
    s_add_u32 s34, s62, 8192
    buffer_load_dwordx4 v18, s[12:15], s34 offen lds
    s_waitcnt lgkmcnt(10)
    v_mfma_f32_32x32x16_bf16 v[176:191], v[220:223], v[116:119], v[176:191]
    ds_read_b64_tr_b16 v[196:197], v29 offset:28672
    ds_read_b64_tr_b16 v[198:199], v29 offset:30720
    s_add_u32 m0, s32, 28672
    s_add_u32 s34, s62, 8704
    buffer_load_dwordx4 v18, s[12:15], s34 offen lds
    s_waitcnt lgkmcnt(10)
    v_mfma_f32_32x32x16_bf16 v[128:143], v[224:227], v[120:123], v[128:143]
    ds_read_b64_tr_b16 v[200:201], v30 offset:28672
    ds_read_b64_tr_b16 v[202:203], v30 offset:30720
    s_cmp_lg_u32 s54, 8
    s_cbranch_scc1 .sk_14
    s_mov_b32 s4, s8
    s_and_b32 s5, s9, 0xffff
    s_mov_b32 s6, 0x1c0000
    s_mov_b32 s7, 0x20000
    buffer_load_dword v37, v38, s[4:7], s91 offen offset:0
    s_mov_b32 s4, s10
    s_and_b32 s5, s11, 0xffff
    s_mov_b32 s6, 0x1c0000
    s_mov_b32 s7, 0x20000
    buffer_load_dword v37, v38, s[4:7], s91 offen offset:0
.sk_14:
    s_waitcnt lgkmcnt(10)
    v_mfma_f32_32x32x16_bf16 v[144:159], v[228:231], v[120:123], v[144:159]
    ds_read_b64_tr_b16 v[204:205], v31 offset:28672
    ds_read_b64_tr_b16 v[206:207], v31 offset:30720
    s_waitcnt lgkmcnt(10)
    v_mfma_f32_32x32x16_bf16 v[160:175], v[232:235], v[120:123], v[160:175]
    ds_read_b128 v[208:211], v20 offset:0
    s_waitcnt lgkmcnt(9)
    v_mfma_f32_32x32x16_bf16 v[176:191], v[236:239], v[120:123], v[176:191]
    ds_read_b128 v[212:215], v20 offset:8192
    s_waitcnt lgkmcnt(8)
    v_mfma_f32_32x32x16_bf16 v[128:143], v[192:195], v[124:127], v[128:143]
    ds_read_b128 v[216:219], v21 offset:0
    s_waitcnt lgkmcnt(7)
    v_mfma_f32_32x32x16_bf16 v[144:159], v[196:199], v[124:127], v[144:159]
    ds_read_b128 v[220:223], v21 offset:8192
    s_waitcnt lgkmcnt(6)
    v_mfma_f32_32x32x16_bf16 v[160:175], v[200:203], v[124:127], v[160:175]
    ds_read_b128 v[224:227], v22 offset:0
    s_waitcnt lgkmcnt(5)
    v_mfma_f32_32x32x16_bf16 v[176:191], v[204:207], v[124:127], v[176:191]
    ds_read_b128 v[228:231], v22 offset:8192
.qk_11:
    s_waitcnt lgkmcnt(5)
    v_mfma_f32_32x32x16_bf16 v[80:95], v[208:211], v[48:51], v[240:255]
    ds_read_b128 v[232:235], v23 offset:0
    s_waitcnt lgkmcnt(5)
    v_mfma_f32_32x32x16_bf16 v[96:111], v[212:215], v[48:51], v[240:255]
    ds_read_b128 v[236:239], v23 offset:8192
    s_waitcnt lgkmcnt(5)
    v_mfma_f32_32x32x16_bf16 v[80:95], v[216:219], v[52:55], v[80:95]
    ds_read_b128 v[192:195], v24 offset:0
    s_waitcnt lgkmcnt(5)
    v_mfma_f32_32x32x16_bf16 v[96:111], v[220:223], v[52:55], v[96:111]
    ds_read_b128 v[196:199], v24 offset:8192
    s_waitcnt lgkmcnt(5)
    v_mfma_f32_32x32x16_bf16 v[80:95], v[224:227], v[56:59], v[80:95]
    ds_read_b128 v[200:203], v25 offset:0
    s_waitcnt lgkmcnt(5)
    v_mfma_f32_32x32x16_bf16 v[96:111], v[228:231], v[56:59], v[96:111]
    ds_read_b128 v[204:207], v25 offset:8192
    s_waitcnt lgkmcnt(5)
    v_mfma_f32_32x32x16_bf16 v[80:95], v[232:235], v[60:63], v[80:95]
    ds_read_b128 v[208:211], v26 offset:0
    s_waitcnt lgkmcnt(5)
    v_mfma_f32_32x32x16_bf16 v[96:111], v[236:239], v[60:63], v[96:111]
    ds_read_b128 v[212:215], v26 offset:8192
    s_waitcnt lgkmcnt(5)
    v_mfma_f32_32x32x16_bf16 v[80:95], v[192:195], v[64:67], v[80:95]
    ds_read_b128 v[216:219], v27 offset:0
    s_waitcnt lgkmcnt(5)
    v_mfma_f32_32x32x16_bf16 v[96:111], v[196:199], v[64:67], v[96:111]
    ds_read_b128 v[220:223], v27 offset:8192
    s_waitcnt lgkmcnt(5)
    v_mfma_f32_32x32x16_bf16 v[80:95], v[200:203], v[68:71], v[80:95]
    s_waitcnt lgkmcnt(4)
    v_mfma_f32_32x32x16_bf16 v[96:111], v[204:207], v[68:71], v[96:111]
    s_waitcnt lgkmcnt(3)
    v_mfma_f32_32x32x16_bf16 v[80:95], v[208:211], v[72:75], v[80:95]
    s_waitcnt lgkmcnt(2)
    v_mfma_f32_32x32x16_bf16 v[96:111], v[212:215], v[72:75], v[96:111]
    s_waitcnt lgkmcnt(1)
    v_mfma_f32_32x32x16_bf16 v[80:95], v[216:219], v[76:79], v[80:95]
    s_waitcnt lgkmcnt(0)
    v_mfma_f32_32x32x16_bf16 v[96:111], v[220:223], v[76:79], v[96:111]
    s_lshl_b32 s50, s55, 6
    s_nop 5
    s_waitcnt vmcnt(4)
    s_barrier
    s_cmp_lg_u32 s54, s57
    s_cbranch_scc1 .nofin_15
    v_add_f32 v34, v34, v35
    v_mov_b32 v40, v34
    s_nop 1
    v_permlane32_swap_b32 v34, v40
    s_nop 1
    v_add_f32 v34, v34, v40
    v_rcp_f32 v42, v34
    s_lshl_b32 s51, s59, 13
    s_lshl_b32 s63, s26, 5
    s_add_u32 s51, s51, s63
    s_add_u32 s63, s51, 4096
    v_lshlrev_b32 v13, 5, v4
    v_lshl_add_u32 v13, v5, 4, v13
    v_mul_f32 v128, v128, v42
    v_mul_f32 v129, v129, v42
    v_mul_f32 v130, v130, v42
    v_mul_f32 v131, v131, v42
    v_mul_f32 v132, v132, v42
    v_mul_f32 v133, v133, v42
    v_mul_f32 v134, v134, v42
    v_mul_f32 v135, v135, v42
    v_mul_f32 v136, v136, v42
    v_mul_f32 v137, v137, v42
    v_mul_f32 v138, v138, v42
    v_mul_f32 v139, v139, v42
    v_mul_f32 v140, v140, v42
    v_mul_f32 v141, v141, v42
    v_mul_f32 v142, v142, v42
    v_mul_f32 v143, v143, v42
    v_cvt_pk_bf16_f32 v192, v128, v129
    v_cvt_pk_bf16_f32 v193, v130, v131
    v_cvt_pk_bf16_f32 v194, v132, v133
    v_cvt_pk_bf16_f32 v195, v134, v135
    buffer_store_dwordx4 v[192:195], v13, s[20:23], s51 offen offset:0
    v_cvt_pk_bf16_f32 v196, v136, v137
    v_cvt_pk_bf16_f32 v197, v138, v139
    v_cvt_pk_bf16_f32 v198, v140, v141
    v_cvt_pk_bf16_f32 v199, v142, v143
    buffer_store_dwordx4 v[196:199], v13, s[20:23], s51 offen offset:1024
    v_mul_f32 v144, v144, v42
    v_mul_f32 v145, v145, v42
    v_mul_f32 v146, v146, v42
    v_mul_f32 v147, v147, v42
    v_mul_f32 v148, v148, v42
    v_mul_f32 v149, v149, v42
    v_mul_f32 v150, v150, v42
    v_mul_f32 v151, v151, v42
    v_mul_f32 v152, v152, v42
    v_mul_f32 v153, v153, v42
    v_mul_f32 v154, v154, v42
    v_mul_f32 v155, v155, v42
    v_mul_f32 v156, v156, v42
    v_mul_f32 v157, v157, v42
    v_mul_f32 v158, v158, v42
    v_mul_f32 v159, v159, v42
    v_cvt_pk_bf16_f32 v200, v144, v145
    v_cvt_pk_bf16_f32 v201, v146, v147
    v_cvt_pk_bf16_f32 v202, v148, v149
    v_cvt_pk_bf16_f32 v203, v150, v151
    buffer_store_dwordx4 v[200:203], v13, s[20:23], s51 offen offset:2048
    v_cvt_pk_bf16_f32 v204, v152, v153
    v_cvt_pk_bf16_f32 v205, v154, v155
    v_cvt_pk_bf16_f32 v206, v156, v157
    v_cvt_pk_bf16_f32 v207, v158, v159
    buffer_store_dwordx4 v[204:207], v13, s[20:23], s51 offen offset:3072
    v_mul_f32 v160, v160, v42
    v_mul_f32 v161, v161, v42
    v_mul_f32 v162, v162, v42
    v_mul_f32 v163, v163, v42
    v_mul_f32 v164, v164, v42
    v_mul_f32 v165, v165, v42
    v_mul_f32 v166, v166, v42
    v_mul_f32 v167, v167, v42
    v_mul_f32 v168, v168, v42
    v_mul_f32 v169, v169, v42
    v_mul_f32 v170, v170, v42
    v_mul_f32 v171, v171, v42
    v_mul_f32 v172, v172, v42
    v_mul_f32 v173, v173, v42
    v_mul_f32 v174, v174, v42
    v_mul_f32 v175, v175, v42
    v_cvt_pk_bf16_f32 v208, v160, v161
    v_cvt_pk_bf16_f32 v209, v162, v163
    v_cvt_pk_bf16_f32 v210, v164, v165
    v_cvt_pk_bf16_f32 v211, v166, v167
    buffer_store_dwordx4 v[208:211], v13, s[20:23], s63 offen offset:0
    v_cvt_pk_bf16_f32 v212, v168, v169
    v_cvt_pk_bf16_f32 v213, v170, v171
    v_cvt_pk_bf16_f32 v214, v172, v173
    v_cvt_pk_bf16_f32 v215, v174, v175
    buffer_store_dwordx4 v[212:215], v13, s[20:23], s63 offen offset:1024
    v_mul_f32 v176, v176, v42
    v_mul_f32 v177, v177, v42
    v_mul_f32 v178, v178, v42
    v_mul_f32 v179, v179, v42
    v_mul_f32 v180, v180, v42
    v_mul_f32 v181, v181, v42
    v_mul_f32 v182, v182, v42
    v_mul_f32 v183, v183, v42
    v_mul_f32 v184, v184, v42
    v_mul_f32 v185, v185, v42
    v_mul_f32 v186, v186, v42
    v_mul_f32 v187, v187, v42
    v_mul_f32 v188, v188, v42
    v_mul_f32 v189, v189, v42
    v_mul_f32 v190, v190, v42
    v_mul_f32 v191, v191, v42
    v_cvt_pk_bf16_f32 v216, v176, v177
    v_cvt_pk_bf16_f32 v217, v178, v179
    v_cvt_pk_bf16_f32 v218, v180, v181
    v_cvt_pk_bf16_f32 v219, v182, v183
    buffer_store_dwordx4 v[216:219], v13, s[20:23], s63 offen offset:2048
    v_cvt_pk_bf16_f32 v220, v184, v185
    v_cvt_pk_bf16_f32 v221, v186, v187
    v_cvt_pk_bf16_f32 v222, v188, v189
    v_cvt_pk_bf16_f32 v223, v190, v191
    buffer_store_dwordx4 v[220:223], v13, s[20:23], s63 offen offset:3072
    s_mov_b32 s70, s58
    s_mov_b32 s71, 0
    s_lshl_b32 s59, s39, 7
    s_lshl_b32 s51, s30, 5
    s_add_u32 s59, s59, s51
.nofin_15:
    s_sub_i32 s50, s59, s50
    s_cmp_ge_i32 s50, 63
    s_cbranch_scc1 .nomask_16
    v_mov_b32 v40, s58
    s_cmp_gt_i32 s50, 0
    s_cbranch_scc1 .nx_17
    s_cmp_lt_i32 s50, 0
    s_cbranch_scc1 .fu_18
    v_cndmask_b32 v80, v40, v80, s[66:67]
    v_cndmask_b32 v81, v40, v81, s[68:69]
    v_cndmask_b32 v82, v40, v82, s[72:73]
    v_cndmask_b32 v83, v40, v83, s[74:75]
    v_cndmask_b32 v84, v40, v84, s[76:77]
    v_cndmask_b32 v85, v40, v85, s[78:79]
    v_cndmask_b32 v86, v40, v86, s[84:85]
    v_cndmask_b32 v87, v40, v87, s[86:87]
    v_cndmask_b32 v88, v40, v88, s[88:89]
    v_cndmask_b32 v89, v40, v89, s[92:93]
    v_cndmask_b32 v90, v40, v90, s[94:95]
    v_cndmask_b32 v91, v40, v91, s[96:97]
    v_cndmask_b32 v92, v40, v92, s[98:99]
    v_cndmask_b32 v93, v40, v93, s[100:101]
    v_cndmask_b32 v94, v40, v94, s[40:41]
    v_cndmask_b32 v95, v40, v95, s[42:43]
    s_branch .nx_17
.fu_18:
    v_mov_b32 v80, s58
    v_mov_b32 v81, s58
    v_mov_b32 v82, s58
    v_mov_b32 v83, s58
    v_mov_b32 v84, s58
    v_mov_b32 v85, s58
    v_mov_b32 v86, s58
    v_mov_b32 v87, s58
    v_mov_b32 v88, s58
    v_mov_b32 v89, s58
    v_mov_b32 v90, s58
    v_mov_b32 v91, s58
    v_mov_b32 v92, s58
    v_mov_b32 v93, s58
    v_mov_b32 v94, s58
    v_mov_b32 v95, s58
.nx_17:
    s_cmp_lt_i32 s50, 32
    s_cbranch_scc1 .fu_20
    v_cndmask_b32 v96, v40, v96, s[66:67]
    v_cndmask_b32 v97, v40, v97, s[68:69]
    v_cndmask_b32 v98, v40, v98, s[72:73]
    v_cndmask_b32 v99, v40, v99, s[74:75]
    v_cndmask_b32 v100, v40, v100, s[76:77]
    v_cndmask_b32 v101, v40, v101, s[78:79]
    v_cndmask_b32 v102, v40, v102, s[84:85]
    v_cndmask_b32 v103, v40, v103, s[86:87]
    v_cndmask_b32 v104, v40, v104, s[88:89]
    v_cndmask_b32 v105, v40, v105, s[92:93]
    v_cndmask_b32 v106, v40, v106, s[94:95]
    v_cndmask_b32 v107, v40, v107, s[96:97]
    v_cndmask_b32 v108, v40, v108, s[98:99]
    v_cndmask_b32 v109, v40, v109, s[100:101]
    v_cndmask_b32 v110, v40, v110, s[40:41]
    v_cndmask_b32 v111, v40, v111, s[42:43]
    s_branch .nx_19
.fu_20:
    v_mov_b32 v96, s58
    v_mov_b32 v97, s58
    v_mov_b32 v98, s58
    v_mov_b32 v99, s58
    v_mov_b32 v100, s58
    v_mov_b32 v101, s58
    v_mov_b32 v102, s58
    v_mov_b32 v103, s58
    v_mov_b32 v104, s58
    v_mov_b32 v105, s58
    v_mov_b32 v106, s58
    v_mov_b32 v107, s58
    v_mov_b32 v108, s58
    v_mov_b32 v109, s58
    v_mov_b32 v110, s58
    v_mov_b32 v111, s58
.nx_19:
.nomask_16:
    v_max3_f32 v39, v80, v81, v82
    v_max3_f32 v40, v83, v84, v85
    v_max3_f32 v39, v39, v86, v87
    v_max3_f32 v40, v40, v88, v89
    v_max3_f32 v39, v39, v90, v91
    v_max3_f32 v40, v40, v92, v93
    v_max3_f32 v39, v39, v94, v95
    v_max3_f32 v40, v40, v96, v97
    v_max3_f32 v39, v39, v98, v99
    v_max3_f32 v40, v40, v100, v101
    v_max3_f32 v39, v39, v102, v103
    v_max3_f32 v40, v40, v104, v105
    v_max3_f32 v39, v39, v106, v107
    v_max3_f32 v40, v40, v108, v109
    v_max3_f32 v39, v39, v110, v111
    v_max_f32 v39, v39, v40
    v_cmp_lt_f32 vcc, s70, v39
    s_cbranch_vccz .nores_21
    v_mov_b32 v40, v39
    s_min_i32 s51, s70, 0
    s_nop 0
    v_permlane32_swap_b32 v39, v40
    s_nop 1
    v_max3_f32 v39, v39, v40, s51
    v_exp_f32 v42, -v39
    v_sub_f32 v240, v240, v39
    v_sub_f32 v241, v241, v39
    v_sub_f32 v242, v242, v39
    v_sub_f32 v243, v243, v39
    v_sub_f32 v244, v244, v39
    v_sub_f32 v245, v245, v39
    v_sub_f32 v246, v246, v39
    v_sub_f32 v247, v247, v39
    v_sub_f32 v248, v248, v39
    v_sub_f32 v249, v249, v39
    v_sub_f32 v250, v250, v39
    v_sub_f32 v251, v251, v39
    v_sub_f32 v252, v252, v39
    v_sub_f32 v253, v253, v39
    v_sub_f32 v254, v254, v39
    v_sub_f32 v255, v255, v39
    v_min_f32 v42, 1.0, v42
    v_mul_f32 v42, s71, v42
    v_sub_f32 v80, v80, v39
    v_sub_f32 v81, v81, v39
    v_sub_f32 v82, v82, v39
    v_sub_f32 v83, v83, v39
    v_sub_f32 v84, v84, v39
    v_sub_f32 v85, v85, v39
    v_sub_f32 v86, v86, v39
    v_sub_f32 v87, v87, v39
    v_sub_f32 v88, v88, v39
    v_sub_f32 v89, v89, v39
    v_sub_f32 v90, v90, v39
    v_sub_f32 v91, v91, v39
    v_sub_f32 v92, v92, v39
    v_sub_f32 v93, v93, v39
    v_sub_f32 v94, v94, v39
    v_sub_f32 v95, v95, v39
    v_sub_f32 v96, v96, v39
    v_sub_f32 v97, v97, v39
    v_sub_f32 v98, v98, v39
    v_sub_f32 v99, v99, v39
    v_sub_f32 v100, v100, v39
    v_sub_f32 v101, v101, v39
    v_sub_f32 v102, v102, v39
    v_sub_f32 v103, v103, v39
    v_sub_f32 v104, v104, v39
    v_sub_f32 v105, v105, v39
    v_sub_f32 v106, v106, v39
    v_sub_f32 v107, v107, v39
    v_sub_f32 v108, v108, v39
    v_sub_f32 v109, v109, v39
    v_sub_f32 v110, v110, v39
    v_sub_f32 v111, v111, v39
    v_mul_f32 v34, v34, v42
    v_mul_f32 v35, v35, v42
    s_cmp_eq_u32 s71, 0
    s_cselect_b32 s64, 1, 0
    s_cbranch_scc1 .nomul_22
    v_mul_f32 v128, v128, v42
    v_mul_f32 v129, v129, v42
    v_mul_f32 v130, v130, v42
    v_mul_f32 v131, v131, v42
    v_mul_f32 v132, v132, v42
    v_mul_f32 v133, v133, v42
    v_mul_f32 v134, v134, v42
    v_mul_f32 v135, v135, v42
    v_mul_f32 v136, v136, v42
    v_mul_f32 v137, v137, v42
    v_mul_f32 v138, v138, v42
    v_mul_f32 v139, v139, v42
    v_mul_f32 v140, v140, v42
    v_mul_f32 v141, v141, v42
    v_mul_f32 v142, v142, v42
    v_mul_f32 v143, v143, v42
    v_mul_f32 v144, v144, v42
    v_mul_f32 v145, v145, v42
    v_mul_f32 v146, v146, v42
    v_mul_f32 v147, v147, v42
    v_mul_f32 v148, v148, v42
    v_mul_f32 v149, v149, v42
    v_mul_f32 v150, v150, v42
    v_mul_f32 v151, v151, v42
    v_mul_f32 v152, v152, v42
    v_mul_f32 v153, v153, v42
    v_mul_f32 v154, v154, v42
    v_mul_f32 v155, v155, v42
    v_mul_f32 v156, v156, v42
    v_mul_f32 v157, v157, v42
    v_mul_f32 v158, v158, v42
    v_mul_f32 v159, v159, v42
    v_mul_f32 v160, v160, v42
    v_mul_f32 v161, v161, v42
    v_mul_f32 v162, v162, v42
    v_mul_f32 v163, v163, v42
    v_mul_f32 v164, v164, v42
    v_mul_f32 v165, v165, v42
    v_mul_f32 v166, v166, v42
    v_mul_f32 v167, v167, v42
    v_mul_f32 v168, v168, v42
    v_mul_f32 v169, v169, v42
    v_mul_f32 v170, v170, v42
    v_mul_f32 v171, v171, v42
    v_mul_f32 v172, v172, v42
    v_mul_f32 v173, v173, v42
    v_mul_f32 v174, v174, v42
    v_mul_f32 v175, v175, v42
    v_mul_f32 v176, v176, v42
    v_mul_f32 v177, v177, v42
    v_mul_f32 v178, v178, v42
    v_mul_f32 v179, v179, v42
    v_mul_f32 v180, v180, v42
    v_mul_f32 v181, v181, v42
    v_mul_f32 v182, v182, v42
    v_mul_f32 v183, v183, v42
    v_mul_f32 v184, v184, v42
    v_mul_f32 v185, v185, v42
    v_mul_f32 v186, v186, v42
    v_mul_f32 v187, v187, v42
    v_mul_f32 v188, v188, v42
    v_mul_f32 v189, v189, v42
    v_mul_f32 v190, v190, v42
    v_mul_f32 v191, v191, v42
.nomul_22:
    s_mov_b32 s70, 0x41000000
    s_mov_b32 s71, 1.0
.nores_21:
    s_add_u32 s54, s54, 1
    s_cmp_lg_u32 s54, s57
    s_cbranch_scc1 .noq_23
    ds_read_b128 v[48:51], v11 offset:0
    ds_read_b128 v[52:55], v11 offset:1024
    ds_read_b128 v[56:59], v11 offset:2048
    ds_read_b128 v[60:63], v11 offset:3072
    ds_read_b128 v[64:67], v11 offset:4096
    ds_read_b128 v[68:71], v11 offset:5120
    ds_read_b128 v[72:75], v11 offset:6144
    ds_read_b128 v[76:79], v11 offset:7168
    s_waitcnt lgkmcnt(2)
.noq_23:
    s_mov_b32 s55, s56
    v_exp_f32 v80, v80
    v_exp_f32 v81, v81
    v_exp_f32 v82, v82
    v_exp_f32 v83, v83
    v_cvt_pk_bf16_f32 v112, v80, v81
    v_add_f32 v34, v34, v80
    v_add_f32 v35, v35, v81
    v_exp_f32 v84, v84
    v_exp_f32 v85, v85
    v_cvt_pk_bf16_f32 v113, v82, v83
    v_add_f32 v34, v34, v82
    v_add_f32 v35, v35, v83
    s_lshl_b32 s27, s55, 14
    s_add_u32 s56, s55, 1
    s_add_u32 s50, s54, 1
    s_cmp_eq_u32 s50, s57
    s_cselect_b32 s56, 0, s56
    s_lshl_b32 s62, s56, 14
    v_exp_f32 v86, v86
    v_exp_f32 v87, v87
    v_cvt_pk_bf16_f32 v114, v84, v85
    v_add_f32 v34, v34, v84
    v_add_f32 v35, v35, v85
    v_exp_f32 v88, v88
    v_exp_f32 v89, v89
    v_cvt_pk_bf16_f32 v115, v86, v87
    v_add_f32 v34, v34, v86
    v_add_f32 v35, v35, v87
    v_exp_f32 v90, v90
    v_exp_f32 v91, v91
    v_cvt_pk_bf16_f32 v116, v88, v89
    v_add_f32 v34, v34, v88
    v_add_f32 v35, v35, v89
    v_exp_f32 v92, v92
    v_exp_f32 v93, v93
    v_cvt_pk_bf16_f32 v117, v90, v91
    v_add_f32 v34, v34, v90
    v_add_f32 v35, v35, v91
    v_exp_f32 v94, v94
    v_exp_f32 v95, v95
    v_cvt_pk_bf16_f32 v118, v92, v93
    v_add_f32 v34, v34, v92
    v_add_f32 v35, v35, v93
    v_exp_f32 v96, v96
    v_exp_f32 v97, v97
    v_cvt_pk_bf16_f32 v119, v94, v95
    v_add_f32 v34, v34, v94
    v_add_f32 v35, v35, v95
    ds_read_b64_tr_b16 v[192:193], v28 offset:0
    ds_read_b64_tr_b16 v[194:195], v28 offset:2048
    v_exp_f32 v98, v98
    v_exp_f32 v99, v99
    v_cvt_pk_bf16_f32 v120, v96, v97
    v_add_f32 v34, v34, v96
    v_add_f32 v35, v35, v97
    ds_read_b64_tr_b16 v[196:197], v29 offset:0
    ds_read_b64_tr_b16 v[198:199], v29 offset:2048
    v_exp_f32 v100, v100
    v_exp_f32 v101, v101
    v_cvt_pk_bf16_f32 v121, v98, v99
    v_add_f32 v34, v34, v98
    v_add_f32 v35, v35, v99
    ds_read_b64_tr_b16 v[200:201], v30 offset:0
    ds_read_b64_tr_b16 v[202:203], v30 offset:2048
    v_exp_f32 v102, v102
    v_exp_f32 v103, v103
    v_cvt_pk_bf16_f32 v122, v100, v101
    v_add_f32 v34, v34, v100
    v_add_f32 v35, v35, v101
    ds_read_b64_tr_b16 v[204:205], v31 offset:0
    ds_read_b64_tr_b16 v[206:207], v31 offset:2048
    v_exp_f32 v104, v104
    v_exp_f32 v105, v105
    v_cvt_pk_bf16_f32 v123, v102, v103
    v_add_f32 v34, v34, v102
    v_add_f32 v35, v35, v103
    ds_read_b64_tr_b16 v[208:209], v28 offset:4096
    ds_read_b64_tr_b16 v[210:211], v28 offset:6144
    v_exp_f32 v106, v106
    v_exp_f32 v107, v107
    v_cvt_pk_bf16_f32 v124, v104, v105
    v_add_f32 v34, v34, v104
    v_add_f32 v35, v35, v105
    ds_read_b64_tr_b16 v[212:213], v29 offset:4096
    ds_read_b64_tr_b16 v[214:215], v29 offset:6144
    v_exp_f32 v108, v108
    v_exp_f32 v109, v109
    v_cvt_pk_bf16_f32 v125, v106, v107
    v_add_f32 v34, v34, v106
    v_add_f32 v35, v35, v107
    v_exp_f32 v110, v110
    v_exp_f32 v111, v111
    v_cvt_pk_bf16_f32 v126, v108, v109
    v_add_f32 v34, v34, v108
    v_add_f32 v35, v35, v109
    s_cmp_lt_u32 s54, 17
    v_cvt_pk_bf16_f32 v127, v110, v111
    v_add_f32 v34, v34, v110
    v_add_f32 v35, v35, v111
    s_waitcnt vmcnt(0)
    s_barrier
    s_cbranch_scc0 .Lattn_fin
    s_cmp_lg_u32 s64, 0
    s_cbranch_scc1 .lz_24
    s_waitcnt lgkmcnt(10)
    v_mfma_f32_32x32x16_bf16 v[128:143], v[192:195], v[112:115], v[128:143]
    ds_read_b64_tr_b16 v[216:217], v30 offset:4096
    ds_read_b64_tr_b16 v[218:219], v30 offset:6144
    s_add_u32 m0, s31, 16384
    s_add_u32 s34, s27, 0
    buffer_load_dwordx4 v19, s[16:19], s34 offen lds
    s_waitcnt lgkmcnt(10)
    v_mfma_f32_32x32x16_bf16 v[144:159], v[196:199], v[112:115], v[144:159]
    ds_read_b64_tr_b16 v[220:221], v31 offset:4096
    ds_read_b64_tr_b16 v[222:223], v31 offset:6144
    s_add_u32 m0, s31, 20480
    s_add_u32 s34, s27, 512
    buffer_load_dwordx4 v19, s[16:19], s34 offen lds
    s_waitcnt lgkmcnt(10)
    v_mfma_f32_32x32x16_bf16 v[160:175], v[200:203], v[112:115], v[160:175]
    ds_read_b64_tr_b16 v[224:225], v28 offset:8192
    ds_read_b64_tr_b16 v[226:227], v28 offset:10240
    s_add_u32 m0, s31, 24576
    s_add_u32 s34, s27, 8192
    buffer_load_dwordx4 v19, s[16:19], s34 offen lds
    s_waitcnt lgkmcnt(10)
    v_mfma_f32_32x32x16_bf16 v[176:191], v[204:207], v[112:115], v[176:191]
    ds_read_b64_tr_b16 v[228:229], v29 offset:8192
    ds_read_b64_tr_b16 v[230:231], v29 offset:10240
    s_add_u32 m0, s31, 28672
    s_add_u32 s34, s27, 8704
    buffer_load_dwordx4 v19, s[16:19], s34 offen lds
.lj_25:
    s_waitcnt lgkmcnt(10)
    v_mfma_f32_32x32x16_bf16 v[128:143], v[208:211], v[116:119], v[128:143]
    ds_read_b64_tr_b16 v[232:233], v30 offset:8192
    ds_read_b64_tr_b16 v[234:235], v30 offset:10240
    s_add_u32 m0, s32, 0
    s_add_u32 s34, s62, 0
    buffer_load_dwordx4 v18, s[12:15], s34 offen lds
    s_waitcnt lgkmcnt(10)
    v_mfma_f32_32x32x16_bf16 v[144:159], v[212:215], v[116:119], v[144:159]
    ds_read_b64_tr_b16 v[236:237], v31 offset:8192
    ds_read_b64_tr_b16 v[238:239], v31 offset:10240
    s_add_u32 m0, s32, 4096
    s_add_u32 s34, s62, 512
    buffer_load_dwordx4 v18, s[12:15], s34 offen lds
    s_waitcnt lgkmcnt(10)
    v_mfma_f32_32x32x16_bf16 v[160:175], v[216:219], v[116:119], v[160:175]
    ds_read_b64_tr_b16 v[192:193], v28 offset:12288
    ds_read_b64_tr_b16 v[194:195], v28 offset:14336
    s_add_u32 m0, s32, 8192
    s_add_u32 s34, s62, 8192
    buffer_load_dwordx4 v18, s[12:15], s34 offen lds
    s_waitcnt lgkmcnt(10)
    v_mfma_f32_32x32x16_bf16 v[176:191], v[220:223], v[116:119], v[176:191]
    ds_read_b64_tr_b16 v[196:197], v29 offset:12288
    ds_read_b64_tr_b16 v[198:199], v29 offset:14336
    s_add_u32 m0, s32, 12288
    s_add_u32 s34, s62, 8704
    buffer_load_dwordx4 v18, s[12:15], s34 offen lds
    s_waitcnt lgkmcnt(10)
    v_mfma_f32_32x32x16_bf16 v[128:143], v[224:227], v[120:123], v[128:143]
    ds_read_b64_tr_b16 v[200:201], v30 offset:12288
    ds_read_b64_tr_b16 v[202:203], v30 offset:14336
    s_cmp_lg_u32 s54, 5
    s_cbranch_scc1 .sk_26
    s_mov_b32 s4, s44
    s_and_b32 s5, s45, 0xffff
    s_mov_b32 s6, 0x400000
    s_mov_b32 s7, 0x20000
    buffer_load_dword v37, v36, s[4:7], s65 offen offset:0
.sk_26:
    s_cmp_lg_u32 s54, 11
    s_cbranch_scc1 .sk_27
    s_mov_b32 s4, s48
    s_and_b32 s5, s49, 0xffff
    s_mov_b32 s6, 0x1c0000
    s_mov_b32 s7, 0x20000
    buffer_load_dword v37, v38, s[4:7], s91 offen offset:0
.sk_27:
    s_waitcnt lgkmcnt(10)
    v_mfma_f32_32x32x16_bf16 v[144:159], v[228:231], v[120:123], v[144:159]
    ds_read_b64_tr_b16 v[204:205], v31 offset:12288
    ds_read_b64_tr_b16 v[206:207], v31 offset:14336
    s_waitcnt lgkmcnt(10)
    v_mfma_f32_32x32x16_bf16 v[160:175], v[232:235], v[120:123], v[160:175]
    ds_read_b128 v[208:211], v20 offset:16384
    s_waitcnt lgkmcnt(9)
    v_mfma_f32_32x32x16_bf16 v[176:191], v[236:239], v[120:123], v[176:191]
    ds_read_b128 v[212:215], v20 offset:24576
    s_waitcnt lgkmcnt(8)
    v_mfma_f32_32x32x16_bf16 v[128:143], v[192:195], v[124:127], v[128:143]
    ds_read_b128 v[216:219], v21 offset:16384
    s_waitcnt lgkmcnt(7)
    v_mfma_f32_32x32x16_bf16 v[144:159], v[196:199], v[124:127], v[144:159]
    ds_read_b128 v[220:223], v21 offset:24576
    s_waitcnt lgkmcnt(6)
    v_mfma_f32_32x32x16_bf16 v[160:175], v[200:203], v[124:127], v[160:175]
    ds_read_b128 v[224:227], v22 offset:16384
    s_waitcnt lgkmcnt(5)
    v_mfma_f32_32x32x16_bf16 v[176:191], v[204:207], v[124:127], v[176:191]
    ds_read_b128 v[228:231], v22 offset:24576
    s_waitcnt lgkmcnt(5)
    v_mfma_f32_32x32x16_bf16 v[80:95], v[208:211], v[48:51], v[240:255]
    ds_read_b128 v[232:235], v23 offset:16384
    s_waitcnt lgkmcnt(5)
    v_mfma_f32_32x32x16_bf16 v[96:111], v[212:215], v[48:51], v[240:255]
    ds_read_b128 v[236:239], v23 offset:24576
    s_waitcnt lgkmcnt(5)
    v_mfma_f32_32x32x16_bf16 v[80:95], v[216:219], v[52:55], v[80:95]
    ds_read_b128 v[192:195], v24 offset:16384
    s_waitcnt lgkmcnt(5)
    v_mfma_f32_32x32x16_bf16 v[96:111], v[220:223], v[52:55], v[96:111]
    ds_read_b128 v[196:199], v24 offset:24576
    s_waitcnt lgkmcnt(5)
    v_mfma_f32_32x32x16_bf16 v[80:95], v[224:227], v[56:59], v[80:95]
    ds_read_b128 v[200:203], v25 offset:16384
    s_waitcnt lgkmcnt(5)
    v_mfma_f32_32x32x16_bf16 v[96:111], v[228:231], v[56:59], v[96:111]
    ds_read_b128 v[204:207], v25 offset:24576
    s_waitcnt lgkmcnt(5)
    v_mfma_f32_32x32x16_bf16 v[80:95], v[232:235], v[60:63], v[80:95]
    ds_read_b128 v[208:211], v26 offset:16384
    s_waitcnt lgkmcnt(5)
    v_mfma_f32_32x32x16_bf16 v[96:111], v[236:239], v[60:63], v[96:111]
    ds_read_b128 v[212:215], v26 offset:24576
    s_waitcnt lgkmcnt(5)
    v_mfma_f32_32x32x16_bf16 v[80:95], v[192:195], v[64:67], v[80:95]
    ds_read_b128 v[216:219], v27 offset:16384
    s_waitcnt lgkmcnt(5)
    v_mfma_f32_32x32x16_bf16 v[96:111], v[196:199], v[64:67], v[96:111]
    ds_read_b128 v[220:223], v27 offset:24576
    s_waitcnt lgkmcnt(5)
    v_mfma_f32_32x32x16_bf16 v[80:95], v[200:203], v[68:71], v[80:95]
    s_waitcnt lgkmcnt(4)
    v_mfma_f32_32x32x16_bf16 v[96:111], v[204:207], v[68:71], v[96:111]
    s_waitcnt lgkmcnt(3)
    v_mfma_f32_32x32x16_bf16 v[80:95], v[208:211], v[72:75], v[80:95]
    s_waitcnt lgkmcnt(2)
    v_mfma_f32_32x32x16_bf16 v[96:111], v[212:215], v[72:75], v[96:111]
    s_waitcnt lgkmcnt(1)
    v_mfma_f32_32x32x16_bf16 v[80:95], v[216:219], v[76:79], v[80:95]
    s_waitcnt lgkmcnt(0)
    v_mfma_f32_32x32x16_bf16 v[96:111], v[220:223], v[76:79], v[96:111]
    s_lshl_b32 s50, s55, 6
    s_nop 5
    s_waitcnt vmcnt(4)
    s_barrier
    s_cmp_lg_u32 s54, s57
    s_cbranch_scc1 .nofin_28
    v_add_f32 v34, v34, v35
    v_mov_b32 v40, v34
    s_nop 1
    v_permlane32_swap_b32 v34, v40
    s_nop 1
    v_add_f32 v34, v34, v40
    v_rcp_f32 v42, v34
    s_lshl_b32 s51, s59, 13
    s_lshl_b32 s63, s26, 5
    s_add_u32 s51, s51, s63
    s_add_u32 s63, s51, 4096
    v_lshlrev_b32 v13, 5, v4
    v_lshl_add_u32 v13, v5, 4, v13
    v_mul_f32 v128, v128, v42
    v_mul_f32 v129, v129, v42
    v_mul_f32 v130, v130, v42
    v_mul_f32 v131, v131, v42
    v_mul_f32 v132, v132, v42
    v_mul_f32 v133, v133, v42
    v_mul_f32 v134, v134, v42
    v_mul_f32 v135, v135, v42
    v_mul_f32 v136, v136, v42
    v_mul_f32 v137, v137, v42
    v_mul_f32 v138, v138, v42
    v_mul_f32 v139, v139, v42
    v_mul_f32 v140, v140, v42
    v_mul_f32 v141, v141, v42
    v_mul_f32 v142, v142, v42
    v_mul_f32 v143, v143, v42
    v_cvt_pk_bf16_f32 v192, v128, v129
    v_cvt_pk_bf16_f32 v193, v130, v131
    v_cvt_pk_bf16_f32 v194, v132, v133
    v_cvt_pk_bf16_f32 v195, v134, v135
    buffer_store_dwordx4 v[192:195], v13, s[20:23], s51 offen offset:0
    v_cvt_pk_bf16_f32 v196, v136, v137
    v_cvt_pk_bf16_f32 v197, v138, v139
    v_cvt_pk_bf16_f32 v198, v140, v141
    v_cvt_pk_bf16_f32 v199, v142, v143
    buffer_store_dwordx4 v[196:199], v13, s[20:23], s51 offen offset:1024
    v_mul_f32 v144, v144, v42
    v_mul_f32 v145, v145, v42
    v_mul_f32 v146, v146, v42
    v_mul_f32 v147, v147, v42
    v_mul_f32 v148, v148, v42
    v_mul_f32 v149, v149, v42
    v_mul_f32 v150, v150, v42
    v_mul_f32 v151, v151, v42
    v_mul_f32 v152, v152, v42
    v_mul_f32 v153, v153, v42
    v_mul_f32 v154, v154, v42
    v_mul_f32 v155, v155, v42
    v_mul_f32 v156, v156, v42
    v_mul_f32 v157, v157, v42
    v_mul_f32 v158, v158, v42
    v_mul_f32 v159, v159, v42
    v_cvt_pk_bf16_f32 v200, v144, v145
    v_cvt_pk_bf16_f32 v201, v146, v147
    v_cvt_pk_bf16_f32 v202, v148, v149
    v_cvt_pk_bf16_f32 v203, v150, v151
    buffer_store_dwordx4 v[200:203], v13, s[20:23], s51 offen offset:2048
    v_cvt_pk_bf16_f32 v204, v152, v153
    v_cvt_pk_bf16_f32 v205, v154, v155
    v_cvt_pk_bf16_f32 v206, v156, v157
    v_cvt_pk_bf16_f32 v207, v158, v159
    buffer_store_dwordx4 v[204:207], v13, s[20:23], s51 offen offset:3072
    v_mul_f32 v160, v160, v42
    v_mul_f32 v161, v161, v42
    v_mul_f32 v162, v162, v42
    v_mul_f32 v163, v163, v42
    v_mul_f32 v164, v164, v42
    v_mul_f32 v165, v165, v42
    v_mul_f32 v166, v166, v42
    v_mul_f32 v167, v167, v42
    v_mul_f32 v168, v168, v42
    v_mul_f32 v169, v169, v42
    v_mul_f32 v170, v170, v42
    v_mul_f32 v171, v171, v42
    v_mul_f32 v172, v172, v42
    v_mul_f32 v173, v173, v42
    v_mul_f32 v174, v174, v42
    v_mul_f32 v175, v175, v42
    v_cvt_pk_bf16_f32 v208, v160, v161
    v_cvt_pk_bf16_f32 v209, v162, v163
    v_cvt_pk_bf16_f32 v210, v164, v165
    v_cvt_pk_bf16_f32 v211, v166, v167
    buffer_store_dwordx4 v[208:211], v13, s[20:23], s63 offen offset:0
    v_cvt_pk_bf16_f32 v212, v168, v169
    v_cvt_pk_bf16_f32 v213, v170, v171
    v_cvt_pk_bf16_f32 v214, v172, v173
    v_cvt_pk_bf16_f32 v215, v174, v175
    buffer_store_dwordx4 v[212:215], v13, s[20:23], s63 offen offset:1024
    v_mul_f32 v176, v176, v42
    v_mul_f32 v177, v177, v42
    v_mul_f32 v178, v178, v42
    v_mul_f32 v179, v179, v42
    v_mul_f32 v180, v180, v42
    v_mul_f32 v181, v181, v42
    v_mul_f32 v182, v182, v42
    v_mul_f32 v183, v183, v42
    v_mul_f32 v184, v184, v42
    v_mul_f32 v185, v185, v42
    v_mul_f32 v186, v186, v42
    v_mul_f32 v187, v187, v42
    v_mul_f32 v188, v188, v42
    v_mul_f32 v189, v189, v42
    v_mul_f32 v190, v190, v42
    v_mul_f32 v191, v191, v42
    v_cvt_pk_bf16_f32 v216, v176, v177
    v_cvt_pk_bf16_f32 v217, v178, v179
    v_cvt_pk_bf16_f32 v218, v180, v181
    v_cvt_pk_bf16_f32 v219, v182, v183
    buffer_store_dwordx4 v[216:219], v13, s[20:23], s63 offen offset:2048
    v_cvt_pk_bf16_f32 v220, v184, v185
    v_cvt_pk_bf16_f32 v221, v186, v187
    v_cvt_pk_bf16_f32 v222, v188, v189
    v_cvt_pk_bf16_f32 v223, v190, v191
    buffer_store_dwordx4 v[220:223], v13, s[20:23], s63 offen offset:3072
    s_mov_b32 s70, s58
    s_mov_b32 s71, 0
    s_lshl_b32 s59, s39, 7
    s_lshl_b32 s51, s30, 5
    s_add_u32 s59, s59, s51
.nofin_28:
    s_sub_i32 s50, s59, s50
    s_cmp_ge_i32 s50, 63
    s_cbranch_scc1 .nomask_29
    v_mov_b32 v40, s58
    s_cmp_gt_i32 s50, 0
    s_cbranch_scc1 .nx_30
    s_cmp_lt_i32 s50, 0
    s_cbranch_scc1 .fu_31
    v_cndmask_b32 v80, v40, v80, s[66:67]
    v_cndmask_b32 v81, v40, v81, s[68:69]
    v_cndmask_b32 v82, v40, v82, s[72:73]
    v_cndmask_b32 v83, v40, v83, s[74:75]
    v_cndmask_b32 v84, v40, v84, s[76:77]
    v_cndmask_b32 v85, v40, v85, s[78:79]
    v_cndmask_b32 v86, v40, v86, s[84:85]
    v_cndmask_b32 v87, v40, v87, s[86:87]
    v_cndmask_b32 v88, v40, v88, s[88:89]
    v_cndmask_b32 v89, v40, v89, s[92:93]
    v_cndmask_b32 v90, v40, v90, s[94:95]
    v_cndmask_b32 v91, v40, v91, s[96:97]
    v_cndmask_b32 v92, v40, v92, s[98:99]
    v_cndmask_b32 v93, v40, v93, s[100:101]
    v_cndmask_b32 v94, v40, v94, s[40:41]
    v_cndmask_b32 v95, v40, v95, s[42:43]
    s_branch .nx_30
.fu_31:
    v_mov_b32 v80, s58
    v_mov_b32 v81, s58
    v_mov_b32 v82, s58
    v_mov_b32 v83, s58
    v_mov_b32 v84, s58
    v_mov_b32 v85, s58
    v_mov_b32 v86, s58
    v_mov_b32 v87, s58
    v_mov_b32 v88, s58
    v_mov_b32 v89, s58
    v_mov_b32 v90, s58
    v_mov_b32 v91, s58
    v_mov_b32 v92, s58
    v_mov_b32 v93, s58
    v_mov_b32 v94, s58
    v_mov_b32 v95, s58
.nx_30:
    s_cmp_lt_i32 s50, 32
    s_cbranch_scc1 .fu_33
    v_cndmask_b32 v96, v40, v96, s[66:67]
    v_cndmask_b32 v97, v40, v97, s[68:69]
    v_cndmask_b32 v98, v40, v98, s[72:73]
    v_cndmask_b32 v99, v40, v99, s[74:75]
    v_cndmask_b32 v100, v40, v100, s[76:77]
    v_cndmask_b32 v101, v40, v101, s[78:79]
    v_cndmask_b32 v102, v40, v102, s[84:85]
    v_cndmask_b32 v103, v40, v103, s[86:87]
    v_cndmask_b32 v104, v40, v104, s[88:89]
    v_cndmask_b32 v105, v40, v105, s[92:93]
    v_cndmask_b32 v106, v40, v106, s[94:95]
    v_cndmask_b32 v107, v40, v107, s[96:97]
    v_cndmask_b32 v108, v40, v108, s[98:99]
    v_cndmask_b32 v109, v40, v109, s[100:101]
    v_cndmask_b32 v110, v40, v110, s[40:41]
    v_cndmask_b32 v111, v40, v111, s[42:43]
    s_branch .nx_32
.fu_33:
    v_mov_b32 v96, s58
    v_mov_b32 v97, s58
    v_mov_b32 v98, s58
    v_mov_b32 v99, s58
    v_mov_b32 v100, s58
    v_mov_b32 v101, s58
    v_mov_b32 v102, s58
    v_mov_b32 v103, s58
    v_mov_b32 v104, s58
    v_mov_b32 v105, s58
    v_mov_b32 v106, s58
    v_mov_b32 v107, s58
    v_mov_b32 v108, s58
    v_mov_b32 v109, s58
    v_mov_b32 v110, s58
    v_mov_b32 v111, s58
.nx_32:
.nomask_29:
    v_max3_f32 v39, v80, v81, v82
    v_max3_f32 v40, v83, v84, v85
    v_max3_f32 v39, v39, v86, v87
    v_max3_f32 v40, v40, v88, v89
    v_max3_f32 v39, v39, v90, v91
    v_max3_f32 v40, v40, v92, v93
    v_max3_f32 v39, v39, v94, v95
    v_max3_f32 v40, v40, v96, v97
    v_max3_f32 v39, v39, v98, v99
    v_max3_f32 v40, v40, v100, v101
    v_max3_f32 v39, v39, v102, v103
    v_max3_f32 v40, v40, v104, v105
    v_max3_f32 v39, v39, v106, v107
    v_max3_f32 v40, v40, v108, v109
    v_max3_f32 v39, v39, v110, v111
    v_max_f32 v39, v39, v40
    v_cmp_lt_f32 vcc, s70, v39
    s_cbranch_vccz .nores_34
    v_mov_b32 v40, v39
    s_min_i32 s51, s70, 0
    s_nop 0
    v_permlane32_swap_b32 v39, v40
    s_nop 1
    v_max3_f32 v39, v39, v40, s51
    v_exp_f32 v42, -v39
    v_sub_f32 v240, v240, v39
    v_sub_f32 v241, v241, v39
    v_sub_f32 v242, v242, v39
    v_sub_f32 v243, v243, v39
    v_sub_f32 v244, v244, v39
    v_sub_f32 v245, v245, v39
    v_sub_f32 v246, v246, v39
    v_sub_f32 v247, v247, v39
    v_sub_f32 v248, v248, v39
    v_sub_f32 v249, v249, v39
    v_sub_f32 v250, v250, v39
    v_sub_f32 v251, v251, v39
    v_sub_f32 v252, v252, v39
    v_sub_f32 v253, v253, v39
    v_sub_f32 v254, v254, v39
    v_sub_f32 v255, v255, v39
    v_min_f32 v42, 1.0, v42
    v_mul_f32 v42, s71, v42
    v_sub_f32 v80, v80, v39
    v_sub_f32 v81, v81, v39
    v_sub_f32 v82, v82, v39
    v_sub_f32 v83, v83, v39
    v_sub_f32 v84, v84, v39
    v_sub_f32 v85, v85, v39
    v_sub_f32 v86, v86, v39
    v_sub_f32 v87, v87, v39
    v_sub_f32 v88, v88, v39
    v_sub_f32 v89, v89, v39
    v_sub_f32 v90, v90, v39
    v_sub_f32 v91, v91, v39
    v_sub_f32 v92, v92, v39
    v_sub_f32 v93, v93, v39
    v_sub_f32 v94, v94, v39
    v_sub_f32 v95, v95, v39
    v_sub_f32 v96, v96, v39
    v_sub_f32 v97, v97, v39
    v_sub_f32 v98, v98, v39
    v_sub_f32 v99, v99, v39
    v_sub_f32 v100, v100, v39
    v_sub_f32 v101, v101, v39
    v_sub_f32 v102, v102, v39
    v_sub_f32 v103, v103, v39
    v_sub_f32 v104, v104, v39
    v_sub_f32 v105, v105, v39
    v_sub_f32 v106, v106, v39
    v_sub_f32 v107, v107, v39
    v_sub_f32 v108, v108, v39
    v_sub_f32 v109, v109, v39
    v_sub_f32 v110, v110, v39
    v_sub_f32 v111, v111, v39
    v_mul_f32 v34, v34, v42
    v_mul_f32 v35, v35, v42
    s_cmp_eq_u32 s71, 0
    s_cselect_b32 s64, 1, 0
    s_cbranch_scc1 .nomul_35
    v_mul_f32 v128, v128, v42
    v_mul_f32 v129, v129, v42
    v_mul_f32 v130, v130, v42
    v_mul_f32 v131, v131, v42
    v_mul_f32 v132, v132, v42
    v_mul_f32 v133, v133, v42
    v_mul_f32 v134, v134, v42
    v_mul_f32 v135, v135, v42
    v_mul_f32 v136, v136, v42
    v_mul_f32 v137, v137, v42
    v_mul_f32 v138, v138, v42
    v_mul_f32 v139, v139, v42
    v_mul_f32 v140, v140, v42
    v_mul_f32 v141, v141, v42
    v_mul_f32 v142, v142, v42
    v_mul_f32 v143, v143, v42
    v_mul_f32 v144, v144, v42
    v_mul_f32 v145, v145, v42
    v_mul_f32 v146, v146, v42
    v_mul_f32 v147, v147, v42
    v_mul_f32 v148, v148, v42
    v_mul_f32 v149, v149, v42
    v_mul_f32 v150, v150, v42
    v_mul_f32 v151, v151, v42
    v_mul_f32 v152, v152, v42
    v_mul_f32 v153, v153, v42
    v_mul_f32 v154, v154, v42
    v_mul_f32 v155, v155, v42
    v_mul_f32 v156, v156, v42
    v_mul_f32 v157, v157, v42
    v_mul_f32 v158, v158, v42
    v_mul_f32 v159, v159, v42
    v_mul_f32 v160, v160, v42
    v_mul_f32 v161, v161, v42
    v_mul_f32 v162, v162, v42
    v_mul_f32 v163, v163, v42
    v_mul_f32 v164, v164, v42
    v_mul_f32 v165, v165, v42
    v_mul_f32 v166, v166, v42
    v_mul_f32 v167, v167, v42
    v_mul_f32 v168, v168, v42
    v_mul_f32 v169, v169, v42
    v_mul_f32 v170, v170, v42
    v_mul_f32 v171, v171, v42
    v_mul_f32 v172, v172, v42
    v_mul_f32 v173, v173, v42
    v_mul_f32 v174, v174, v42
    v_mul_f32 v175, v175, v42
    v_mul_f32 v176, v176, v42
    v_mul_f32 v177, v177, v42
    v_mul_f32 v178, v178, v42
    v_mul_f32 v179, v179, v42
    v_mul_f32 v180, v180, v42
    v_mul_f32 v181, v181, v42
    v_mul_f32 v182, v182, v42
    v_mul_f32 v183, v183, v42
    v_mul_f32 v184, v184, v42
    v_mul_f32 v185, v185, v42
    v_mul_f32 v186, v186, v42
    v_mul_f32 v187, v187, v42
    v_mul_f32 v188, v188, v42
    v_mul_f32 v189, v189, v42
    v_mul_f32 v190, v190, v42
    v_mul_f32 v191, v191, v42
.nomul_35:
    s_mov_b32 s70, 0x41000000
    s_mov_b32 s71, 1.0
.nores_34:
    s_add_u32 s54, s54, 1
    s_cmp_lg_u32 s54, s57
    s_cbranch_scc1 .noq_36
    ds_read_b128 v[48:51], v11 offset:0
    ds_read_b128 v[52:55], v11 offset:1024
    ds_read_b128 v[56:59], v11 offset:2048
    ds_read_b128 v[60:63], v11 offset:3072
    ds_read_b128 v[64:67], v11 offset:4096
    ds_read_b128 v[68:71], v11 offset:5120
    ds_read_b128 v[72:75], v11 offset:6144
    ds_read_b128 v[76:79], v11 offset:7168
    s_waitcnt lgkmcnt(2)
.noq_36:
    s_mov_b32 s55, s56
    v_exp_f32 v80, v80
    v_exp_f32 v81, v81
    v_exp_f32 v82, v82
    v_exp_f32 v83, v83
    v_cvt_pk_bf16_f32 v112, v80, v81
    v_add_f32 v34, v34, v80
    v_add_f32 v35, v35, v81
    v_exp_f32 v84, v84
    v_exp_f32 v85, v85
    v_cvt_pk_bf16_f32 v113, v82, v83
    v_add_f32 v34, v34, v82
    v_add_f32 v35, v35, v83
    s_lshl_b32 s27, s55, 14
    s_add_u32 s56, s55, 1
    s_add_u32 s50, s54, 1
    s_cmp_eq_u32 s50, s57
    s_cselect_b32 s56, 0, s56
    s_lshl_b32 s62, s56, 14
    v_exp_f32 v86, v86
    v_exp_f32 v87, v87
    v_cvt_pk_bf16_f32 v114, v84, v85
    v_add_f32 v34, v34, v84
    v_add_f32 v35, v35, v85
    v_exp_f32 v88, v88
    v_exp_f32 v89, v89
    v_cvt_pk_bf16_f32 v115, v86, v87
    v_add_f32 v34, v34, v86
    v_add_f32 v35, v35, v87
    v_exp_f32 v90, v90
    v_exp_f32 v91, v91
    v_cvt_pk_bf16_f32 v116, v88, v89
    v_add_f32 v34, v34, v88
    v_add_f32 v35, v35, v89
    v_exp_f32 v92, v92
    v_exp_f32 v93, v93
    v_cvt_pk_bf16_f32 v117, v90, v91
    v_add_f32 v34, v34, v90
    v_add_f32 v35, v35, v91
    v_exp_f32 v94, v94
    v_exp_f32 v95, v95
    v_cvt_pk_bf16_f32 v118, v92, v93
    v_add_f32 v34, v34, v92
    v_add_f32 v35, v35, v93
    v_exp_f32 v96, v96
    v_exp_f32 v97, v97
    v_cvt_pk_bf16_f32 v119, v94, v95
    v_add_f32 v34, v34, v94
    v_add_f32 v35, v35, v95
    ds_read_b64_tr_b16 v[192:193], v28 offset:16384
    ds_read_b64_tr_b16 v[194:195], v28 offset:18432
    v_exp_f32 v98, v98
    v_exp_f32 v99, v99
    v_cvt_pk_bf16_f32 v120, v96, v97
    v_add_f32 v34, v34, v96
    v_add_f32 v35, v35, v97
    ds_read_b64_tr_b16 v[196:197], v29 offset:16384
    ds_read_b64_tr_b16 v[198:199], v29 offset:18432
    v_exp_f32 v100, v100
    v_exp_f32 v101, v101
    v_cvt_pk_bf16_f32 v121, v98, v99
    v_add_f32 v34, v34, v98
    v_add_f32 v35, v35, v99
    ds_read_b64_tr_b16 v[200:201], v30 offset:16384
    ds_read_b64_tr_b16 v[202:203], v30 offset:18432
    v_exp_f32 v102, v102
    v_exp_f32 v103, v103
    v_cvt_pk_bf16_f32 v122, v100, v101
    v_add_f32 v34, v34, v100
    v_add_f32 v35, v35, v101
    ds_read_b64_tr_b16 v[204:205], v31 offset:16384
    ds_read_b64_tr_b16 v[206:207], v31 offset:18432
    v_exp_f32 v104, v104
    v_exp_f32 v105, v105
    v_cvt_pk_bf16_f32 v123, v102, v103
    v_add_f32 v34, v34, v102
    v_add_f32 v35, v35, v103
    ds_read_b64_tr_b16 v[208:209], v28 offset:20480
    ds_read_b64_tr_b16 v[210:211], v28 offset:22528
    v_exp_f32 v106, v106
    v_exp_f32 v107, v107
    v_cvt_pk_bf16_f32 v124, v104, v105
    v_add_f32 v34, v34, v104
    v_add_f32 v35, v35, v105
    ds_read_b64_tr_b16 v[212:213], v29 offset:20480
    ds_read_b64_tr_b16 v[214:215], v29 offset:22528
    v_exp_f32 v108, v108
    v_exp_f32 v109, v109
    v_cvt_pk_bf16_f32 v125, v106, v107
    v_add_f32 v34, v34, v106
    v_add_f32 v35, v35, v107
    v_exp_f32 v110, v110
    v_exp_f32 v111, v111
    v_cvt_pk_bf16_f32 v126, v108, v109
    v_add_f32 v34, v34, v108
    v_add_f32 v35, v35, v109
    s_cmp_lt_u32 s54, 17
    v_cvt_pk_bf16_f32 v127, v110, v111
    v_add_f32 v34, v34, v110
    v_add_f32 v35, v35, v111
    s_waitcnt vmcnt(0)
    s_barrier
    s_branch .loop_10
.lz_12:
    s_waitcnt lgkmcnt(10)
    v_mfma_f32_32x32x16_bf16 v[128:143], v[192:195], v[112:115], 0
    ds_read_b64_tr_b16 v[216:217], v30 offset:20480
    ds_read_b64_tr_b16 v[218:219], v30 offset:22528
    s_add_u32 m0, s31, 0
    s_add_u32 s34, s27, 0
    buffer_load_dwordx4 v19, s[16:19], s34 offen lds
    s_waitcnt lgkmcnt(10)
    v_mfma_f32_32x32x16_bf16 v[144:159], v[196:199], v[112:115], 0
    ds_read_b64_tr_b16 v[220:221], v31 offset:20480
    ds_read_b64_tr_b16 v[222:223], v31 offset:22528
    s_add_u32 m0, s31, 4096
    s_add_u32 s34, s27, 512
    buffer_load_dwordx4 v19, s[16:19], s34 offen lds
    s_waitcnt lgkmcnt(10)
    v_mfma_f32_32x32x16_bf16 v[160:175], v[200:203], v[112:115], 0
    ds_read_b64_tr_b16 v[224:225], v28 offset:24576
    ds_read_b64_tr_b16 v[226:227], v28 offset:26624
    s_add_u32 m0, s31, 8192
    s_add_u32 s34, s27, 8192
    buffer_load_dwordx4 v19, s[16:19], s34 offen lds
    s_waitcnt lgkmcnt(10)
    v_mfma_f32_32x32x16_bf16 v[176:191], v[204:207], v[112:115], 0
    ds_read_b64_tr_b16 v[228:229], v29 offset:24576
    ds_read_b64_tr_b16 v[230:231], v29 offset:26624
    s_add_u32 m0, s31, 12288
    s_add_u32 s34, s27, 8704
    buffer_load_dwordx4 v19, s[16:19], s34 offen lds
    s_mov_b32 s64, 0
    s_branch .lj_13
.lz_24:
    s_waitcnt lgkmcnt(10)
    v_mfma_f32_32x32x16_bf16 v[128:143], v[192:195], v[112:115], 0
    ds_read_b64_tr_b16 v[216:217], v30 offset:4096
    ds_read_b64_tr_b16 v[218:219], v30 offset:6144
    s_add_u32 m0, s31, 16384
    s_add_u32 s34, s27, 0
    buffer_load_dwordx4 v19, s[16:19], s34 offen lds
    s_waitcnt lgkmcnt(10)
    v_mfma_f32_32x32x16_bf16 v[144:159], v[196:199], v[112:115], 0
    ds_read_b64_tr_b16 v[220:221], v31 offset:4096
    ds_read_b64_tr_b16 v[222:223], v31 offset:6144
    s_add_u32 m0, s31, 20480
    s_add_u32 s34, s27, 512
    buffer_load_dwordx4 v19, s[16:19], s34 offen lds
    s_waitcnt lgkmcnt(10)
    v_mfma_f32_32x32x16_bf16 v[160:175], v[200:203], v[112:115], 0
    ds_read_b64_tr_b16 v[224:225], v28 offset:8192
    ds_read_b64_tr_b16 v[226:227], v28 offset:10240
    s_add_u32 m0, s31, 24576
    s_add_u32 s34, s27, 8192
    buffer_load_dwordx4 v19, s[16:19], s34 offen lds
    s_waitcnt lgkmcnt(10)
    v_mfma_f32_32x32x16_bf16 v[176:191], v[204:207], v[112:115], 0
    ds_read_b64_tr_b16 v[228:229], v29 offset:8192
    ds_read_b64_tr_b16 v[230:231], v29 offset:10240
    s_add_u32 m0, s31, 28672
    s_add_u32 s34, s27, 8704
    buffer_load_dwordx4 v19, s[16:19], s34 offen lds
    s_mov_b32 s64, 0
    s_branch .lj_25
.Lattn_finz:
    s_waitcnt lgkmcnt(10)
    v_mfma_f32_32x32x16_bf16 v[128:143], v[192:195], v[112:115], 0
    ds_read_b64_tr_b16 v[216:217], v30 offset:4096
    ds_read_b64_tr_b16 v[218:219], v30 offset:6144
    s_waitcnt lgkmcnt(10)
    v_mfma_f32_32x32x16_bf16 v[144:159], v[196:199], v[112:115], 0
    ds_read_b64_tr_b16 v[220:221], v31 offset:4096
    ds_read_b64_tr_b16 v[222:223], v31 offset:6144
    s_waitcnt lgkmcnt(10)
    v_mfma_f32_32x32x16_bf16 v[160:175], v[200:203], v[112:115], 0
    ds_read_b64_tr_b16 v[224:225], v28 offset:8192
    ds_read_b64_tr_b16 v[226:227], v28 offset:10240
    s_waitcnt lgkmcnt(10)
    v_mfma_f32_32x32x16_bf16 v[176:191], v[204:207], v[112:115], 0
    ds_read_b64_tr_b16 v[228:229], v29 offset:8192
    ds_read_b64_tr_b16 v[230:231], v29 offset:10240
    s_branch .Lattn_finj
.Lattn_fin:
    s_cmp_lg_u32 s64, 0
    s_cbranch_scc1 .Lattn_finz
    s_waitcnt lgkmcnt(10)
    v_mfma_f32_32x32x16_bf16 v[128:143], v[192:195], v[112:115], v[128:143]
    ds_read_b64_tr_b16 v[216:217], v30 offset:4096
    ds_read_b64_tr_b16 v[218:219], v30 offset:6144
    s_waitcnt lgkmcnt(10)
    v_mfma_f32_32x32x16_bf16 v[144:159], v[196:199], v[112:115], v[144:159]
    ds_read_b64_tr_b16 v[220:221], v31 offset:4096
    ds_read_b64_tr_b16 v[222:223], v31 offset:6144
    s_waitcnt lgkmcnt(10)
    v_mfma_f32_32x32x16_bf16 v[160:175], v[200:203], v[112:115], v[160:175]
    ds_read_b64_tr_b16 v[224:225], v28 offset:8192
    ds_read_b64_tr_b16 v[226:227], v28 offset:10240
    s_waitcnt lgkmcnt(10)
    v_mfma_f32_32x32x16_bf16 v[176:191], v[204:207], v[112:115], v[176:191]
    ds_read_b64_tr_b16 v[228:229], v29 offset:8192
    ds_read_b64_tr_b16 v[230:231], v29 offset:10240
.Lattn_finj:
    s_waitcnt lgkmcnt(10)
    v_mfma_f32_32x32x16_bf16 v[128:143], v[208:211], v[116:119], v[128:143]
    ds_read_b64_tr_b16 v[232:233], v30 offset:8192
    ds_read_b64_tr_b16 v[234:235], v30 offset:10240
    s_waitcnt lgkmcnt(10)
    v_mfma_f32_32x32x16_bf16 v[144:159], v[212:215], v[116:119], v[144:159]
    ds_read_b64_tr_b16 v[236:237], v31 offset:8192
    ds_read_b64_tr_b16 v[238:239], v31 offset:10240
    s_waitcnt lgkmcnt(10)
    v_mfma_f32_32x32x16_bf16 v[160:175], v[216:219], v[116:119], v[160:175]
    ds_read_b64_tr_b16 v[192:193], v28 offset:12288
    ds_read_b64_tr_b16 v[194:195], v28 offset:14336
    s_waitcnt lgkmcnt(10)
    v_mfma_f32_32x32x16_bf16 v[176:191], v[220:223], v[116:119], v[176:191]
    ds_read_b64_tr_b16 v[196:197], v29 offset:12288
    ds_read_b64_tr_b16 v[198:199], v29 offset:14336
    s_waitcnt lgkmcnt(10)
    v_mfma_f32_32x32x16_bf16 v[128:143], v[224:227], v[120:123], v[128:143]
    ds_read_b64_tr_b16 v[200:201], v30 offset:12288
    ds_read_b64_tr_b16 v[202:203], v30 offset:14336
    s_waitcnt lgkmcnt(10)
    v_mfma_f32_32x32x16_bf16 v[144:159], v[228:231], v[120:123], v[144:159]
    ds_read_b64_tr_b16 v[204:205], v31 offset:12288
    ds_read_b64_tr_b16 v[206:207], v31 offset:14336
    s_waitcnt lgkmcnt(10)
    v_mfma_f32_32x32x16_bf16 v[160:175], v[232:235], v[120:123], v[160:175]
    s_waitcnt lgkmcnt(8)
    v_mfma_f32_32x32x16_bf16 v[176:191], v[236:239], v[120:123], v[176:191]
    s_waitcnt lgkmcnt(6)
    v_mfma_f32_32x32x16_bf16 v[128:143], v[192:195], v[124:127], v[128:143]
    s_waitcnt lgkmcnt(4)
    v_mfma_f32_32x32x16_bf16 v[144:159], v[196:199], v[124:127], v[144:159]
    s_waitcnt lgkmcnt(2)
    v_mfma_f32_32x32x16_bf16 v[160:175], v[200:203], v[124:127], v[160:175]
    s_waitcnt lgkmcnt(0)
    v_mfma_f32_32x32x16_bf16 v[176:191], v[204:207], v[124:127], v[176:191]
    v_add_f32 v34, v34, v35
    v_mov_b32 v40, v34
    s_nop 1
    v_permlane32_swap_b32 v34, v40
    s_nop 1
    v_add_f32 v33, v34, v40
    v_sub_f32 v32, 0, v240
    s_lshl_b32 s50, s29, 16
    s_lshl_b32 s51, s30, 13
    s_add_u32 s51, s51, s50
    s_add_u32 s51, s51, 32768
    s_xor_b32 s50, s51, 0x10000
    v_lshlrev_b32 v13, 4, v1
    v_add_u32 v14, s51, v13
    v_add_u32 v15, s50, v13
    v_lshlrev_b32 v13, 3, v1
    s_lshl_b32 s51, s28, 9
    s_add_u32 s51, s51, 131072
    s_xor_b32 s50, s51, 0x800
    v_add_u32 v12, s51, v13
    v_add_u32 v13, s50, v13
    ds_write_b64 v12, v[32:33]
    s_nop 4
    s_cmp_eq_u32 s29, 1
    s_cbranch_scc1 .g1_37
    ds_write_b128 v14, v[160:163] offset:0
    ds_write_b128 v14, v[164:167] offset:1024
    ds_write_b128 v14, v[168:171] offset:2048
    ds_write_b128 v14, v[172:175] offset:3072
    ds_write_b128 v14, v[176:179] offset:4096
    ds_write_b128 v14, v[180:183] offset:5120
    ds_write_b128 v14, v[184:187] offset:6144
    ds_write_b128 v14, v[188:191] offset:7168
    s_waitcnt lgkmcnt(0)
    s_barrier
    s_branch .gj_38
.g1_37:
    ds_write_b128 v14, v[128:131] offset:0
    ds_write_b128 v14, v[132:135] offset:1024
    ds_write_b128 v14, v[136:139] offset:2048
    ds_write_b128 v14, v[140:143] offset:3072
    ds_write_b128 v14, v[144:147] offset:4096
    ds_write_b128 v14, v[148:151] offset:5120
    ds_write_b128 v14, v[152:155] offset:6144
    ds_write_b128 v14, v[156:159] offset:7168
    s_waitcnt lgkmcnt(0)
    v_mov_b32 v128, v160
    v_mov_b32 v129, v161
    v_mov_b32 v130, v162
    v_mov_b32 v131, v163
    v_mov_b32 v132, v164
    v_mov_b32 v133, v165
    v_mov_b32 v134, v166
    v_mov_b32 v135, v167
    v_mov_b32 v136, v168
    v_mov_b32 v137, v169
    v_mov_b32 v138, v170
    v_mov_b32 v139, v171
    v_mov_b32 v140, v172
    v_mov_b32 v141, v173
    v_mov_b32 v142, v174
    v_mov_b32 v143, v175
    v_mov_b32 v144, v176
    v_mov_b32 v145, v177
    v_mov_b32 v146, v178
    v_mov_b32 v147, v179
    v_mov_b32 v148, v180
    v_mov_b32 v149, v181
    v_mov_b32 v150, v182
    v_mov_b32 v151, v183
    v_mov_b32 v152, v184
    v_mov_b32 v153, v185
    v_mov_b32 v154, v186
    v_mov_b32 v155, v187
    v_mov_b32 v156, v188
    v_mov_b32 v157, v189
    v_mov_b32 v158, v190
    v_mov_b32 v159, v191
.gj_38:
    s_barrier
    ds_read_b64 v[80:81], v13
    ds_read_b128 v[160:163], v15 offset:0
    ds_read_b128 v[164:167], v15 offset:1024
    ds_read_b128 v[168:171], v15 offset:2048
    ds_read_b128 v[172:175], v15 offset:3072
    ds_read_b128 v[176:179], v15 offset:4096
    ds_read_b128 v[180:183], v15 offset:5120
    ds_read_b128 v[184:187], v15 offset:6144
    ds_read_b128 v[188:191], v15 offset:7168
    s_waitcnt lgkmcnt(8)
    v_max_f32 v39, v32, v80
    v_sub_f32 v42, v32, v39
    v_sub_f32 v40, v80, v39
    v_exp_f32 v42, v42
    v_exp_f32 v40, v40
    s_nop 0
    v_mul_f32 v34, v33, v42
    v_fmac_f32 v34, v81, v40
    v_rcp_f32 v34, v34
    s_nop 0
    v_mul_f32 v42, v42, v34
    v_mul_f32 v40, v40, v34
    s_lshl_b32 s50, s59, 13
    s_lshl_b32 s51, s26, 5
    s_add_u32 s50, s50, s51
    s_lshl_b32 s51, s29, 12
    s_add_u32 s50, s50, s51
    v_lshlrev_b32 v13, 5, v4
    v_lshl_add_u32 v13, v5, 4, v13
    s_waitcnt lgkmcnt(0)
    v_mul_f32 v128, v128, v42
    v_fmac_f32 v128, v160, v40
    v_mul_f32 v129, v129, v42
    v_fmac_f32 v129, v161, v40
    v_mul_f32 v130, v130, v42
    v_fmac_f32 v130, v162, v40
    v_mul_f32 v131, v131, v42
    v_fmac_f32 v131, v163, v40
    v_mul_f32 v132, v132, v42
    v_fmac_f32 v132, v164, v40
    v_mul_f32 v133, v133, v42
    v_fmac_f32 v133, v165, v40
    v_mul_f32 v134, v134, v42
    v_fmac_f32 v134, v166, v40
    v_mul_f32 v135, v135, v42
    v_fmac_f32 v135, v167, v40
    v_mul_f32 v136, v136, v42
    v_fmac_f32 v136, v168, v40
    v_mul_f32 v137, v137, v42
    v_fmac_f32 v137, v169, v40
    v_mul_f32 v138, v138, v42
    v_fmac_f32 v138, v170, v40
    v_mul_f32 v139, v139, v42
    v_fmac_f32 v139, v171, v40
    v_mul_f32 v140, v140, v42
    v_fmac_f32 v140, v172, v40
    v_mul_f32 v141, v141, v42
    v_fmac_f32 v141, v173, v40
    v_mul_f32 v142, v142, v42
    v_fmac_f32 v142, v174, v40
    v_mul_f32 v143, v143, v42
    v_fmac_f32 v143, v175, v40
    v_mul_f32 v144, v144, v42
    v_fmac_f32 v144, v176, v40
    v_mul_f32 v145, v145, v42
    v_fmac_f32 v145, v177, v40
    v_mul_f32 v146, v146, v42
    v_fmac_f32 v146, v178, v40
    v_mul_f32 v147, v147, v42
    v_fmac_f32 v147, v179, v40
    v_mul_f32 v148, v148, v42
    v_fmac_f32 v148, v180, v40
    v_mul_f32 v149, v149, v42
    v_fmac_f32 v149, v181, v40
    v_mul_f32 v150, v150, v42
    v_fmac_f32 v150, v182, v40
    v_mul_f32 v151, v151, v42
    v_fmac_f32 v151, v183, v40
    v_mul_f32 v152, v152, v42
    v_fmac_f32 v152, v184, v40
    v_mul_f32 v153, v153, v42
    v_fmac_f32 v153, v185, v40
    v_mul_f32 v154, v154, v42
    v_fmac_f32 v154, v186, v40
    v_mul_f32 v155, v155, v42
    v_fmac_f32 v155, v187, v40
    v_mul_f32 v156, v156, v42
    v_fmac_f32 v156, v188, v40
    v_mul_f32 v157, v157, v42
    v_fmac_f32 v157, v189, v40
    v_mul_f32 v158, v158, v42
    v_fmac_f32 v158, v190, v40
    v_mul_f32 v159, v159, v42
    v_fmac_f32 v159, v191, v40
    v_cvt_pk_bf16_f32 v192, v128, v129
    v_cvt_pk_bf16_f32 v193, v130, v131
    v_cvt_pk_bf16_f32 v194, v132, v133
    v_cvt_pk_bf16_f32 v195, v134, v135
    buffer_store_dwordx4 v[192:195], v13, s[20:23], s50 offen offset:0
    v_cvt_pk_bf16_f32 v196, v136, v137
    v_cvt_pk_bf16_f32 v197, v138, v139
    v_cvt_pk_bf16_f32 v198, v140, v141
    v_cvt_pk_bf16_f32 v199, v142, v143
    buffer_store_dwordx4 v[196:199], v13, s[20:23], s50 offen offset:1024
    v_cvt_pk_bf16_f32 v200, v144, v145
    v_cvt_pk_bf16_f32 v201, v146, v147
    v_cvt_pk_bf16_f32 v202, v148, v149
    v_cvt_pk_bf16_f32 v203, v150, v151
    buffer_store_dwordx4 v[200:203], v13, s[20:23], s50 offen offset:2048
    v_cvt_pk_bf16_f32 v204, v152, v153
    v_cvt_pk_bf16_f32 v205, v154, v155
    v_cvt_pk_bf16_f32 v206, v156, v157
    v_cvt_pk_bf16_f32 v207, v158, v159
    buffer_store_dwordx4 v[204:207], v13, s[20:23], s50 offen offset:3072
.end_8:
    s_endpgm
.globl k_oproj_kernel
.p2align 8
.type k_oproj_kernel,@function
k_oproj_kernel:
    s_cmp_ge_u32 s2, 256
    s_cbranch_scc1 .end_39
    s_load_dwordx2 s[40:41], s[0:1], 40
    s_load_dwordx2 s[46:47], s[0:1], 112
    s_and_b32 s35, s2, 7
    s_lshr_b32 s36, s2, 3
    s_lshr_b32 s37, s35, 1
    s_and_b32 s38, s35, 1
    s_lshl_b32 s38, s38, 3
    s_lshr_b32 s39, s36, 2
    s_add_u32 s39, s39, s38
    s_and_b32 s38, s36, 3
    v_and_b32 v1, 63, v0
    v_lshrrev_b32 v2, 6, v0
    s_nop 0
    v_readfirstlane_b32 s28, v2
    s_nop 2
    v_lshrrev_b32 v16, 3, v1
    s_lshl_b32 s90, s28, 3
    v_add_u32 v16, s90, v16
    v_bfe_u32 v10, v16, 1, 3
    v_and_b32 v11, 7, v1
    v_xor_b32 v10, v10, v11
    v_lshrrev_b32 v11, 5, v16
    s_mov_b32 s90, 262144
    v_mul_lo_u32 v11, v11, s90
    v_and_b32 v16, 31, v16
    v_lshl_add_u32 v16, v16, 5, v11
    v_and_b32 v11, 1, v10
    v_lshl_add_u32 v16, v11, 4, v16
    v_lshrrev_b32 v10, 1, v10
    v_lshl_add_u32 v16, v10, 10, v16
    v_lshrrev_b32 v17, 4, v1
    s_mul_i32 s90, s28, 4
    v_add_u32 v17, s90, v17
    v_and_b32 v10, 3, v17
    v_lshlrev_b32 v10, 2, v10
    s_mov_b32 s90, 1024
    v_mul_lo_u32 v17, v17, s90
    v_and_b32 v11, 15, v1
    v_xor_b32 v10, v10, v11
    v_lshl_add_u32 v17, v10, 4, v17
    s_lshl_b32 s33, s28, 10
    s_waitcnt lgkmcnt(0)
    s_add_u32 s4, s46, 0x2400000
    s_addc_u32 s5, s47, 0
    s_and_b32 s5, s5, 0xffff
    s_mov_b32 s6, 0x1000000
    s_mov_b32 s7, 0x20000
    s_mov_b32 s8, s40
    s_and_b32 s9, s41, 0xffff
    s_mov_b32 s10, 0x400000
    s_mov_b32 s11, 0x20000
    s_lshl_b32 s24, s39, 20
    s_lshl_b32 s54, s37, 16
    s_add_u32 s24, s24, s54
    s_lshl_b32 s25, s37, 20
    s_lshl_b32 s54, s38, 8
    s_add_u32 s25, s25, s54
    s_add_u32 m0, s33, 0
    s_add_u32 s34, s24, 0
    buffer_load_dwordx4 v16, s[4:7], s34 offen lds
    s_add_u32 m0, s33, 4096
    s_add_u32 s34, s24, 262144
    buffer_load_dwordx4 v16, s[4:7], s34 offen lds
    s_add_u32 m0, s33, 8192
    s_add_u32 s34, s24, 524288
    buffer_load_dwordx4 v16, s[4:7], s34 offen lds
    s_add_u32 m0, s33, 12288
    s_add_u32 s34, s24, 786432
    buffer_load_dwordx4 v16, s[4:7], s34 offen lds
    s_add_u32 m0, s33, 16384
    s_add_u32 s34, s25, 0
    buffer_load_dwordx4 v17, s[8:11], s34 offen lds
    s_add_u32 m0, s33, 20480
    s_add_u32 s34, s25, 16384
    buffer_load_dwordx4 v17, s[8:11], s34 offen lds
    s_add_u32 m0, s33, 24576
    s_add_u32 s34, s25, 32768
    buffer_load_dwordx4 v17, s[8:11], s34 offen lds
    s_add_u32 m0, s33, 28672
    s_add_u32 s34, s25, 49152
    buffer_load_dwordx4 v17, s[8:11], s34 offen lds
    s_and_b32 s29, s28, 1
    s_lshr_b32 s30, s28, 1
    v_and_b32 v4, 31, v1
    v_lshrrev_b32 v5, 5, v1
    v_bfe_u32 v6, v1, 2, 2
    v_and_b32 v7, 3, v1
    v_bfe_u32 v8, v1, 4, 1
    s_mul_i32 s31, s30, 8192
    v_bfe_u32 v116, v4, 1, 3
    v_xor_b32 v116, v116, v5
    v_lshlrev_b32 v116, 4, v116
    v_lshl_add_u32 v116, v4, 7, v116
    v_add_u32 v116, s31, v116
    v_xor_b32 v117, 32, v116
    v_xor_b32 v118, 64, v116
    v_xor_b32 v119, 96, v116
    s_mul_i32 s31, s29, 2
    s_add_u32 s31, s31, 0
    s_and_b32 s32, s31, 3
    s_lshr_b32 s31, s31, 2
    s_lshl_b32 s31, s31, 8
    v_lshl_add_u32 v120, v5, 3, v6
    v_mul_u32_u24 v120, 256, v120
    v_xor_b32 v10, s32, v6
    v_lshl_add_u32 v120, v10, 6, v120
    v_lshl_add_u32 v120, v8, 5, v120
    v_lshl_add_u32 v120, v7, 3, v120
    v_add_u32 v120, 0x4000, v120
    v_add_u32 v120, s31, v120
    s_mul_i32 s31, s29, 2
    s_add_u32 s31, s31, 1
    s_and_b32 s32, s31, 3
    s_lshr_b32 s31, s31, 2
    s_lshl_b32 s31, s31, 8
    v_lshl_add_u32 v121, v5, 3, v6
    v_mul_u32_u24 v121, 256, v121
    v_xor_b32 v10, s32, v6
    v_lshl_add_u32 v121, v10, 6, v121
    v_lshl_add_u32 v121, v8, 5, v121
    v_lshl_add_u32 v121, v7, 3, v121
    v_add_u32 v121, 0x4000, v121
    v_add_u32 v121, s31, v121
    v_add_u32 v122, 0x10000, v116
    v_add_u32 v123, 0x10000, v117
    v_add_u32 v124, 0x10000, v118
    v_add_u32 v125, 0x10000, v119
    v_add_u32 v126, 0x10000, v120
    v_add_u32 v127, 0x10000, v121
    s_add_u32 s16, s46, 0x3400000
    s_addc_u32 s17, s47, 0
    s_and_b32 s17, s17, 0xffff
    s_mov_b32 s18, 0x800000
    s_mov_b32 s19, 0x20000
    s_add_u32 m0, s33, 32768
    s_add_u32 s34, s24, 4096
    buffer_load_dwordx4 v16, s[4:7], s34 offen lds
    s_add_u32 m0, s33, 36864
    s_add_u32 s34, s24, 266240
    buffer_load_dwordx4 v16, s[4:7], s34 offen lds
    s_add_u32 m0, s33, 40960
    s_add_u32 s34, s24, 528384
    buffer_load_dwordx4 v16, s[4:7], s34 offen lds
    s_add_u32 m0, s33, 45056
    s_add_u32 s34, s24, 790528
    buffer_load_dwordx4 v16, s[4:7], s34 offen lds
    s_add_u32 m0, s33, 49152
    s_add_u32 s34, s25, 65536
    buffer_load_dwordx4 v17, s[8:11], s34 offen lds
    s_add_u32 m0, s33, 53248
    s_add_u32 s34, s25, 81920
    buffer_load_dwordx4 v17, s[8:11], s34 offen lds
    s_add_u32 m0, s33, 57344
    s_add_u32 s34, s25, 98304
    buffer_load_dwordx4 v17, s[8:11], s34 offen lds
    s_add_u32 m0, s33, 61440
    s_add_u32 s34, s25, 114688
    buffer_load_dwordx4 v17, s[8:11], s34 offen lds
    s_add_u32 m0, s33, 65536
    s_add_u32 s34, s24, 8192
    buffer_load_dwordx4 v16, s[4:7], s34 offen lds
    s_add_u32 m0, s33, 69632
    s_add_u32 s34, s24, 270336
    buffer_load_dwordx4 v16, s[4:7], s34 offen lds
    s_add_u32 m0, s33, 73728
    s_add_u32 s34, s24, 532480
    buffer_load_dwordx4 v16, s[4:7], s34 offen lds
    s_add_u32 m0, s33, 77824
    s_add_u32 s34, s24, 794624
    buffer_load_dwordx4 v16, s[4:7], s34 offen lds
    s_add_u32 m0, s33, 81920
    s_add_u32 s34, s25, 131072
    buffer_load_dwordx4 v17, s[8:11], s34 offen lds
    s_add_u32 m0, s33, 86016
    s_add_u32 s34, s25, 147456
    buffer_load_dwordx4 v17, s[8:11], s34 offen lds
    s_add_u32 m0, s33, 90112
    s_add_u32 s34, s25, 163840
    buffer_load_dwordx4 v17, s[8:11], s34 offen lds
    s_add_u32 m0, s33, 94208
    s_add_u32 s34, s25, 180224
    buffer_load_dwordx4 v17, s[8:11], s34 offen lds
    s_waitcnt vmcnt(16)
    s_barrier
    ds_read_b128 v[20:23], v116 offset:0
    ds_read_b128 v[24:27], v116 offset:4096
    ds_read_b64_tr_b16 v[28:29], v120 offset:0
    ds_read_b64_tr_b16 v[30:31], v120 offset:1024
    ds_read_b64_tr_b16 v[32:33], v121 offset:0
    ds_read_b64_tr_b16 v[34:35], v121 offset:1024
    s_waitcnt lgkmcnt(0)
    ds_read_b128 v[36:39], v117 offset:0
    ds_read_b128 v[40:43], v117 offset:4096
    ds_read_b64_tr_b16 v[44:45], v120 offset:4096
    ds_read_b64_tr_b16 v[46:47], v120 offset:5120
    ds_read_b64_tr_b16 v[48:49], v121 offset:4096
    ds_read_b64_tr_b16 v[50:51], v121 offset:5120
    v_mfma_f32_32x32x16_bf16 v[52:67], v[28:31], v[20:23], 0
    s_add_u32 m0, s33, 98304
    s_add_u32 s34, s24, 12288
    buffer_load_dwordx4 v16, s[4:7], s34 offen lds
    v_mfma_f32_32x32x16_bf16 v[68:83], v[28:31], v[24:27], 0
    s_add_u32 m0, s33, 102400
    s_add_u32 s34, s24, 274432
    buffer_load_dwordx4 v16, s[4:7], s34 offen lds
    v_mfma_f32_32x32x16_bf16 v[84:99], v[32:35], v[20:23], 0
    s_add_u32 m0, s33, 106496
    s_add_u32 s34, s24, 536576
    buffer_load_dwordx4 v16, s[4:7], s34 offen lds
    v_mfma_f32_32x32x16_bf16 v[100:115], v[32:35], v[24:27], 0
    s_add_u32 m0, s33, 110592
    s_add_u32 s34, s24, 798720
    buffer_load_dwordx4 v16, s[4:7], s34 offen lds
    s_waitcnt lgkmcnt(0)
    ds_read_b128 v[20:23], v118 offset:0
    ds_read_b128 v[24:27], v118 offset:4096
    ds_read_b64_tr_b16 v[28:29], v120 offset:8192
    ds_read_b64_tr_b16 v[30:31], v120 offset:9216
    ds_read_b64_tr_b16 v[32:33], v121 offset:8192
    ds_read_b64_tr_b16 v[34:35], v121 offset:9216
    v_mfma_f32_32x32x16_bf16 v[52:67], v[44:47], v[36:39], v[52:67]
    s_add_u32 m0, s33, 114688
    s_add_u32 s34, s25, 196608
    buffer_load_dwordx4 v17, s[8:11], s34 offen lds
    v_mfma_f32_32x32x16_bf16 v[68:83], v[44:47], v[40:43], v[68:83]
    s_add_u32 m0, s33, 118784
    s_add_u32 s34, s25, 212992
    buffer_load_dwordx4 v17, s[8:11], s34 offen lds
    v_mfma_f32_32x32x16_bf16 v[84:99], v[48:51], v[36:39], v[84:99]
    s_add_u32 m0, s33, 122880
    s_add_u32 s34, s25, 229376
    buffer_load_dwordx4 v17, s[8:11], s34 offen lds
    v_mfma_f32_32x32x16_bf16 v[100:115], v[48:51], v[40:43], v[100:115]
    s_add_u32 m0, s33, 126976
    s_add_u32 s34, s25, 245760
    buffer_load_dwordx4 v17, s[8:11], s34 offen lds
    s_waitcnt lgkmcnt(0)
    ds_read_b128 v[36:39], v119 offset:0
    ds_read_b128 v[40:43], v119 offset:4096
    ds_read_b64_tr_b16 v[44:45], v120 offset:12288
    ds_read_b64_tr_b16 v[46:47], v120 offset:13312
    ds_read_b64_tr_b16 v[48:49], v121 offset:12288
    ds_read_b64_tr_b16 v[50:51], v121 offset:13312
    v_mfma_f32_32x32x16_bf16 v[52:67], v[28:31], v[20:23], v[52:67]
    v_mfma_f32_32x32x16_bf16 v[68:83], v[28:31], v[24:27], v[68:83]
    v_mfma_f32_32x32x16_bf16 v[84:99], v[32:35], v[20:23], v[84:99]
    v_mfma_f32_32x32x16_bf16 v[100:115], v[32:35], v[24:27], v[100:115]
    s_waitcnt lgkmcnt(0)
    s_waitcnt vmcnt(16)
    s_barrier
    ds_read_b128 v[20:23], v116 offset:32768
    ds_read_b128 v[24:27], v116 offset:36864
    ds_read_b64_tr_b16 v[28:29], v120 offset:32768
    ds_read_b64_tr_b16 v[30:31], v120 offset:33792
    ds_read_b64_tr_b16 v[32:33], v121 offset:32768
    ds_read_b64_tr_b16 v[34:35], v121 offset:33792
    v_mfma_f32_32x32x16_bf16 v[52:67], v[44:47], v[36:39], v[52:67]
    s_add_u32 m0, s33, 0
    s_add_u32 s34, s24, 16384
    buffer_load_dwordx4 v16, s[4:7], s34 offen lds
    v_mfma_f32_32x32x16_bf16 v[68:83], v[44:47], v[40:43], v[68:83]
    s_add_u32 m0, s33, 4096
    s_add_u32 s34, s24, 278528
    buffer_load_dwordx4 v16, s[4:7], s34 offen lds
    v_mfma_f32_32x32x16_bf16 v[84:99], v[48:51], v[36:39], v[84:99]
    s_add_u32 m0, s33, 8192
    s_add_u32 s34, s24, 540672
    buffer_load_dwordx4 v16, s[4:7], s34 offen lds
    v_mfma_f32_32x32x16_bf16 v[100:115], v[48:51], v[40:43], v[100:115]
    s_add_u32 m0, s33, 12288
    s_add_u32 s34, s24, 802816
    buffer_load_dwordx4 v16, s[4:7], s34 offen lds
    s_waitcnt lgkmcnt(0)
    ds_read_b128 v[36:39], v117 offset:32768
    ds_read_b128 v[40:43], v117 offset:36864
    ds_read_b64_tr_b16 v[44:45], v120 offset:36864
    ds_read_b64_tr_b16 v[46:47], v120 offset:37888
    ds_read_b64_tr_b16 v[48:49], v121 offset:36864
    ds_read_b64_tr_b16 v[50:51], v121 offset:37888
    v_mfma_f32_32x32x16_bf16 v[52:67], v[28:31], v[20:23], v[52:67]
    s_add_u32 m0, s33, 16384
    s_add_u32 s34, s25, 262144
    buffer_load_dwordx4 v17, s[8:11], s34 offen lds
    v_mfma_f32_32x32x16_bf16 v[68:83], v[28:31], v[24:27], v[68:83]
    s_add_u32 m0, s33, 20480
    s_add_u32 s34, s25, 278528
    buffer_load_dwordx4 v17, s[8:11], s34 offen lds
    v_mfma_f32_32x32x16_bf16 v[84:99], v[32:35], v[20:23], v[84:99]
    s_add_u32 m0, s33, 24576
    s_add_u32 s34, s25, 294912
    buffer_load_dwordx4 v17, s[8:11], s34 offen lds
    v_mfma_f32_32x32x16_bf16 v[100:115], v[32:35], v[24:27], v[100:115]
    s_add_u32 m0, s33, 28672
    s_add_u32 s34, s25, 311296
    buffer_load_dwordx4 v17, s[8:11], s34 offen lds
    s_waitcnt lgkmcnt(0)
    ds_read_b128 v[20:23], v118 offset:32768
    ds_read_b128 v[24:27], v118 offset:36864
    ds_read_b64_tr_b16 v[28:29], v120 offset:40960
    ds_read_b64_tr_b16 v[30:31], v120 offset:41984
    ds_read_b64_tr_b16 v[32:33], v121 offset:40960
    ds_read_b64_tr_b16 v[34:35], v121 offset:41984
    v_mfma_f32_32x32x16_bf16 v[52:67], v[44:47], v[36:39], v[52:67]
    v_mfma_f32_32x32x16_bf16 v[68:83], v[44:47], v[40:43], v[68:83]
    v_mfma_f32_32x32x16_bf16 v[84:99], v[48:51], v[36:39], v[84:99]
    v_mfma_f32_32x32x16_bf16 v[100:115], v[48:51], v[40:43], v[100:115]
    s_waitcnt lgkmcnt(0)
    ds_read_b128 v[36:39], v119 offset:32768
    ds_read_b128 v[40:43], v119 offset:36864
    ds_read_b64_tr_b16 v[44:45], v120 offset:45056
    ds_read_b64_tr_b16 v[46:47], v120 offset:46080
    ds_read_b64_tr_b16 v[48:49], v121 offset:45056
    ds_read_b64_tr_b16 v[50:51], v121 offset:46080
    v_mfma_f32_32x32x16_bf16 v[52:67], v[28:31], v[20:23], v[52:67]
    v_mfma_f32_32x32x16_bf16 v[68:83], v[28:31], v[24:27], v[68:83]
    v_mfma_f32_32x32x16_bf16 v[84:99], v[32:35], v[20:23], v[84:99]
    v_mfma_f32_32x32x16_bf16 v[100:115], v[32:35], v[24:27], v[100:115]
    s_waitcnt lgkmcnt(0)
    s_waitcnt vmcnt(16)
    s_barrier
    ds_read_b128 v[20:23], v122 offset:0
    ds_read_b128 v[24:27], v122 offset:4096
    ds_read_b64_tr_b16 v[28:29], v126 offset:0
    ds_read_b64_tr_b16 v[30:31], v126 offset:1024
    ds_read_b64_tr_b16 v[32:33], v127 offset:0
    ds_read_b64_tr_b16 v[34:35], v127 offset:1024
    v_mfma_f32_32x32x16_bf16 v[52:67], v[44:47], v[36:39], v[52:67]
    s_add_u32 m0, s33, 32768
    s_add_u32 s34, s24, 20480
    buffer_load_dwordx4 v16, s[4:7], s34 offen lds
    v_mfma_f32_32x32x16_bf16 v[68:83], v[44:47], v[40:43], v[68:83]
    s_add_u32 m0, s33, 36864
    s_add_u32 s34, s24, 282624
    buffer_load_dwordx4 v16, s[4:7], s34 offen lds
    v_mfma_f32_32x32x16_bf16 v[84:99], v[48:51], v[36:39], v[84:99]
    s_add_u32 m0, s33, 40960
    s_add_u32 s34, s24, 544768
    buffer_load_dwordx4 v16, s[4:7], s34 offen lds
    v_mfma_f32_32x32x16_bf16 v[100:115], v[48:51], v[40:43], v[100:115]
    s_add_u32 m0, s33, 45056
    s_add_u32 s34, s24, 806912
    buffer_load_dwordx4 v16, s[4:7], s34 offen lds
    s_waitcnt lgkmcnt(0)
    ds_read_b128 v[36:39], v123 offset:0
    ds_read_b128 v[40:43], v123 offset:4096
    ds_read_b64_tr_b16 v[44:45], v126 offset:4096
    ds_read_b64_tr_b16 v[46:47], v126 offset:5120
    ds_read_b64_tr_b16 v[48:49], v127 offset:4096
    ds_read_b64_tr_b16 v[50:51], v127 offset:5120
    v_mfma_f32_32x32x16_bf16 v[52:67], v[28:31], v[20:23], v[52:67]
    s_add_u32 m0, s33, 49152
    s_add_u32 s34, s25, 327680
    buffer_load_dwordx4 v17, s[8:11], s34 offen lds
    v_mfma_f32_32x32x16_bf16 v[68:83], v[28:31], v[24:27], v[68:83]
    s_add_u32 m0, s33, 53248
    s_add_u32 s34, s25, 344064
    buffer_load_dwordx4 v17, s[8:11], s34 offen lds
    v_mfma_f32_32x32x16_bf16 v[84:99], v[32:35], v[20:23], v[84:99]
    s_add_u32 m0, s33, 57344
    s_add_u32 s34, s25, 360448
    buffer_load_dwordx4 v17, s[8:11], s34 offen lds
    v_mfma_f32_32x32x16_bf16 v[100:115], v[32:35], v[24:27], v[100:115]
    s_add_u32 m0, s33, 61440
    s_add_u32 s34, s25, 376832
    buffer_load_dwordx4 v17, s[8:11], s34 offen lds
    s_waitcnt lgkmcnt(0)
    ds_read_b128 v[20:23], v124 offset:0
    ds_read_b128 v[24:27], v124 offset:4096
    ds_read_b64_tr_b16 v[28:29], v126 offset:8192
    ds_read_b64_tr_b16 v[30:31], v126 offset:9216
    ds_read_b64_tr_b16 v[32:33], v127 offset:8192
    ds_read_b64_tr_b16 v[34:35], v127 offset:9216
    v_mfma_f32_32x32x16_bf16 v[52:67], v[44:47], v[36:39], v[52:67]
    v_mfma_f32_32x32x16_bf16 v[68:83], v[44:47], v[40:43], v[68:83]
    v_mfma_f32_32x32x16_bf16 v[84:99], v[48:51], v[36:39], v[84:99]
    v_mfma_f32_32x32x16_bf16 v[100:115], v[48:51], v[40:43], v[100:115]
    s_waitcnt lgkmcnt(0)
    ds_read_b128 v[36:39], v125 offset:0
    ds_read_b128 v[40:43], v125 offset:4096
    ds_read_b64_tr_b16 v[44:45], v126 offset:12288
    ds_read_b64_tr_b16 v[46:47], v126 offset:13312
    ds_read_b64_tr_b16 v[48:49], v127 offset:12288
    ds_read_b64_tr_b16 v[50:51], v127 offset:13312
    v_mfma_f32_32x32x16_bf16 v[52:67], v[28:31], v[20:23], v[52:67]
    v_mfma_f32_32x32x16_bf16 v[68:83], v[28:31], v[24:27], v[68:83]
    v_mfma_f32_32x32x16_bf16 v[84:99], v[32:35], v[20:23], v[84:99]
    v_mfma_f32_32x32x16_bf16 v[100:115], v[32:35], v[24:27], v[100:115]
    s_waitcnt lgkmcnt(0)
    s_waitcnt vmcnt(16)
    s_barrier
    ds_read_b128 v[20:23], v122 offset:32768
    ds_read_b128 v[24:27], v122 offset:36864
    ds_read_b64_tr_b16 v[28:29], v126 offset:32768
    ds_read_b64_tr_b16 v[30:31], v126 offset:33792
    ds_read_b64_tr_b16 v[32:33], v127 offset:32768
    ds_read_b64_tr_b16 v[34:35], v127 offset:33792
    v_mfma_f32_32x32x16_bf16 v[52:67], v[44:47], v[36:39], v[52:67]
    s_add_u32 m0, s33, 65536
    s_add_u32 s34, s24, 24576
    buffer_load_dwordx4 v16, s[4:7], s34 offen lds
    v_mfma_f32_32x32x16_bf16 v[68:83], v[44:47], v[40:43], v[68:83]
    s_add_u32 m0, s33, 69632
    s_add_u32 s34, s24, 286720
    buffer_load_dwordx4 v16, s[4:7], s34 offen lds
    v_mfma_f32_32x32x16_bf16 v[84:99], v[48:51], v[36:39], v[84:99]
    s_add_u32 m0, s33, 73728
    s_add_u32 s34, s24, 548864
    buffer_load_dwordx4 v16, s[4:7], s34 offen lds
    v_mfma_f32_32x32x16_bf16 v[100:115], v[48:51], v[40:43], v[100:115]
    s_add_u32 m0, s33, 77824
    s_add_u32 s34, s24, 811008
    buffer_load_dwordx4 v16, s[4:7], s34 offen lds
    s_waitcnt lgkmcnt(0)
    ds_read_b128 v[36:39], v123 offset:32768
    ds_read_b128 v[40:43], v123 offset:36864
    ds_read_b64_tr_b16 v[44:45], v126 offset:36864
    ds_read_b64_tr_b16 v[46:47], v126 offset:37888
    ds_read_b64_tr_b16 v[48:49], v127 offset:36864
    ds_read_b64_tr_b16 v[50:51], v127 offset:37888
    v_mfma_f32_32x32x16_bf16 v[52:67], v[28:31], v[20:23], v[52:67]
    s_add_u32 m0, s33, 81920
    s_add_u32 s34, s25, 393216
    buffer_load_dwordx4 v17, s[8:11], s34 offen lds
    v_mfma_f32_32x32x16_bf16 v[68:83], v[28:31], v[24:27], v[68:83]
    s_add_u32 m0, s33, 86016
    s_add_u32 s34, s25, 409600
    buffer_load_dwordx4 v17, s[8:11], s34 offen lds
    v_mfma_f32_32x32x16_bf16 v[84:99], v[32:35], v[20:23], v[84:99]
    s_add_u32 m0, s33, 90112
    s_add_u32 s34, s25, 425984
    buffer_load_dwordx4 v17, s[8:11], s34 offen lds
    v_mfma_f32_32x32x16_bf16 v[100:115], v[32:35], v[24:27], v[100:115]
    s_add_u32 m0, s33, 94208
    s_add_u32 s34, s25, 442368
    buffer_load_dwordx4 v17, s[8:11], s34 offen lds
    s_waitcnt lgkmcnt(0)
    ds_read_b128 v[20:23], v124 offset:32768
    ds_read_b128 v[24:27], v124 offset:36864
    ds_read_b64_tr_b16 v[28:29], v126 offset:40960
    ds_read_b64_tr_b16 v[30:31], v126 offset:41984
    ds_read_b64_tr_b16 v[32:33], v127 offset:40960
    ds_read_b64_tr_b16 v[34:35], v127 offset:41984
    v_mfma_f32_32x32x16_bf16 v[52:67], v[44:47], v[36:39], v[52:67]
    v_mfma_f32_32x32x16_bf16 v[68:83], v[44:47], v[40:43], v[68:83]
    v_mfma_f32_32x32x16_bf16 v[84:99], v[48:51], v[36:39], v[84:99]
    v_mfma_f32_32x32x16_bf16 v[100:115], v[48:51], v[40:43], v[100:115]
    s_waitcnt lgkmcnt(0)
    ds_read_b128 v[36:39], v125 offset:32768
    ds_read_b128 v[40:43], v125 offset:36864
    ds_read_b64_tr_b16 v[44:45], v126 offset:45056
    ds_read_b64_tr_b16 v[46:47], v126 offset:46080
    ds_read_b64_tr_b16 v[48:49], v127 offset:45056
    ds_read_b64_tr_b16 v[50:51], v127 offset:46080
    v_mfma_f32_32x32x16_bf16 v[52:67], v[28:31], v[20:23], v[52:67]
    v_mfma_f32_32x32x16_bf16 v[68:83], v[28:31], v[24:27], v[68:83]
    v_mfma_f32_32x32x16_bf16 v[84:99], v[32:35], v[20:23], v[84:99]
    v_mfma_f32_32x32x16_bf16 v[100:115], v[32:35], v[24:27], v[100:115]
    s_waitcnt lgkmcnt(0)
    s_waitcnt vmcnt(16)
    s_barrier
    ds_read_b128 v[20:23], v116 offset:0
    ds_read_b128 v[24:27], v116 offset:4096
    ds_read_b64_tr_b16 v[28:29], v120 offset:0
    ds_read_b64_tr_b16 v[30:31], v120 offset:1024
    ds_read_b64_tr_b16 v[32:33], v121 offset:0
    ds_read_b64_tr_b16 v[34:35], v121 offset:1024
    v_mfma_f32_32x32x16_bf16 v[52:67], v[44:47], v[36:39], v[52:67]
    s_add_u32 m0, s33, 98304
    s_add_u32 s34, s24, 28672
    buffer_load_dwordx4 v16, s[4:7], s34 offen lds
    v_mfma_f32_32x32x16_bf16 v[68:83], v[44:47], v[40:43], v[68:83]
    s_add_u32 m0, s33, 102400
    s_add_u32 s34, s24, 290816
    buffer_load_dwordx4 v16, s[4:7], s34 offen lds
    v_mfma_f32_32x32x16_bf16 v[84:99], v[48:51], v[36:39], v[84:99]
    s_add_u32 m0, s33, 106496
    s_add_u32 s34, s24, 552960
    buffer_load_dwordx4 v16, s[4:7], s34 offen lds
    v_mfma_f32_32x32x16_bf16 v[100:115], v[48:51], v[40:43], v[100:115]
    s_add_u32 m0, s33, 110592
    s_add_u32 s34, s24, 815104
    buffer_load_dwordx4 v16, s[4:7], s34 offen lds
    s_waitcnt lgkmcnt(0)
    ds_read_b128 v[36:39], v117 offset:0
    ds_read_b128 v[40:43], v117 offset:4096
    ds_read_b64_tr_b16 v[44:45], v120 offset:4096
    ds_read_b64_tr_b16 v[46:47], v120 offset:5120
    ds_read_b64_tr_b16 v[48:49], v121 offset:4096
    ds_read_b64_tr_b16 v[50:51], v121 offset:5120
    v_mfma_f32_32x32x16_bf16 v[52:67], v[28:31], v[20:23], v[52:67]
    s_add_u32 m0, s33, 114688
    s_add_u32 s34, s25, 458752
    buffer_load_dwordx4 v17, s[8:11], s34 offen lds
    v_mfma_f32_32x32x16_bf16 v[68:83], v[28:31], v[24:27], v[68:83]
    s_add_u32 m0, s33, 118784
    s_add_u32 s34, s25, 475136
    buffer_load_dwordx4 v17, s[8:11], s34 offen lds
    v_mfma_f32_32x32x16_bf16 v[84:99], v[32:35], v[20:23], v[84:99]
    s_add_u32 m0, s33, 122880
    s_add_u32 s34, s25, 491520
    buffer_load_dwordx4 v17, s[8:11], s34 offen lds
    v_mfma_f32_32x32x16_bf16 v[100:115], v[32:35], v[24:27], v[100:115]
    s_add_u32 m0, s33, 126976
    s_add_u32 s34, s25, 507904
    buffer_load_dwordx4 v17, s[8:11], s34 offen lds
    s_waitcnt lgkmcnt(0)
    ds_read_b128 v[20:23], v118 offset:0
    ds_read_b128 v[24:27], v118 offset:4096
    ds_read_b64_tr_b16 v[28:29], v120 offset:8192
    ds_read_b64_tr_b16 v[30:31], v120 offset:9216
    ds_read_b64_tr_b16 v[32:33], v121 offset:8192
    ds_read_b64_tr_b16 v[34:35], v121 offset:9216
    v_mfma_f32_32x32x16_bf16 v[52:67], v[44:47], v[36:39], v[52:67]
    v_mfma_f32_32x32x16_bf16 v[68:83], v[44:47], v[40:43], v[68:83]
    v_mfma_f32_32x32x16_bf16 v[84:99], v[48:51], v[36:39], v[84:99]
    v_mfma_f32_32x32x16_bf16 v[100:115], v[48:51], v[40:43], v[100:115]
    s_waitcnt lgkmcnt(0)
    ds_read_b128 v[36:39], v119 offset:0
    ds_read_b128 v[40:43], v119 offset:4096
    ds_read_b64_tr_b16 v[44:45], v120 offset:12288
    ds_read_b64_tr_b16 v[46:47], v120 offset:13312
    ds_read_b64_tr_b16 v[48:49], v121 offset:12288
    ds_read_b64_tr_b16 v[50:51], v121 offset:13312
    v_mfma_f32_32x32x16_bf16 v[52:67], v[28:31], v[20:23], v[52:67]
    v_mfma_f32_32x32x16_bf16 v[68:83], v[28:31], v[24:27], v[68:83]
    v_mfma_f32_32x32x16_bf16 v[84:99], v[32:35], v[20:23], v[84:99]
    v_mfma_f32_32x32x16_bf16 v[100:115], v[32:35], v[24:27], v[100:115]
    s_waitcnt lgkmcnt(0)
    s_waitcnt vmcnt(16)
    s_barrier
    ds_read_b128 v[20:23], v116 offset:32768
    ds_read_b128 v[24:27], v116 offset:36864
    ds_read_b64_tr_b16 v[28:29], v120 offset:32768
    ds_read_b64_tr_b16 v[30:31], v120 offset:33792
    ds_read_b64_tr_b16 v[32:33], v121 offset:32768
    ds_read_b64_tr_b16 v[34:35], v121 offset:33792
    v_mfma_f32_32x32x16_bf16 v[52:67], v[44:47], v[36:39], v[52:67]
    s_add_u32 m0, s33, 0
    s_add_u32 s34, s24, 32768
    buffer_load_dwordx4 v16, s[4:7], s34 offen lds
    v_mfma_f32_32x32x16_bf16 v[68:83], v[44:47], v[40:43], v[68:83]
    s_add_u32 m0, s33, 4096
    s_add_u32 s34, s24, 294912
    buffer_load_dwordx4 v16, s[4:7], s34 offen lds
    v_mfma_f32_32x32x16_bf16 v[84:99], v[48:51], v[36:39], v[84:99]
    s_add_u32 m0, s33, 8192
    s_add_u32 s34, s24, 557056
    buffer_load_dwordx4 v16, s[4:7], s34 offen lds
    v_mfma_f32_32x32x16_bf16 v[100:115], v[48:51], v[40:43], v[100:115]
    s_add_u32 m0, s33, 12288
    s_add_u32 s34, s24, 819200
    buffer_load_dwordx4 v16, s[4:7], s34 offen lds
    s_waitcnt lgkmcnt(0)
    ds_read_b128 v[36:39], v117 offset:32768
    ds_read_b128 v[40:43], v117 offset:36864
    ds_read_b64_tr_b16 v[44:45], v120 offset:36864
    ds_read_b64_tr_b16 v[46:47], v120 offset:37888
    ds_read_b64_tr_b16 v[48:49], v121 offset:36864
    ds_read_b64_tr_b16 v[50:51], v121 offset:37888
    v_mfma_f32_32x32x16_bf16 v[52:67], v[28:31], v[20:23], v[52:67]
    s_add_u32 m0, s33, 16384
    s_add_u32 s34, s25, 524288
    buffer_load_dwordx4 v17, s[8:11], s34 offen lds
    v_mfma_f32_32x32x16_bf16 v[68:83], v[28:31], v[24:27], v[68:83]
    s_add_u32 m0, s33, 20480
    s_add_u32 s34, s25, 540672
    buffer_load_dwordx4 v17, s[8:11], s34 offen lds
    v_mfma_f32_32x32x16_bf16 v[84:99], v[32:35], v[20:23], v[84:99]
    s_add_u32 m0, s33, 24576
    s_add_u32 s34, s25, 557056
    buffer_load_dwordx4 v17, s[8:11], s34 offen lds
    v_mfma_f32_32x32x16_bf16 v[100:115], v[32:35], v[24:27], v[100:115]
    s_add_u32 m0, s33, 28672
    s_add_u32 s34, s25, 573440
    buffer_load_dwordx4 v17, s[8:11], s34 offen lds
    s_waitcnt lgkmcnt(0)
    ds_read_b128 v[20:23], v118 offset:32768
    ds_read_b128 v[24:27], v118 offset:36864
    ds_read_b64_tr_b16 v[28:29], v120 offset:40960
    ds_read_b64_tr_b16 v[30:31], v120 offset:41984
    ds_read_b64_tr_b16 v[32:33], v121 offset:40960
    ds_read_b64_tr_b16 v[34:35], v121 offset:41984
    v_mfma_f32_32x32x16_bf16 v[52:67], v[44:47], v[36:39], v[52:67]
    v_mfma_f32_32x32x16_bf16 v[68:83], v[44:47], v[40:43], v[68:83]
    v_mfma_f32_32x32x16_bf16 v[84:99], v[48:51], v[36:39], v[84:99]
    v_mfma_f32_32x32x16_bf16 v[100:115], v[48:51], v[40:43], v[100:115]
    s_waitcnt lgkmcnt(0)
    ds_read_b128 v[36:39], v119 offset:32768
    ds_read_b128 v[40:43], v119 offset:36864
    ds_read_b64_tr_b16 v[44:45], v120 offset:45056
    ds_read_b64_tr_b16 v[46:47], v120 offset:46080
    ds_read_b64_tr_b16 v[48:49], v121 offset:45056
    ds_read_b64_tr_b16 v[50:51], v121 offset:46080
    v_mfma_f32_32x32x16_bf16 v[52:67], v[28:31], v[20:23], v[52:67]
    v_mfma_f32_32x32x16_bf16 v[68:83], v[28:31], v[24:27], v[68:83]
    v_mfma_f32_32x32x16_bf16 v[84:99], v[32:35], v[20:23], v[84:99]
    v_mfma_f32_32x32x16_bf16 v[100:115], v[32:35], v[24:27], v[100:115]
    s_waitcnt lgkmcnt(0)
    s_waitcnt vmcnt(16)
    s_barrier
    ds_read_b128 v[20:23], v122 offset:0
    ds_read_b128 v[24:27], v122 offset:4096
    ds_read_b64_tr_b16 v[28:29], v126 offset:0
    ds_read_b64_tr_b16 v[30:31], v126 offset:1024
    ds_read_b64_tr_b16 v[32:33], v127 offset:0
    ds_read_b64_tr_b16 v[34:35], v127 offset:1024
    v_mfma_f32_32x32x16_bf16 v[52:67], v[44:47], v[36:39], v[52:67]
    s_add_u32 m0, s33, 32768
    s_add_u32 s34, s24, 36864
    buffer_load_dwordx4 v16, s[4:7], s34 offen lds
    v_mfma_f32_32x32x16_bf16 v[68:83], v[44:47], v[40:43], v[68:83]
    s_add_u32 m0, s33, 36864
    s_add_u32 s34, s24, 299008
    buffer_load_dwordx4 v16, s[4:7], s34 offen lds
    v_mfma_f32_32x32x16_bf16 v[84:99], v[48:51], v[36:39], v[84:99]
    s_add_u32 m0, s33, 40960
    s_add_u32 s34, s24, 561152
    buffer_load_dwordx4 v16, s[4:7], s34 offen lds
    v_mfma_f32_32x32x16_bf16 v[100:115], v[48:51], v[40:43], v[100:115]
    s_add_u32 m0, s33, 45056
    s_add_u32 s34, s24, 823296
    buffer_load_dwordx4 v16, s[4:7], s34 offen lds
    s_waitcnt lgkmcnt(0)
    ds_read_b128 v[36:39], v123 offset:0
    ds_read_b128 v[40:43], v123 offset:4096
    ds_read_b64_tr_b16 v[44:45], v126 offset:4096
    ds_read_b64_tr_b16 v[46:47], v126 offset:5120
    ds_read_b64_tr_b16 v[48:49], v127 offset:4096
    ds_read_b64_tr_b16 v[50:51], v127 offset:5120
    v_mfma_f32_32x32x16_bf16 v[52:67], v[28:31], v[20:23], v[52:67]
    s_add_u32 m0, s33, 49152
    s_add_u32 s34, s25, 589824
    buffer_load_dwordx4 v17, s[8:11], s34 offen lds
    v_mfma_f32_32x32x16_bf16 v[68:83], v[28:31], v[24:27], v[68:83]
    s_add_u32 m0, s33, 53248
    s_add_u32 s34, s25, 606208
    buffer_load_dwordx4 v17, s[8:11], s34 offen lds
    v_mfma_f32_32x32x16_bf16 v[84:99], v[32:35], v[20:23], v[84:99]
    s_add_u32 m0, s33, 57344
    s_add_u32 s34, s25, 622592
    buffer_load_dwordx4 v17, s[8:11], s34 offen lds
    v_mfma_f32_32x32x16_bf16 v[100:115], v[32:35], v[24:27], v[100:115]
    s_add_u32 m0, s33, 61440
    s_add_u32 s34, s25, 638976
    buffer_load_dwordx4 v17, s[8:11], s34 offen lds
    s_waitcnt lgkmcnt(0)
    ds_read_b128 v[20:23], v124 offset:0
    ds_read_b128 v[24:27], v124 offset:4096
    ds_read_b64_tr_b16 v[28:29], v126 offset:8192
    ds_read_b64_tr_b16 v[30:31], v126 offset:9216
    ds_read_b64_tr_b16 v[32:33], v127 offset:8192
    ds_read_b64_tr_b16 v[34:35], v127 offset:9216
    v_mfma_f32_32x32x16_bf16 v[52:67], v[44:47], v[36:39], v[52:67]
    v_mfma_f32_32x32x16_bf16 v[68:83], v[44:47], v[40:43], v[68:83]
    v_mfma_f32_32x32x16_bf16 v[84:99], v[48:51], v[36:39], v[84:99]
    v_mfma_f32_32x32x16_bf16 v[100:115], v[48:51], v[40:43], v[100:115]
    s_waitcnt lgkmcnt(0)
    ds_read_b128 v[36:39], v125 offset:0
    ds_read_b128 v[40:43], v125 offset:4096
    ds_read_b64_tr_b16 v[44:45], v126 offset:12288
    ds_read_b64_tr_b16 v[46:47], v126 offset:13312
    ds_read_b64_tr_b16 v[48:49], v127 offset:12288
    ds_read_b64_tr_b16 v[50:51], v127 offset:13312
    v_mfma_f32_32x32x16_bf16 v[52:67], v[28:31], v[20:23], v[52:67]
    v_mfma_f32_32x32x16_bf16 v[68:83], v[28:31], v[24:27], v[68:83]
    v_mfma_f32_32x32x16_bf16 v[84:99], v[32:35], v[20:23], v[84:99]
    v_mfma_f32_32x32x16_bf16 v[100:115], v[32:35], v[24:27], v[100:115]
    s_waitcnt lgkmcnt(0)
    s_waitcnt vmcnt(16)
    s_barrier
    ds_read_b128 v[20:23], v122 offset:32768
    ds_read_b128 v[24:27], v122 offset:36864
    ds_read_b64_tr_b16 v[28:29], v126 offset:32768
    ds_read_b64_tr_b16 v[30:31], v126 offset:33792
    ds_read_b64_tr_b16 v[32:33], v127 offset:32768
    ds_read_b64_tr_b16 v[34:35], v127 offset:33792
    v_mfma_f32_32x32x16_bf16 v[52:67], v[44:47], v[36:39], v[52:67]
    s_add_u32 m0, s33, 65536
    s_add_u32 s34, s24, 40960
    buffer_load_dwordx4 v16, s[4:7], s34 offen lds
    v_mfma_f32_32x32x16_bf16 v[68:83], v[44:47], v[40:43], v[68:83]
    s_add_u32 m0, s33, 69632
    s_add_u32 s34, s24, 303104
    buffer_load_dwordx4 v16, s[4:7], s34 offen lds
    v_mfma_f32_32x32x16_bf16 v[84:99], v[48:51], v[36:39], v[84:99]
    s_add_u32 m0, s33, 73728
    s_add_u32 s34, s24, 565248
    buffer_load_dwordx4 v16, s[4:7], s34 offen lds
    v_mfma_f32_32x32x16_bf16 v[100:115], v[48:51], v[40:43], v[100:115]
    s_add_u32 m0, s33, 77824
    s_add_u32 s34, s24, 827392
    buffer_load_dwordx4 v16, s[4:7], s34 offen lds
    s_waitcnt lgkmcnt(0)
    ds_read_b128 v[36:39], v123 offset:32768
    ds_read_b128 v[40:43], v123 offset:36864
    ds_read_b64_tr_b16 v[44:45], v126 offset:36864
    ds_read_b64_tr_b16 v[46:47], v126 offset:37888
    ds_read_b64_tr_b16 v[48:49], v127 offset:36864
    ds_read_b64_tr_b16 v[50:51], v127 offset:37888
    v_mfma_f32_32x32x16_bf16 v[52:67], v[28:31], v[20:23], v[52:67]
    s_add_u32 m0, s33, 81920
    s_add_u32 s34, s25, 655360
    buffer_load_dwordx4 v17, s[8:11], s34 offen lds
    v_mfma_f32_32x32x16_bf16 v[68:83], v[28:31], v[24:27], v[68:83]
    s_add_u32 m0, s33, 86016
    s_add_u32 s34, s25, 671744
    buffer_load_dwordx4 v17, s[8:11], s34 offen lds
    v_mfma_f32_32x32x16_bf16 v[84:99], v[32:35], v[20:23], v[84:99]
    s_add_u32 m0, s33, 90112
    s_add_u32 s34, s25, 688128
    buffer_load_dwordx4 v17, s[8:11], s34 offen lds
    v_mfma_f32_32x32x16_bf16 v[100:115], v[32:35], v[24:27], v[100:115]
    s_add_u32 m0, s33, 94208
    s_add_u32 s34, s25, 704512
    buffer_load_dwordx4 v17, s[8:11], s34 offen lds
    s_waitcnt lgkmcnt(0)
    ds_read_b128 v[20:23], v124 offset:32768
    ds_read_b128 v[24:27], v124 offset:36864
    ds_read_b64_tr_b16 v[28:29], v126 offset:40960
    ds_read_b64_tr_b16 v[30:31], v126 offset:41984
    ds_read_b64_tr_b16 v[32:33], v127 offset:40960
    ds_read_b64_tr_b16 v[34:35], v127 offset:41984
    v_mfma_f32_32x32x16_bf16 v[52:67], v[44:47], v[36:39], v[52:67]
    v_mfma_f32_32x32x16_bf16 v[68:83], v[44:47], v[40:43], v[68:83]
    v_mfma_f32_32x32x16_bf16 v[84:99], v[48:51], v[36:39], v[84:99]
    v_mfma_f32_32x32x16_bf16 v[100:115], v[48:51], v[40:43], v[100:115]
    s_waitcnt lgkmcnt(0)
    ds_read_b128 v[36:39], v125 offset:32768
    ds_read_b128 v[40:43], v125 offset:36864
    ds_read_b64_tr_b16 v[44:45], v126 offset:45056
    ds_read_b64_tr_b16 v[46:47], v126 offset:46080
    ds_read_b64_tr_b16 v[48:49], v127 offset:45056
    ds_read_b64_tr_b16 v[50:51], v127 offset:46080
    v_mfma_f32_32x32x16_bf16 v[52:67], v[28:31], v[20:23], v[52:67]
    v_mfma_f32_32x32x16_bf16 v[68:83], v[28:31], v[24:27], v[68:83]
    v_mfma_f32_32x32x16_bf16 v[84:99], v[32:35], v[20:23], v[84:99]
    v_mfma_f32_32x32x16_bf16 v[100:115], v[32:35], v[24:27], v[100:115]
    s_waitcnt lgkmcnt(0)
    s_waitcnt vmcnt(16)
    s_barrier
    ds_read_b128 v[20:23], v116 offset:0
    ds_read_b128 v[24:27], v116 offset:4096
    ds_read_b64_tr_b16 v[28:29], v120 offset:0
    ds_read_b64_tr_b16 v[30:31], v120 offset:1024
    ds_read_b64_tr_b16 v[32:33], v121 offset:0
    ds_read_b64_tr_b16 v[34:35], v121 offset:1024
    v_mfma_f32_32x32x16_bf16 v[52:67], v[44:47], v[36:39], v[52:67]
    s_add_u32 m0, s33, 98304
    s_add_u32 s34, s24, 45056
    buffer_load_dwordx4 v16, s[4:7], s34 offen lds
    v_mfma_f32_32x32x16_bf16 v[68:83], v[44:47], v[40:43], v[68:83]
    s_add_u32 m0, s33, 102400
    s_add_u32 s34, s24, 307200
    buffer_load_dwordx4 v16, s[4:7], s34 offen lds
    v_mfma_f32_32x32x16_bf16 v[84:99], v[48:51], v[36:39], v[84:99]
    s_add_u32 m0, s33, 106496
    s_add_u32 s34, s24, 569344
    buffer_load_dwordx4 v16, s[4:7], s34 offen lds
    v_mfma_f32_32x32x16_bf16 v[100:115], v[48:51], v[40:43], v[100:115]
    s_add_u32 m0, s33, 110592
    s_add_u32 s34, s24, 831488
    buffer_load_dwordx4 v16, s[4:7], s34 offen lds
    s_waitcnt lgkmcnt(0)
    ds_read_b128 v[36:39], v117 offset:0
    ds_read_b128 v[40:43], v117 offset:4096
    ds_read_b64_tr_b16 v[44:45], v120 offset:4096
    ds_read_b64_tr_b16 v[46:47], v120 offset:5120
    ds_read_b64_tr_b16 v[48:49], v121 offset:4096
    ds_read_b64_tr_b16 v[50:51], v121 offset:5120
    v_mfma_f32_32x32x16_bf16 v[52:67], v[28:31], v[20:23], v[52:67]
    s_add_u32 m0, s33, 114688
    s_add_u32 s34, s25, 720896
    buffer_load_dwordx4 v17, s[8:11], s34 offen lds
    v_mfma_f32_32x32x16_bf16 v[68:83], v[28:31], v[24:27], v[68:83]
    s_add_u32 m0, s33, 118784
    s_add_u32 s34, s25, 737280
    buffer_load_dwordx4 v17, s[8:11], s34 offen lds
    v_mfma_f32_32x32x16_bf16 v[84:99], v[32:35], v[20:23], v[84:99]
    s_add_u32 m0, s33, 122880
    s_add_u32 s34, s25, 753664
    buffer_load_dwordx4 v17, s[8:11], s34 offen lds
    v_mfma_f32_32x32x16_bf16 v[100:115], v[32:35], v[24:27], v[100:115]
    s_add_u32 m0, s33, 126976
    s_add_u32 s34, s25, 770048
    buffer_load_dwordx4 v17, s[8:11], s34 offen lds
    s_waitcnt lgkmcnt(0)
    ds_read_b128 v[20:23], v118 offset:0
    ds_read_b128 v[24:27], v118 offset:4096
    ds_read_b64_tr_b16 v[28:29], v120 offset:8192
    ds_read_b64_tr_b16 v[30:31], v120 offset:9216
    ds_read_b64_tr_b16 v[32:33], v121 offset:8192
    ds_read_b64_tr_b16 v[34:35], v121 offset:9216
    v_mfma_f32_32x32x16_bf16 v[52:67], v[44:47], v[36:39], v[52:67]
    v_mfma_f32_32x32x16_bf16 v[68:83], v[44:47], v[40:43], v[68:83]
    v_mfma_f32_32x32x16_bf16 v[84:99], v[48:51], v[36:39], v[84:99]
    v_mfma_f32_32x32x16_bf16 v[100:115], v[48:51], v[40:43], v[100:115]
    s_waitcnt lgkmcnt(0)
    ds_read_b128 v[36:39], v119 offset:0
    ds_read_b128 v[40:43], v119 offset:4096
    ds_read_b64_tr_b16 v[44:45], v120 offset:12288
    ds_read_b64_tr_b16 v[46:47], v120 offset:13312
    ds_read_b64_tr_b16 v[48:49], v121 offset:12288
    ds_read_b64_tr_b16 v[50:51], v121 offset:13312
    v_mfma_f32_32x32x16_bf16 v[52:67], v[28:31], v[20:23], v[52:67]
    v_mfma_f32_32x32x16_bf16 v[68:83], v[28:31], v[24:27], v[68:83]
    v_mfma_f32_32x32x16_bf16 v[84:99], v[32:35], v[20:23], v[84:99]
    v_mfma_f32_32x32x16_bf16 v[100:115], v[32:35], v[24:27], v[100:115]
    s_waitcnt lgkmcnt(0)
    s_waitcnt vmcnt(16)
    s_barrier
    ds_read_b128 v[20:23], v116 offset:32768
    ds_read_b128 v[24:27], v116 offset:36864
    ds_read_b64_tr_b16 v[28:29], v120 offset:32768
    ds_read_b64_tr_b16 v[30:31], v120 offset:33792
    ds_read_b64_tr_b16 v[32:33], v121 offset:32768
    ds_read_b64_tr_b16 v[34:35], v121 offset:33792
    v_mfma_f32_32x32x16_bf16 v[52:67], v[44:47], v[36:39], v[52:67]
    s_add_u32 m0, s33, 0
    s_add_u32 s34, s24, 49152
    buffer_load_dwordx4 v16, s[4:7], s34 offen lds
    v_mfma_f32_32x32x16_bf16 v[68:83], v[44:47], v[40:43], v[68:83]
    s_add_u32 m0, s33, 4096
    s_add_u32 s34, s24, 311296
    buffer_load_dwordx4 v16, s[4:7], s34 offen lds
    v_mfma_f32_32x32x16_bf16 v[84:99], v[48:51], v[36:39], v[84:99]
    s_add_u32 m0, s33, 8192
    s_add_u32 s34, s24, 573440
    buffer_load_dwordx4 v16, s[4:7], s34 offen lds
    v_mfma_f32_32x32x16_bf16 v[100:115], v[48:51], v[40:43], v[100:115]
    s_add_u32 m0, s33, 12288
    s_add_u32 s34, s24, 835584
    buffer_load_dwordx4 v16, s[4:7], s34 offen lds
    s_waitcnt lgkmcnt(0)
    ds_read_b128 v[36:39], v117 offset:32768
    ds_read_b128 v[40:43], v117 offset:36864
    ds_read_b64_tr_b16 v[44:45], v120 offset:36864
    ds_read_b64_tr_b16 v[46:47], v120 offset:37888
    ds_read_b64_tr_b16 v[48:49], v121 offset:36864
    ds_read_b64_tr_b16 v[50:51], v121 offset:37888
    v_mfma_f32_32x32x16_bf16 v[52:67], v[28:31], v[20:23], v[52:67]
    s_add_u32 m0, s33, 16384
    s_add_u32 s34, s25, 786432
    buffer_load_dwordx4 v17, s[8:11], s34 offen lds
    v_mfma_f32_32x32x16_bf16 v[68:83], v[28:31], v[24:27], v[68:83]
    s_add_u32 m0, s33, 20480
    s_add_u32 s34, s25, 802816
    buffer_load_dwordx4 v17, s[8:11], s34 offen lds
    v_mfma_f32_32x32x16_bf16 v[84:99], v[32:35], v[20:23], v[84:99]
    s_add_u32 m0, s33, 24576
    s_add_u32 s34, s25, 819200
    buffer_load_dwordx4 v17, s[8:11], s34 offen lds
    v_mfma_f32_32x32x16_bf16 v[100:115], v[32:35], v[24:27], v[100:115]
    s_add_u32 m0, s33, 28672
    s_add_u32 s34, s25, 835584
    buffer_load_dwordx4 v17, s[8:11], s34 offen lds
    s_waitcnt lgkmcnt(0)
    ds_read_b128 v[20:23], v118 offset:32768
    ds_read_b128 v[24:27], v118 offset:36864
    ds_read_b64_tr_b16 v[28:29], v120 offset:40960
    ds_read_b64_tr_b16 v[30:31], v120 offset:41984
    ds_read_b64_tr_b16 v[32:33], v121 offset:40960
    ds_read_b64_tr_b16 v[34:35], v121 offset:41984
    v_mfma_f32_32x32x16_bf16 v[52:67], v[44:47], v[36:39], v[52:67]
    v_mfma_f32_32x32x16_bf16 v[68:83], v[44:47], v[40:43], v[68:83]
    v_mfma_f32_32x32x16_bf16 v[84:99], v[48:51], v[36:39], v[84:99]
    v_mfma_f32_32x32x16_bf16 v[100:115], v[48:51], v[40:43], v[100:115]
    s_waitcnt lgkmcnt(0)
    ds_read_b128 v[36:39], v119 offset:32768
    ds_read_b128 v[40:43], v119 offset:36864
    ds_read_b64_tr_b16 v[44:45], v120 offset:45056
    ds_read_b64_tr_b16 v[46:47], v120 offset:46080
    ds_read_b64_tr_b16 v[48:49], v121 offset:45056
    ds_read_b64_tr_b16 v[50:51], v121 offset:46080
    v_mfma_f32_32x32x16_bf16 v[52:67], v[28:31], v[20:23], v[52:67]
    v_mfma_f32_32x32x16_bf16 v[68:83], v[28:31], v[24:27], v[68:83]
    v_mfma_f32_32x32x16_bf16 v[84:99], v[32:35], v[20:23], v[84:99]
    v_mfma_f32_32x32x16_bf16 v[100:115], v[32:35], v[24:27], v[100:115]
    s_waitcnt lgkmcnt(0)
    s_waitcnt vmcnt(16)
    s_barrier
    ds_read_b128 v[20:23], v122 offset:0
    ds_read_b128 v[24:27], v122 offset:4096
    ds_read_b64_tr_b16 v[28:29], v126 offset:0
    ds_read_b64_tr_b16 v[30:31], v126 offset:1024
    ds_read_b64_tr_b16 v[32:33], v127 offset:0
    ds_read_b64_tr_b16 v[34:35], v127 offset:1024
    v_mfma_f32_32x32x16_bf16 v[52:67], v[44:47], v[36:39], v[52:67]
    s_add_u32 m0, s33, 32768
    s_add_u32 s34, s24, 53248
    buffer_load_dwordx4 v16, s[4:7], s34 offen lds
    v_mfma_f32_32x32x16_bf16 v[68:83], v[44:47], v[40:43], v[68:83]
    s_add_u32 m0, s33, 36864
    s_add_u32 s34, s24, 315392
    buffer_load_dwordx4 v16, s[4:7], s34 offen lds
    v_mfma_f32_32x32x16_bf16 v[84:99], v[48:51], v[36:39], v[84:99]
    s_add_u32 m0, s33, 40960
    s_add_u32 s34, s24, 577536
    buffer_load_dwordx4 v16, s[4:7], s34 offen lds
    v_mfma_f32_32x32x16_bf16 v[100:115], v[48:51], v[40:43], v[100:115]
    s_add_u32 m0, s33, 45056
    s_add_u32 s34, s24, 839680
    buffer_load_dwordx4 v16, s[4:7], s34 offen lds
    s_waitcnt lgkmcnt(0)
    ds_read_b128 v[36:39], v123 offset:0
    ds_read_b128 v[40:43], v123 offset:4096
    ds_read_b64_tr_b16 v[44:45], v126 offset:4096
    ds_read_b64_tr_b16 v[46:47], v126 offset:5120
    ds_read_b64_tr_b16 v[48:49], v127 offset:4096
    ds_read_b64_tr_b16 v[50:51], v127 offset:5120
    v_mfma_f32_32x32x16_bf16 v[52:67], v[28:31], v[20:23], v[52:67]
    s_add_u32 m0, s33, 49152
    s_add_u32 s34, s25, 851968
    buffer_load_dwordx4 v17, s[8:11], s34 offen lds
    v_mfma_f32_32x32x16_bf16 v[68:83], v[28:31], v[24:27], v[68:83]
    s_add_u32 m0, s33, 53248
    s_add_u32 s34, s25, 868352
    buffer_load_dwordx4 v17, s[8:11], s34 offen lds
    v_mfma_f32_32x32x16_bf16 v[84:99], v[32:35], v[20:23], v[84:99]
    s_add_u32 m0, s33, 57344
    s_add_u32 s34, s25, 884736
    buffer_load_dwordx4 v17, s[8:11], s34 offen lds
    v_mfma_f32_32x32x16_bf16 v[100:115], v[32:35], v[24:27], v[100:115]
    s_add_u32 m0, s33, 61440
    s_add_u32 s34, s25, 901120
    buffer_load_dwordx4 v17, s[8:11], s34 offen lds
    s_waitcnt lgkmcnt(0)
    ds_read_b128 v[20:23], v124 offset:0
    ds_read_b128 v[24:27], v124 offset:4096
    ds_read_b64_tr_b16 v[28:29], v126 offset:8192
    ds_read_b64_tr_b16 v[30:31], v126 offset:9216
    ds_read_b64_tr_b16 v[32:33], v127 offset:8192
    ds_read_b64_tr_b16 v[34:35], v127 offset:9216
    v_mfma_f32_32x32x16_bf16 v[52:67], v[44:47], v[36:39], v[52:67]
    v_mfma_f32_32x32x16_bf16 v[68:83], v[44:47], v[40:43], v[68:83]
    v_mfma_f32_32x32x16_bf16 v[84:99], v[48:51], v[36:39], v[84:99]
    v_mfma_f32_32x32x16_bf16 v[100:115], v[48:51], v[40:43], v[100:115]
    s_waitcnt lgkmcnt(0)
    ds_read_b128 v[36:39], v125 offset:0
    ds_read_b128 v[40:43], v125 offset:4096
    ds_read_b64_tr_b16 v[44:45], v126 offset:12288
    ds_read_b64_tr_b16 v[46:47], v126 offset:13312
    ds_read_b64_tr_b16 v[48:49], v127 offset:12288
    ds_read_b64_tr_b16 v[50:51], v127 offset:13312
    v_mfma_f32_32x32x16_bf16 v[52:67], v[28:31], v[20:23], v[52:67]
    v_mfma_f32_32x32x16_bf16 v[68:83], v[28:31], v[24:27], v[68:83]
    v_mfma_f32_32x32x16_bf16 v[84:99], v[32:35], v[20:23], v[84:99]
    v_mfma_f32_32x32x16_bf16 v[100:115], v[32:35], v[24:27], v[100:115]
    s_waitcnt lgkmcnt(0)
    s_waitcnt vmcnt(16)
    s_barrier
    ds_read_b128 v[20:23], v122 offset:32768
    ds_read_b128 v[24:27], v122 offset:36864
    ds_read_b64_tr_b16 v[28:29], v126 offset:32768
    ds_read_b64_tr_b16 v[30:31], v126 offset:33792
    ds_read_b64_tr_b16 v[32:33], v127 offset:32768
    ds_read_b64_tr_b16 v[34:35], v127 offset:33792
    v_mfma_f32_32x32x16_bf16 v[52:67], v[44:47], v[36:39], v[52:67]
    s_add_u32 m0, s33, 65536
    s_add_u32 s34, s24, 57344
    buffer_load_dwordx4 v16, s[4:7], s34 offen lds
    v_mfma_f32_32x32x16_bf16 v[68:83], v[44:47], v[40:43], v[68:83]
    s_add_u32 m0, s33, 69632
    s_add_u32 s34, s24, 319488
    buffer_load_dwordx4 v16, s[4:7], s34 offen lds
    v_mfma_f32_32x32x16_bf16 v[84:99], v[48:51], v[36:39], v[84:99]
    s_add_u32 m0, s33, 73728
    s_add_u32 s34, s24, 581632
    buffer_load_dwordx4 v16, s[4:7], s34 offen lds
    v_mfma_f32_32x32x16_bf16 v[100:115], v[48:51], v[40:43], v[100:115]
    s_add_u32 m0, s33, 77824
    s_add_u32 s34, s24, 843776
    buffer_load_dwordx4 v16, s[4:7], s34 offen lds
    s_waitcnt lgkmcnt(0)
    ds_read_b128 v[36:39], v123 offset:32768
    ds_read_b128 v[40:43], v123 offset:36864
    ds_read_b64_tr_b16 v[44:45], v126 offset:36864
    ds_read_b64_tr_b16 v[46:47], v126 offset:37888
    ds_read_b64_tr_b16 v[48:49], v127 offset:36864
    ds_read_b64_tr_b16 v[50:51], v127 offset:37888
    v_mfma_f32_32x32x16_bf16 v[52:67], v[28:31], v[20:23], v[52:67]
    s_add_u32 m0, s33, 81920
    s_add_u32 s34, s25, 917504
    buffer_load_dwordx4 v17, s[8:11], s34 offen lds
    v_mfma_f32_32x32x16_bf16 v[68:83], v[28:31], v[24:27], v[68:83]
    s_add_u32 m0, s33, 86016
    s_add_u32 s34, s25, 933888
    buffer_load_dwordx4 v17, s[8:11], s34 offen lds
    v_mfma_f32_32x32x16_bf16 v[84:99], v[32:35], v[20:23], v[84:99]
    s_add_u32 m0, s33, 90112
    s_add_u32 s34, s25, 950272
    buffer_load_dwordx4 v17, s[8:11], s34 offen lds
    v_mfma_f32_32x32x16_bf16 v[100:115], v[32:35], v[24:27], v[100:115]
    s_add_u32 m0, s33, 94208
    s_add_u32 s34, s25, 966656
    buffer_load_dwordx4 v17, s[8:11], s34 offen lds
    s_waitcnt lgkmcnt(0)
    ds_read_b128 v[20:23], v124 offset:32768
    ds_read_b128 v[24:27], v124 offset:36864
    ds_read_b64_tr_b16 v[28:29], v126 offset:40960
    ds_read_b64_tr_b16 v[30:31], v126 offset:41984
    ds_read_b64_tr_b16 v[32:33], v127 offset:40960
    ds_read_b64_tr_b16 v[34:35], v127 offset:41984
    v_mfma_f32_32x32x16_bf16 v[52:67], v[44:47], v[36:39], v[52:67]
    v_mfma_f32_32x32x16_bf16 v[68:83], v[44:47], v[40:43], v[68:83]
    v_mfma_f32_32x32x16_bf16 v[84:99], v[48:51], v[36:39], v[84:99]
    v_mfma_f32_32x32x16_bf16 v[100:115], v[48:51], v[40:43], v[100:115]
    s_waitcnt lgkmcnt(0)
    ds_read_b128 v[36:39], v125 offset:32768
    ds_read_b128 v[40:43], v125 offset:36864
    ds_read_b64_tr_b16 v[44:45], v126 offset:45056
    ds_read_b64_tr_b16 v[46:47], v126 offset:46080
    ds_read_b64_tr_b16 v[48:49], v127 offset:45056
    ds_read_b64_tr_b16 v[50:51], v127 offset:46080
    v_mfma_f32_32x32x16_bf16 v[52:67], v[28:31], v[20:23], v[52:67]
    v_mfma_f32_32x32x16_bf16 v[68:83], v[28:31], v[24:27], v[68:83]
    v_mfma_f32_32x32x16_bf16 v[84:99], v[32:35], v[20:23], v[84:99]
    v_mfma_f32_32x32x16_bf16 v[100:115], v[32:35], v[24:27], v[100:115]
    s_waitcnt lgkmcnt(0)
    s_waitcnt vmcnt(16)
    s_barrier
    ds_read_b128 v[20:23], v116 offset:0
    ds_read_b128 v[24:27], v116 offset:4096
    ds_read_b64_tr_b16 v[28:29], v120 offset:0
    ds_read_b64_tr_b16 v[30:31], v120 offset:1024
    ds_read_b64_tr_b16 v[32:33], v121 offset:0
    ds_read_b64_tr_b16 v[34:35], v121 offset:1024
    v_mfma_f32_32x32x16_bf16 v[52:67], v[44:47], v[36:39], v[52:67]
    s_add_u32 m0, s33, 98304
    s_add_u32 s34, s24, 61440
    buffer_load_dwordx4 v16, s[4:7], s34 offen lds
    v_mfma_f32_32x32x16_bf16 v[68:83], v[44:47], v[40:43], v[68:83]
    s_add_u32 m0, s33, 102400
    s_add_u32 s34, s24, 323584
    buffer_load_dwordx4 v16, s[4:7], s34 offen lds
    v_mfma_f32_32x32x16_bf16 v[84:99], v[48:51], v[36:39], v[84:99]
    s_add_u32 m0, s33, 106496
    s_add_u32 s34, s24, 585728
    buffer_load_dwordx4 v16, s[4:7], s34 offen lds
    v_mfma_f32_32x32x16_bf16 v[100:115], v[48:51], v[40:43], v[100:115]
    s_add_u32 m0, s33, 110592
    s_add_u32 s34, s24, 847872
    buffer_load_dwordx4 v16, s[4:7], s34 offen lds
    s_waitcnt lgkmcnt(0)
    ds_read_b128 v[36:39], v117 offset:0
    ds_read_b128 v[40:43], v117 offset:4096
    ds_read_b64_tr_b16 v[44:45], v120 offset:4096
    ds_read_b64_tr_b16 v[46:47], v120 offset:5120
    ds_read_b64_tr_b16 v[48:49], v121 offset:4096
    ds_read_b64_tr_b16 v[50:51], v121 offset:5120
    v_mfma_f32_32x32x16_bf16 v[52:67], v[28:31], v[20:23], v[52:67]
    s_add_u32 m0, s33, 114688
    s_add_u32 s34, s25, 983040
    buffer_load_dwordx4 v17, s[8:11], s34 offen lds
    v_mfma_f32_32x32x16_bf16 v[68:83], v[28:31], v[24:27], v[68:83]
    s_add_u32 m0, s33, 118784
    s_add_u32 s34, s25, 999424
    buffer_load_dwordx4 v17, s[8:11], s34 offen lds
    v_mfma_f32_32x32x16_bf16 v[84:99], v[32:35], v[20:23], v[84:99]
    s_add_u32 m0, s33, 122880
    s_add_u32 s34, s25, 1015808
    buffer_load_dwordx4 v17, s[8:11], s34 offen lds
    v_mfma_f32_32x32x16_bf16 v[100:115], v[32:35], v[24:27], v[100:115]
    s_add_u32 m0, s33, 126976
    s_add_u32 s34, s25, 1032192
    buffer_load_dwordx4 v17, s[8:11], s34 offen lds
    s_waitcnt lgkmcnt(0)
    ds_read_b128 v[20:23], v118 offset:0
    ds_read_b128 v[24:27], v118 offset:4096
    ds_read_b64_tr_b16 v[28:29], v120 offset:8192
    ds_read_b64_tr_b16 v[30:31], v120 offset:9216
    ds_read_b64_tr_b16 v[32:33], v121 offset:8192
    ds_read_b64_tr_b16 v[34:35], v121 offset:9216
    v_mfma_f32_32x32x16_bf16 v[52:67], v[44:47], v[36:39], v[52:67]
    v_mfma_f32_32x32x16_bf16 v[68:83], v[44:47], v[40:43], v[68:83]
    v_mfma_f32_32x32x16_bf16 v[84:99], v[48:51], v[36:39], v[84:99]
    v_mfma_f32_32x32x16_bf16 v[100:115], v[48:51], v[40:43], v[100:115]
    s_waitcnt lgkmcnt(0)
    ds_read_b128 v[36:39], v119 offset:0
    ds_read_b128 v[40:43], v119 offset:4096
    ds_read_b64_tr_b16 v[44:45], v120 offset:12288
    ds_read_b64_tr_b16 v[46:47], v120 offset:13312
    ds_read_b64_tr_b16 v[48:49], v121 offset:12288
    ds_read_b64_tr_b16 v[50:51], v121 offset:13312
    v_mfma_f32_32x32x16_bf16 v[52:67], v[28:31], v[20:23], v[52:67]
    v_mfma_f32_32x32x16_bf16 v[68:83], v[28:31], v[24:27], v[68:83]
    v_mfma_f32_32x32x16_bf16 v[84:99], v[32:35], v[20:23], v[84:99]
    v_mfma_f32_32x32x16_bf16 v[100:115], v[32:35], v[24:27], v[100:115]
    s_waitcnt lgkmcnt(0)
    s_waitcnt vmcnt(16)
    s_barrier
    ds_read_b128 v[20:23], v116 offset:32768
    ds_read_b128 v[24:27], v116 offset:36864
    ds_read_b64_tr_b16 v[28:29], v120 offset:32768
    ds_read_b64_tr_b16 v[30:31], v120 offset:33792
    ds_read_b64_tr_b16 v[32:33], v121 offset:32768
    ds_read_b64_tr_b16 v[34:35], v121 offset:33792
    v_mfma_f32_32x32x16_bf16 v[52:67], v[44:47], v[36:39], v[52:67]
    v_mfma_f32_32x32x16_bf16 v[68:83], v[44:47], v[40:43], v[68:83]
    v_mfma_f32_32x32x16_bf16 v[84:99], v[48:51], v[36:39], v[84:99]
    v_mfma_f32_32x32x16_bf16 v[100:115], v[48:51], v[40:43], v[100:115]
    s_waitcnt lgkmcnt(0)
    ds_read_b128 v[36:39], v117 offset:32768
    ds_read_b128 v[40:43], v117 offset:36864
    ds_read_b64_tr_b16 v[44:45], v120 offset:36864
    ds_read_b64_tr_b16 v[46:47], v120 offset:37888
    ds_read_b64_tr_b16 v[48:49], v121 offset:36864
    ds_read_b64_tr_b16 v[50:51], v121 offset:37888
    v_mfma_f32_32x32x16_bf16 v[52:67], v[28:31], v[20:23], v[52:67]
    v_mfma_f32_32x32x16_bf16 v[68:83], v[28:31], v[24:27], v[68:83]
    v_mfma_f32_32x32x16_bf16 v[84:99], v[32:35], v[20:23], v[84:99]
    v_mfma_f32_32x32x16_bf16 v[100:115], v[32:35], v[24:27], v[100:115]
    s_waitcnt lgkmcnt(0)
    ds_read_b128 v[20:23], v118 offset:32768
    ds_read_b128 v[24:27], v118 offset:36864
    ds_read_b64_tr_b16 v[28:29], v120 offset:40960
    ds_read_b64_tr_b16 v[30:31], v120 offset:41984
    ds_read_b64_tr_b16 v[32:33], v121 offset:40960
    ds_read_b64_tr_b16 v[34:35], v121 offset:41984
    v_mfma_f32_32x32x16_bf16 v[52:67], v[44:47], v[36:39], v[52:67]
    v_mfma_f32_32x32x16_bf16 v[68:83], v[44:47], v[40:43], v[68:83]
    v_mfma_f32_32x32x16_bf16 v[84:99], v[48:51], v[36:39], v[84:99]
    v_mfma_f32_32x32x16_bf16 v[100:115], v[48:51], v[40:43], v[100:115]
    s_waitcnt lgkmcnt(0)
    ds_read_b128 v[36:39], v119 offset:32768
    ds_read_b128 v[40:43], v119 offset:36864
    ds_read_b64_tr_b16 v[44:45], v120 offset:45056
    ds_read_b64_tr_b16 v[46:47], v120 offset:46080
    ds_read_b64_tr_b16 v[48:49], v121 offset:45056
    ds_read_b64_tr_b16 v[50:51], v121 offset:46080
    v_mfma_f32_32x32x16_bf16 v[52:67], v[28:31], v[20:23], v[52:67]
    v_mfma_f32_32x32x16_bf16 v[68:83], v[28:31], v[24:27], v[68:83]
    v_mfma_f32_32x32x16_bf16 v[84:99], v[32:35], v[20:23], v[84:99]
    v_mfma_f32_32x32x16_bf16 v[100:115], v[32:35], v[24:27], v[100:115]
    s_waitcnt lgkmcnt(0)
    s_waitcnt vmcnt(8)
    s_barrier
    ds_read_b128 v[20:23], v122 offset:0
    ds_read_b128 v[24:27], v122 offset:4096
    ds_read_b64_tr_b16 v[28:29], v126 offset:0
    ds_read_b64_tr_b16 v[30:31], v126 offset:1024
    ds_read_b64_tr_b16 v[32:33], v127 offset:0
    ds_read_b64_tr_b16 v[34:35], v127 offset:1024
    v_mfma_f32_32x32x16_bf16 v[52:67], v[44:47], v[36:39], v[52:67]
    v_mfma_f32_32x32x16_bf16 v[68:83], v[44:47], v[40:43], v[68:83]
    v_mfma_f32_32x32x16_bf16 v[84:99], v[48:51], v[36:39], v[84:99]
    v_mfma_f32_32x32x16_bf16 v[100:115], v[48:51], v[40:43], v[100:115]
    s_waitcnt lgkmcnt(0)
    ds_read_b128 v[36:39], v123 offset:0
    ds_read_b128 v[40:43], v123 offset:4096
    ds_read_b64_tr_b16 v[44:45], v126 offset:4096
    ds_read_b64_tr_b16 v[46:47], v126 offset:5120
    ds_read_b64_tr_b16 v[48:49], v127 offset:4096
    ds_read_b64_tr_b16 v[50:51], v127 offset:5120
    v_mfma_f32_32x32x16_bf16 v[52:67], v[28:31], v[20:23], v[52:67]
    v_mfma_f32_32x32x16_bf16 v[68:83], v[28:31], v[24:27], v[68:83]
    v_mfma_f32_32x32x16_bf16 v[84:99], v[32:35], v[20:23], v[84:99]
    v_mfma_f32_32x32x16_bf16 v[100:115], v[32:35], v[24:27], v[100:115]
    s_waitcnt lgkmcnt(0)
    ds_read_b128 v[20:23], v124 offset:0
    ds_read_b128 v[24:27], v124 offset:4096
    ds_read_b64_tr_b16 v[28:29], v126 offset:8192
    ds_read_b64_tr_b16 v[30:31], v126 offset:9216
    ds_read_b64_tr_b16 v[32:33], v127 offset:8192
    ds_read_b64_tr_b16 v[34:35], v127 offset:9216
    v_mfma_f32_32x32x16_bf16 v[52:67], v[44:47], v[36:39], v[52:67]
    v_mfma_f32_32x32x16_bf16 v[68:83], v[44:47], v[40:43], v[68:83]
    v_mfma_f32_32x32x16_bf16 v[84:99], v[48:51], v[36:39], v[84:99]
    v_mfma_f32_32x32x16_bf16 v[100:115], v[48:51], v[40:43], v[100:115]
    s_waitcnt lgkmcnt(0)
    ds_read_b128 v[36:39], v125 offset:0
    ds_read_b128 v[40:43], v125 offset:4096
    ds_read_b64_tr_b16 v[44:45], v126 offset:12288
    ds_read_b64_tr_b16 v[46:47], v126 offset:13312
    ds_read_b64_tr_b16 v[48:49], v127 offset:12288
    ds_read_b64_tr_b16 v[50:51], v127 offset:13312
    v_mfma_f32_32x32x16_bf16 v[52:67], v[28:31], v[20:23], v[52:67]
    v_mfma_f32_32x32x16_bf16 v[68:83], v[28:31], v[24:27], v[68:83]
    v_mfma_f32_32x32x16_bf16 v[84:99], v[32:35], v[20:23], v[84:99]
    v_mfma_f32_32x32x16_bf16 v[100:115], v[32:35], v[24:27], v[100:115]
    s_waitcnt lgkmcnt(0)
    s_waitcnt vmcnt(0)
    s_barrier
    ds_read_b128 v[20:23], v122 offset:32768
    ds_read_b128 v[24:27], v122 offset:36864
    ds_read_b64_tr_b16 v[28:29], v126 offset:32768
    ds_read_b64_tr_b16 v[30:31], v126 offset:33792
    ds_read_b64_tr_b16 v[32:33], v127 offset:32768
    ds_read_b64_tr_b16 v[34:35], v127 offset:33792
    v_mfma_f32_32x32x16_bf16 v[52:67], v[44:47], v[36:39], v[52:67]
    v_mfma_f32_32x32x16_bf16 v[68:83], v[44:47], v[40:43], v[68:83]
    v_mfma_f32_32x32x16_bf16 v[84:99], v[48:51], v[36:39], v[84:99]
    v_mfma_f32_32x32x16_bf16 v[100:115], v[48:51], v[40:43], v[100:115]
    s_waitcnt lgkmcnt(0)
    ds_read_b128 v[36:39], v123 offset:32768
    ds_read_b128 v[40:43], v123 offset:36864
    ds_read_b64_tr_b16 v[44:45], v126 offset:36864
    ds_read_b64_tr_b16 v[46:47], v126 offset:37888
    ds_read_b64_tr_b16 v[48:49], v127 offset:36864
    ds_read_b64_tr_b16 v[50:51], v127 offset:37888
    v_mfma_f32_32x32x16_bf16 v[52:67], v[28:31], v[20:23], v[52:67]
    v_mfma_f32_32x32x16_bf16 v[68:83], v[28:31], v[24:27], v[68:83]
    v_mfma_f32_32x32x16_bf16 v[84:99], v[32:35], v[20:23], v[84:99]
    v_mfma_f32_32x32x16_bf16 v[100:115], v[32:35], v[24:27], v[100:115]
    s_waitcnt lgkmcnt(0)
    ds_read_b128 v[20:23], v124 offset:32768
    ds_read_b128 v[24:27], v124 offset:36864
    ds_read_b64_tr_b16 v[28:29], v126 offset:40960
    ds_read_b64_tr_b16 v[30:31], v126 offset:41984
    ds_read_b64_tr_b16 v[32:33], v127 offset:40960
    ds_read_b64_tr_b16 v[34:35], v127 offset:41984
    v_mfma_f32_32x32x16_bf16 v[52:67], v[44:47], v[36:39], v[52:67]
    v_mfma_f32_32x32x16_bf16 v[68:83], v[44:47], v[40:43], v[68:83]
    v_mfma_f32_32x32x16_bf16 v[84:99], v[48:51], v[36:39], v[84:99]
    v_mfma_f32_32x32x16_bf16 v[100:115], v[48:51], v[40:43], v[100:115]
    s_waitcnt lgkmcnt(0)
    ds_read_b128 v[36:39], v125 offset:32768
    ds_read_b128 v[40:43], v125 offset:36864
    ds_read_b64_tr_b16 v[44:45], v126 offset:45056
    ds_read_b64_tr_b16 v[46:47], v126 offset:46080
    ds_read_b64_tr_b16 v[48:49], v127 offset:45056
    ds_read_b64_tr_b16 v[50:51], v127 offset:46080
    v_mfma_f32_32x32x16_bf16 v[52:67], v[28:31], v[20:23], v[52:67]
    v_mfma_f32_32x32x16_bf16 v[68:83], v[28:31], v[24:27], v[68:83]
    v_mfma_f32_32x32x16_bf16 v[84:99], v[32:35], v[20:23], v[84:99]
    v_mfma_f32_32x32x16_bf16 v[100:115], v[32:35], v[24:27], v[100:115]
    s_waitcnt lgkmcnt(0)
    v_mfma_f32_32x32x16_bf16 v[52:67], v[44:47], v[36:39], v[52:67]
    v_mfma_f32_32x32x16_bf16 v[68:83], v[44:47], v[40:43], v[68:83]
    v_mfma_f32_32x32x16_bf16 v[84:99], v[48:51], v[36:39], v[84:99]
    v_mfma_f32_32x32x16_bf16 v[100:115], v[48:51], v[40:43], v[100:115]
    s_nop 15
    v_lshlrev_b32 v128, 5, v4
    v_lshl_add_u32 v128, v5, 4, v128
    s_lshl_b32 s34, s37, 21
    s_lshl_b32 s54, s39, 17
    s_add_u32 s34, s34, s54
    s_mul_i32 s54, s30, 65536
    s_add_u32 s34, s34, s54
    s_lshl_b32 s54, s38, 13
    s_add_u32 s34, s34, s54
    s_mul_i32 s54, s29, 4096
    s_add_u32 s34, s34, s54
    s_add_u32 s54, s34, 0
    v_cvt_pkrtz_f16_f32 v20, v52, v53
    v_cvt_pkrtz_f16_f32 v21, v54, v55
    v_cvt_pkrtz_f16_f32 v22, v56, v57
    v_cvt_pkrtz_f16_f32 v23, v58, v59
    buffer_store_dwordx4 v[20:23], v128, s[16:19], s54 offen offset:0
    v_cvt_pkrtz_f16_f32 v24, v60, v61
    v_cvt_pkrtz_f16_f32 v25, v62, v63
    v_cvt_pkrtz_f16_f32 v26, v64, v65
    v_cvt_pkrtz_f16_f32 v27, v66, v67
    buffer_store_dwordx4 v[24:27], v128, s[16:19], s54 offen offset:1024
    v_cvt_pkrtz_f16_f32 v28, v84, v85
    v_cvt_pkrtz_f16_f32 v29, v86, v87
    v_cvt_pkrtz_f16_f32 v30, v88, v89
    v_cvt_pkrtz_f16_f32 v31, v90, v91
    buffer_store_dwordx4 v[28:31], v128, s[16:19], s54 offen offset:2048
    v_cvt_pkrtz_f16_f32 v32, v92, v93
    v_cvt_pkrtz_f16_f32 v33, v94, v95
    v_cvt_pkrtz_f16_f32 v34, v96, v97
    v_cvt_pkrtz_f16_f32 v35, v98, v99
    buffer_store_dwordx4 v[32:35], v128, s[16:19], s54 offen offset:3072
    s_add_u32 s54, s34, 32768
    v_cvt_pkrtz_f16_f32 v36, v68, v69
    v_cvt_pkrtz_f16_f32 v37, v70, v71
    v_cvt_pkrtz_f16_f32 v38, v72, v73
    v_cvt_pkrtz_f16_f32 v39, v74, v75
    buffer_store_dwordx4 v[36:39], v128, s[16:19], s54 offen offset:0
    v_cvt_pkrtz_f16_f32 v40, v76, v77
    v_cvt_pkrtz_f16_f32 v41, v78, v79
    v_cvt_pkrtz_f16_f32 v42, v80, v81
    v_cvt_pkrtz_f16_f32 v43, v82, v83
    buffer_store_dwordx4 v[40:43], v128, s[16:19], s54 offen offset:1024
    v_cvt_pkrtz_f16_f32 v44, v100, v101
    v_cvt_pkrtz_f16_f32 v45, v102, v103
    v_cvt_pkrtz_f16_f32 v46, v104, v105
    v_cvt_pkrtz_f16_f32 v47, v106, v107
    buffer_store_dwordx4 v[44:47], v128, s[16:19], s54 offen offset:2048
    v_cvt_pkrtz_f16_f32 v48, v108, v109
    v_cvt_pkrtz_f16_f32 v49, v110, v111
    v_cvt_pkrtz_f16_f32 v50, v112, v113
    v_cvt_pkrtz_f16_f32 v51, v114, v115
    buffer_store_dwordx4 v[48:51], v128, s[16:19], s54 offen offset:3072
.end_39:
    s_endpgm
.globl k_ln2_kernel
.p2align 8
.type k_ln2_kernel,@function
k_ln2_kernel:
    s_cmp_ge_u32 s2, 512
    s_cbranch_scc1 .Lln2_end
    s_load_dwordx2 s[4:5], s[0:1], 0
    s_load_dwordx2 s[6:7], s[0:1], 112
    v_and_b32 v1, 63, v0
    v_lshrrev_b32 v2, 6, v0
    s_lshl_b32 s3, s2, 12
    v_lshlrev_b32 v2, 10, v2
    v_lshrrev_b32 v3, 1, v1
    v_lshlrev_b32 v3, 10, v3
    v_and_b32 v4, 1, v1
    v_lshl_add_u32 v3, v4, 4, v3
    v_lshrrev_b32 v4, 5, v2
    v_add_u32 v3, v3, v4
    s_lshr_b32 s31, s2, 3
    s_lshl_b32 s31, s31, 15
    s_and_b32 s29, s2, 7
    s_lshl_b32 s29, s29, 7
    s_add_u32 s31, s31, s29
    v_and_b32 v4, 1, v1
    v_lshlrev_b32 v4, 3, v4
    v_and_b32 v5, 62, v1
    v_lshl_add_u32 v4, v5, 4, v4
    v_lshlrev_b32 v5, 1, v4
    v_add_u32 v4, v4, v2
    v_lshlrev_b32 v6, 1, v4
    s_waitcnt lgkmcnt(0)
    s_add_u32 s16, s6, 0x3400000
    s_addc_u32 s17, s7, 0
    s_and_b32 s17, s17, 0xffff
    s_mov_b32 s18, 0x800000
    s_mov_b32 s19, 0x20000
    buffer_load_dwordx4 v[76:79], v3, s[16:19], s31 offen
    s_add_u32 s29, s31, 2097152
    buffer_load_dwordx4 v[80:83], v3, s[16:19], s29 offen
    s_add_u32 s29, s31, 4194304
    buffer_load_dwordx4 v[84:87], v3, s[16:19], s29 offen
    s_add_u32 s29, s31, 6291456
    buffer_load_dwordx4 v[88:91], v3, s[16:19], s29 offen
    s_mov_b32 s8, s4
    s_and_b32 s9, s5, 0xffff
    s_mov_b32 s10, 0x200000
    s_mov_b32 s11, 0x20000
    buffer_load_dwordx2 v[8:9], v4, s[8:11], s3 offen
    buffer_load_dwordx2 v[10:11], v4, s[8:11], s3 offen offset:16
    s_mov_b32 s12, s6
    s_and_b32 s13, s7, 0xffff
    s_mov_b32 s14, 0x3000
    s_mov_b32 s15, 0x20000
    s_movk_i32 s28, 4096
    buffer_load_dwordx4 v[32:35], v5, s[12:15], s28 offen
    buffer_load_dwordx4 v[36:39], v5, s[12:15], s28 offen offset:32
    s_movk_i32 s28, 6144
    buffer_load_dwordx4 v[40:43], v5, s[12:15], s28 offen
    buffer_load_dwordx4 v[44:47], v5, s[12:15], s28 offen offset:32
    s_movk_i32 s28, 8192
    buffer_load_dwordx4 v[48:51], v5, s[12:15], s28 offen
    buffer_load_dwordx4 v[52:55], v5, s[12:15], s28 offen offset:32
    s_add_u32 s20, s6, 0x4400000
    s_addc_u32 s21, s7, 0
    s_and_b32 s21, s21, 0xffff
    s_mov_b32 s22, 0x400000
    s_mov_b32 s23, 0x20000
    s_add_u32 s24, s6, 0x4800000
    s_addc_u32 s25, s7, 0
    s_and_b32 s25, s25, 0xffff
    s_mov_b32 s26, 0x200000
    s_mov_b32 s27, 0x20000
    s_lshl_b32 s30, s3, 1
    v_mov_b32 v64, 0
    v_mov_b32 v65, 0
    v_mov_b32 v66, 0
    v_mov_b32 v67, 0
    v_mov_b32 v68, 0
    v_mov_b32 v69, 0
    v_mov_b32 v70, 0
    v_mov_b32 v71, 0
    s_waitcnt vmcnt(11)
    v_fma_mix_f32 v64, v76, 1.0, v64 op_sel:[0,0,0] op_sel_hi:[1,0,0]
    v_fma_mix_f32 v65, v76, 1.0, v65 op_sel:[1,0,0] op_sel_hi:[1,0,0]
    v_fma_mix_f32 v66, v77, 1.0, v66 op_sel:[0,0,0] op_sel_hi:[1,0,0]
    v_fma_mix_f32 v67, v77, 1.0, v67 op_sel:[1,0,0] op_sel_hi:[1,0,0]
    v_fma_mix_f32 v68, v78, 1.0, v68 op_sel:[0,0,0] op_sel_hi:[1,0,0]
    v_fma_mix_f32 v69, v78, 1.0, v69 op_sel:[1,0,0] op_sel_hi:[1,0,0]
    v_fma_mix_f32 v70, v79, 1.0, v70 op_sel:[0,0,0] op_sel_hi:[1,0,0]
    v_fma_mix_f32 v71, v79, 1.0, v71 op_sel:[1,0,0] op_sel_hi:[1,0,0]
    s_waitcnt vmcnt(10)
    v_fma_mix_f32 v64, v80, 1.0, v64 op_sel:[0,0,0] op_sel_hi:[1,0,0]
    v_fma_mix_f32 v65, v80, 1.0, v65 op_sel:[1,0,0] op_sel_hi:[1,0,0]
    v_fma_mix_f32 v66, v81, 1.0, v66 op_sel:[0,0,0] op_sel_hi:[1,0,0]
    v_fma_mix_f32 v67, v81, 1.0, v67 op_sel:[1,0,0] op_sel_hi:[1,0,0]
    v_fma_mix_f32 v68, v82, 1.0, v68 op_sel:[0,0,0] op_sel_hi:[1,0,0]
    v_fma_mix_f32 v69, v82, 1.0, v69 op_sel:[1,0,0] op_sel_hi:[1,0,0]
    v_fma_mix_f32 v70, v83, 1.0, v70 op_sel:[0,0,0] op_sel_hi:[1,0,0]
    v_fma_mix_f32 v71, v83, 1.0, v71 op_sel:[1,0,0] op_sel_hi:[1,0,0]
    s_waitcnt vmcnt(9)
    v_fma_mix_f32 v64, v84, 1.0, v64 op_sel:[0,0,0] op_sel_hi:[1,0,0]
    v_fma_mix_f32 v65, v84, 1.0, v65 op_sel:[1,0,0] op_sel_hi:[1,0,0]
    v_fma_mix_f32 v66, v85, 1.0, v66 op_sel:[0,0,0] op_sel_hi:[1,0,0]
    v_fma_mix_f32 v67, v85, 1.0, v67 op_sel:[1,0,0] op_sel_hi:[1,0,0]
    v_fma_mix_f32 v68, v86, 1.0, v68 op_sel:[0,0,0] op_sel_hi:[1,0,0]
    v_fma_mix_f32 v69, v86, 1.0, v69 op_sel:[1,0,0] op_sel_hi:[1,0,0]
    v_fma_mix_f32 v70, v87, 1.0, v70 op_sel:[0,0,0] op_sel_hi:[1,0,0]
    v_fma_mix_f32 v71, v87, 1.0, v71 op_sel:[1,0,0] op_sel_hi:[1,0,0]
    s_waitcnt vmcnt(8)
    v_fma_mix_f32 v64, v88, 1.0, v64 op_sel:[0,0,0] op_sel_hi:[1,0,0]
    v_fma_mix_f32 v65, v88, 1.0, v65 op_sel:[1,0,0] op_sel_hi:[1,0,0]
    v_fma_mix_f32 v66, v89, 1.0, v66 op_sel:[0,0,0] op_sel_hi:[1,0,0]
    v_fma_mix_f32 v67, v89, 1.0, v67 op_sel:[1,0,0] op_sel_hi:[1,0,0]
    v_fma_mix_f32 v68, v90, 1.0, v68 op_sel:[0,0,0] op_sel_hi:[1,0,0]
    v_fma_mix_f32 v69, v90, 1.0, v69 op_sel:[1,0,0] op_sel_hi:[1,0,0]
    v_fma_mix_f32 v70, v91, 1.0, v70 op_sel:[0,0,0] op_sel_hi:[1,0,0]
    v_fma_mix_f32 v71, v91, 1.0, v71 op_sel:[1,0,0] op_sel_hi:[1,0,0]
    s_waitcnt vmcnt(4)
    v_lshlrev_b32 v56, 16, v8
    v_and_b32 v57, 0xffff0000, v8
    v_lshlrev_b32 v58, 16, v9
    v_and_b32 v59, 0xffff0000, v9
    v_lshlrev_b32 v60, 16, v10
    v_and_b32 v61, 0xffff0000, v10
    v_lshlrev_b32 v62, 16, v11
    v_and_b32 v63, 0xffff0000, v11
    v_fmac_f32 v56, v64, v32
    v_fmac_f32 v57, v65, v33
    v_fmac_f32 v58, v66, v34
    v_fmac_f32 v59, v67, v35
    v_fmac_f32 v60, v68, v36
    v_fmac_f32 v61, v69, v37
    v_fmac_f32 v62, v70, v38
    v_fmac_f32 v63, v71, v39
    buffer_store_dwordx4 v[56:59], v6, s[20:23], s30 offen
    buffer_store_dwordx4 v[60:63], v6, s[20:23], s30 offen offset:32
    v_add_f32 v72, v56, v57
    v_add_f32 v72, v72, v58
    v_add_f32 v72, v72, v59
    v_add_f32 v72, v72, v60
    v_add_f32 v72, v72, v61
    v_add_f32 v72, v72, v62
    v_add_f32 v72, v72, v63
    s_nop 1
    v_add_f32_dpp v72, v72, v72 quad_perm:[1,0,3,2] row_mask:0xf bank_mask:0xf
    s_nop 1
    v_add_f32_dpp v72, v72, v72 quad_perm:[2,3,0,1] row_mask:0xf bank_mask:0xf
    s_nop 1
    v_add_f32_dpp v72, v72, v72 row_half_mirror row_mask:0xf bank_mask:0xf
    s_nop 1
    v_add_f32_dpp v72, v72, v72 row_mirror row_mask:0xf bank_mask:0xf
    v_mov_b32 v73, v72
    s_nop 1
    v_permlane16_swap_b32 v72, v73
    s_nop 1
    v_add_f32 v72, v72, v73
    v_mov_b32 v73, v72
    s_nop 1
    v_permlane32_swap_b32 v72, v73
    s_nop 1
    v_add_f32 v72, v72, v73
    v_mul_f32 v72, 0x3b000000, v72
    v_sub_f32 v64, v56, v72
    v_sub_f32 v65, v57, v72
    v_sub_f32 v66, v58, v72
    v_sub_f32 v67, v59, v72
    v_sub_f32 v68, v60, v72
    v_sub_f32 v69, v61, v72
    v_sub_f32 v70, v62, v72
    v_sub_f32 v71, v63, v72
    v_mul_f32 v74, v64, v64
    v_fmac_f32 v74, v65, v65
    v_fmac_f32 v74, v66, v66
    v_fmac_f32 v74, v67, v67
    v_fmac_f32 v74, v68, v68
    v_fmac_f32 v74, v69, v69
    v_fmac_f32 v74, v70, v70
    v_fmac_f32 v74, v71, v71
    s_nop 1
    v_add_f32_dpp v74, v74, v74 quad_perm:[1,0,3,2] row_mask:0xf bank_mask:0xf
    s_nop 1
    v_add_f32_dpp v74, v74, v74 quad_perm:[2,3,0,1] row_mask:0xf bank_mask:0xf
    s_nop 1
    v_add_f32_dpp v74, v74, v74 row_half_mirror row_mask:0xf bank_mask:0xf
    s_nop 1
    v_add_f32_dpp v74, v74, v74 row_mirror row_mask:0xf bank_mask:0xf
    v_mov_b32 v73, v74
    s_nop 1
    v_permlane16_swap_b32 v74, v73
    s_nop 1
    v_add_f32 v74, v74, v73
    v_mov_b32 v73, v74
    s_nop 1
    v_permlane32_swap_b32 v74, v73
    s_nop 1
    v_add_f32 v74, v74, v73
    v_mov_b32 v73, 0x3727c5ac
    v_fmac_f32 v73, 0x3b000000, v74
    v_rsq_f32 v73, v73
    s_waitcnt vmcnt(2)
    v_mul_f32 v64, v64, v73
    v_mul_f32 v65, v65, v73
    v_mul_f32 v66, v66, v73
    v_mul_f32 v67, v67, v73
    v_mul_f32 v68, v68, v73
    v_mul_f32 v69, v69, v73
    v_mul_f32 v70, v70, v73
    v_mul_f32 v71, v71, v73
    v_fma_f32 v64, v64, v48, v40
    v_fma_f32 v65, v65, v49, v41
    v_fma_f32 v66, v66, v50, v42
    v_fma_f32 v67, v67, v51, v43
    v_fma_f32 v68, v68, v52, v44
    v_fma_f32 v69, v69, v53, v45
    v_fma_f32 v70, v70, v54, v46
    v_fma_f32 v71, v71, v55, v47
    v_cvt_pk_bf16_f32 v12, v64, v65
    v_cvt_pk_bf16_f32 v13, v66, v67
    v_cvt_pk_bf16_f32 v14, v68, v69
    v_cvt_pk_bf16_f32 v15, v70, v71
    buffer_store_dwordx2 v[12:13], v4, s[24:27], s3 offen
    buffer_store_dwordx2 v[14:15], v4, s[24:27], s3 offen offset:16
.Lln2_end:
    s_endpgm
.globl k_gu_kernel
.p2align 8
.type k_gu_kernel,@function
k_gu_kernel:
    s_cmp_ge_u32 s2, 224
    s_cbranch_scc1 .end_40
    s_load_dwordx2 s[40:41], s[0:1], 56
    s_load_dwordx2 s[42:43], s[0:1], 64
    s_load_dwordx2 s[46:47], s[0:1], 112
    s_and_b32 s35, s2, 7
    s_lshr_b32 s36, s2, 3
    s_mul_i32 s37, s36, 37
    s_lshr_b32 s37, s37, 8
    s_mul_i32 s38, s37, 7
    s_sub_u32 s38, s36, s38
    s_lshr_b32 s39, s35, 1
    s_lshl_b32 s39, s39, 2
    s_add_u32 s39, s39, s37
    s_and_b32 s54, s35, 1
    s_mul_i32 s54, s54, 7
    s_add_u32 s38, s38, s54
    v_and_b32 v1, 63, v0
    v_lshrrev_b32 v2, 6, v0
    s_nop 0
    v_readfirstlane_b32 s28, v2
    s_nop 2
    v_lshrrev_b32 v16, 3, v1
    s_lshl_b32 s90, s28, 3
    v_add_u32 v16, s90, v16
    v_bfe_u32 v10, v16, 1, 3
    v_and_b32 v11, 7, v1
    v_xor_b32 v10, v10, v11
    s_mov_b32 s90, 1024
    v_mul_lo_u32 v16, v16, s90
    v_lshl_add_u32 v16, v10, 4, v16
    v_lshrrev_b32 v17, 4, v1
    s_mul_i32 s90, s28, 4
    v_add_u32 v17, s90, v17
    v_and_b32 v10, 3, v17
    v_lshlrev_b32 v10, 2, v10
    s_mov_b32 s90, 3584
    v_mul_lo_u32 v17, v17, s90
    v_and_b32 v11, 15, v1
    v_xor_b32 v10, v10, v11
    v_lshl_add_u32 v17, v10, 4, v17
    s_lshl_b32 s33, s28, 10
    s_waitcnt lgkmcnt(0)
    s_add_u32 s4, s46, 0x4800000
    s_addc_u32 s5, s47, 0
    s_and_b32 s5, s5, 0xffff
    s_mov_b32 s6, 0x200000
    s_mov_b32 s7, 0x20000
    s_mov_b32 s8, s40
    s_and_b32 s9, s41, 0xffff
    s_mov_b32 s10, 0x1c0000
    s_mov_b32 s11, 0x20000
    s_mov_b32 s12, s42
    s_and_b32 s13, s43, 0xffff
    s_mov_b32 s14, 0x1c0000
    s_mov_b32 s15, 0x20000
    s_lshl_b32 s24, s39, 17
    s_lshl_b32 s25, s38, 8
    s_mov_b32 s26, s25
    s_add_u32 m0, s33, 0
    s_add_u32 s34, s24, 0
    buffer_load_dwordx4 v16, s[4:7], s34 offen lds
    s_add_u32 m0, s33, 8192
    s_add_u32 s34, s24, 65536
    buffer_load_dwordx4 v16, s[4:7], s34 offen lds
    s_add_u32 m0, s33, 16384
    s_add_u32 s34, s25, 0
    buffer_load_dwordx4 v17, s[8:11], s34 offen lds
    s_add_u32 m0, s33, 24576
    s_add_u32 s34, s25, 114688
    buffer_load_dwordx4 v17, s[8:11], s34 offen lds
    s_add_u32 m0, s33, 32768
    s_add_u32 s34, s26, 0
    buffer_load_dwordx4 v17, s[12:15], s34 offen lds
    s_add_u32 m0, s33, 40960
    s_add_u32 s34, s26, 114688
    buffer_load_dwordx4 v17, s[12:15], s34 offen lds
    s_and_b32 s29, s28, 3
    s_lshr_b32 s30, s28, 2
    v_and_b32 v4, 31, v1
    v_lshrrev_b32 v5, 5, v1
    v_bfe_u32 v6, v1, 2, 2
    v_and_b32 v7, 3, v1
    v_bfe_u32 v8, v1, 4, 1
    s_mul_i32 s31, s30, 8192
    v_bfe_u32 v116, v4, 1, 3
    v_xor_b32 v116, v116, v5
    v_lshlrev_b32 v116, 4, v116
    v_lshl_add_u32 v116, v4, 7, v116
    v_add_u32 v116, s31, v116
    v_xor_b32 v117, 32, v116
    v_xor_b32 v118, 64, v116
    v_xor_b32 v119, 96, v116
    s_mul_i32 s31, s29, 1
    s_add_u32 s31, s31, 0
    s_and_b32 s32, s31, 3
    s_lshr_b32 s31, s31, 2
    s_lshl_b32 s31, s31, 8
    v_lshl_add_u32 v120, v5, 3, v6
    v_mul_u32_u24 v120, 256, v120
    v_xor_b32 v10, s32, v6
    v_lshl_add_u32 v120, v10, 6, v120
    v_lshl_add_u32 v120, v8, 5, v120
    v_lshl_add_u32 v120, v7, 3, v120
    v_add_u32 v120, 0x4000, v120
    v_add_u32 v120, s31, v120
    s_mul_i32 s31, s29, 1
    s_add_u32 s31, s31, 0
    s_and_b32 s32, s31, 3
    s_lshr_b32 s31, s31, 2
    s_lshl_b32 s31, s31, 8
    v_lshl_add_u32 v121, v5, 3, v6
    v_mul_u32_u24 v121, 256, v121
    v_xor_b32 v10, s32, v6
    v_lshl_add_u32 v121, v10, 6, v121
    v_lshl_add_u32 v121, v8, 5, v121
    v_lshl_add_u32 v121, v7, 3, v121
    v_add_u32 v121, 0x8000, v121
    v_add_u32 v121, s31, v121
    v_add_u32 v122, 0x10000, v116
    v_add_u32 v123, 0x10000, v117
    v_add_u32 v124, 0x10000, v118
    v_add_u32 v125, 0x10000, v119
    v_add_u32 v126, 0x20000, v116
    v_add_u32 v127, 0x20000, v117
    v_add_u32 v128, 0x20000, v118
    v_add_u32 v129, 0x20000, v119
    v_add_u32 v130, 0x10000, v120
    v_add_u32 v131, 0x10000, v121
    v_add_u32 v132, 0x20000, v120
    v_add_u32 v133, 0x20000, v121
    s_add_u32 s16, s46, 0x4c00000
    s_addc_u32 s17, s47, 0
    s_and_b32 s17, s17, 0xffff
    s_mov_b32 s18, 0x700000
    s_mov_b32 s19, 0x20000
    s_add_u32 m0, s33, 49152
    s_add_u32 s34, s24, 128
    buffer_load_dwordx4 v16, s[4:7], s34 offen lds
    s_add_u32 m0, s33, 57344
    s_add_u32 s34, s24, 65664
    buffer_load_dwordx4 v16, s[4:7], s34 offen lds
    s_add_u32 m0, s33, 65536
    s_add_u32 s34, s25, 229376
    buffer_load_dwordx4 v17, s[8:11], s34 offen lds
    s_add_u32 m0, s33, 73728
    s_add_u32 s34, s25, 344064
    buffer_load_dwordx4 v17, s[8:11], s34 offen lds
    s_add_u32 m0, s33, 81920
    s_add_u32 s34, s26, 229376
    buffer_load_dwordx4 v17, s[12:15], s34 offen lds
    s_add_u32 m0, s33, 90112
    s_add_u32 s34, s26, 344064
    buffer_load_dwordx4 v17, s[12:15], s34 offen lds
    s_waitcnt vmcnt(6)
    s_barrier
    ds_read_b128 v[20:23], v116 offset:0
    ds_read_b128 v[24:27], v116 offset:4096
    ds_read_b64_tr_b16 v[28:29], v120 offset:0
    ds_read_b64_tr_b16 v[30:31], v120 offset:1024
    ds_read_b64_tr_b16 v[32:33], v121 offset:0
    ds_read_b64_tr_b16 v[34:35], v121 offset:1024
    s_waitcnt lgkmcnt(0)
    ds_read_b128 v[36:39], v117 offset:0
    ds_read_b128 v[40:43], v117 offset:4096
    ds_read_b64_tr_b16 v[44:45], v120 offset:4096
    ds_read_b64_tr_b16 v[46:47], v120 offset:5120
    ds_read_b64_tr_b16 v[48:49], v121 offset:4096
    ds_read_b64_tr_b16 v[50:51], v121 offset:5120
    v_mfma_f32_32x32x16_bf16 v[52:67], v[28:31], v[20:23], 0
    s_add_u32 m0, s33, 98304
    s_add_u32 s34, s24, 256
    buffer_load_dwordx4 v16, s[4:7], s34 offen lds
    v_mfma_f32_32x32x16_bf16 v[68:83], v[28:31], v[24:27], 0
    s_add_u32 m0, s33, 106496
    s_add_u32 s34, s24, 65792
    buffer_load_dwordx4 v16, s[4:7], s34 offen lds
    v_mfma_f32_32x32x16_bf16 v[84:99], v[32:35], v[20:23], 0
    s_add_u32 m0, s33, 114688
    s_add_u32 s34, s25, 458752
    buffer_load_dwordx4 v17, s[8:11], s34 offen lds
    v_mfma_f32_32x32x16_bf16 v[100:115], v[32:35], v[24:27], 0
    s_add_u32 m0, s33, 122880
    s_add_u32 s34, s25, 573440
    buffer_load_dwordx4 v17, s[8:11], s34 offen lds
    s_waitcnt lgkmcnt(0)
    ds_read_b128 v[20:23], v118 offset:0
    ds_read_b128 v[24:27], v118 offset:4096
    ds_read_b64_tr_b16 v[28:29], v120 offset:8192
    ds_read_b64_tr_b16 v[30:31], v120 offset:9216
    ds_read_b64_tr_b16 v[32:33], v121 offset:8192
    ds_read_b64_tr_b16 v[34:35], v121 offset:9216
    v_mfma_f32_32x32x16_bf16 v[52:67], v[44:47], v[36:39], v[52:67]
    s_add_u32 m0, s33, 131072
    s_add_u32 s34, s26, 458752
    buffer_load_dwordx4 v17, s[12:15], s34 offen lds
    v_mfma_f32_32x32x16_bf16 v[68:83], v[44:47], v[40:43], v[68:83]
    s_add_u32 m0, s33, 139264
    s_add_u32 s34, s26, 573440
    buffer_load_dwordx4 v17, s[12:15], s34 offen lds
    v_mfma_f32_32x32x16_bf16 v[84:99], v[48:51], v[36:39], v[84:99]
    v_mfma_f32_32x32x16_bf16 v[100:115], v[48:51], v[40:43], v[100:115]
    s_waitcnt lgkmcnt(0)
    ds_read_b128 v[36:39], v119 offset:0
    ds_read_b128 v[40:43], v119 offset:4096
    ds_read_b64_tr_b16 v[44:45], v120 offset:12288
    ds_read_b64_tr_b16 v[46:47], v120 offset:13312
    ds_read_b64_tr_b16 v[48:49], v121 offset:12288
    ds_read_b64_tr_b16 v[50:51], v121 offset:13312
    v_mfma_f32_32x32x16_bf16 v[52:67], v[28:31], v[20:23], v[52:67]
    v_mfma_f32_32x32x16_bf16 v[68:83], v[28:31], v[24:27], v[68:83]
    v_mfma_f32_32x32x16_bf16 v[84:99], v[32:35], v[20:23], v[84:99]
    v_mfma_f32_32x32x16_bf16 v[100:115], v[32:35], v[24:27], v[100:115]
    s_waitcnt lgkmcnt(0)
    s_waitcnt vmcnt(6)
    s_barrier
    ds_read_b128 v[20:23], v116 offset:49152
    ds_read_b128 v[24:27], v116 offset:53248
    ds_read_b64_tr_b16 v[28:29], v120 offset:49152
    ds_read_b64_tr_b16 v[30:31], v120 offset:50176
    ds_read_b64_tr_b16 v[32:33], v121 offset:49152
    ds_read_b64_tr_b16 v[34:35], v121 offset:50176
    v_mfma_f32_32x32x16_bf16 v[52:67], v[44:47], v[36:39], v[52:67]
    s_add_u32 m0, s33, 0
    s_add_u32 s34, s24, 384
    buffer_load_dwordx4 v16, s[4:7], s34 offen lds
    v_mfma_f32_32x32x16_bf16 v[68:83], v[44:47], v[40:43], v[68:83]
    s_add_u32 m0, s33, 8192
    s_add_u32 s34, s24, 65920
    buffer_load_dwordx4 v16, s[4:7], s34 offen lds
    v_mfma_f32_32x32x16_bf16 v[84:99], v[48:51], v[36:39], v[84:99]
    s_add_u32 m0, s33, 16384
    s_add_u32 s34, s25, 688128
    buffer_load_dwordx4 v17, s[8:11], s34 offen lds
    v_mfma_f32_32x32x16_bf16 v[100:115], v[48:51], v[40:43], v[100:115]
    s_add_u32 m0, s33, 24576
    s_add_u32 s34, s25, 802816
    buffer_load_dwordx4 v17, s[8:11], s34 offen lds
    s_waitcnt lgkmcnt(0)
    ds_read_b128 v[36:39], v117 offset:49152
    ds_read_b128 v[40:43], v117 offset:53248
    ds_read_b64_tr_b16 v[44:45], v120 offset:53248
    ds_read_b64_tr_b16 v[46:47], v120 offset:54272
    ds_read_b64_tr_b16 v[48:49], v121 offset:53248
    ds_read_b64_tr_b16 v[50:51], v121 offset:54272
    v_mfma_f32_32x32x16_bf16 v[52:67], v[28:31], v[20:23], v[52:67]
    s_add_u32 m0, s33, 32768
    s_add_u32 s34, s26, 688128
    buffer_load_dwordx4 v17, s[12:15], s34 offen lds
    v_mfma_f32_32x32x16_bf16 v[68:83], v[28:31], v[24:27], v[68:83]
    s_add_u32 m0, s33, 40960
    s_add_u32 s34, s26, 802816
    buffer_load_dwordx4 v17, s[12:15], s34 offen lds
    v_mfma_f32_32x32x16_bf16 v[84:99], v[32:35], v[20:23], v[84:99]
    v_mfma_f32_32x32x16_bf16 v[100:115], v[32:35], v[24:27], v[100:115]
    s_waitcnt lgkmcnt(0)
    ds_read_b128 v[20:23], v118 offset:49152
    ds_read_b128 v[24:27], v118 offset:53248
    ds_read_b64_tr_b16 v[28:29], v120 offset:57344
    ds_read_b64_tr_b16 v[30:31], v120 offset:58368
    ds_read_b64_tr_b16 v[32:33], v121 offset:57344
    ds_read_b64_tr_b16 v[34:35], v121 offset:58368
    v_mfma_f32_32x32x16_bf16 v[52:67], v[44:47], v[36:39], v[52:67]
    v_mfma_f32_32x32x16_bf16 v[68:83], v[44:47], v[40:43], v[68:83]
    v_mfma_f32_32x32x16_bf16 v[84:99], v[48:51], v[36:39], v[84:99]
    v_mfma_f32_32x32x16_bf16 v[100:115], v[48:51], v[40:43], v[100:115]
    s_waitcnt lgkmcnt(0)
    ds_read_b128 v[36:39], v119 offset:49152
    ds_read_b128 v[40:43], v119 offset:53248
    ds_read_b64_tr_b16 v[44:45], v120 offset:61440
    ds_read_b64_tr_b16 v[46:47], v120 offset:62464
    ds_read_b64_tr_b16 v[48:49], v121 offset:61440
    ds_read_b64_tr_b16 v[50:51], v121 offset:62464
    v_mfma_f32_32x32x16_bf16 v[52:67], v[28:31], v[20:23], v[52:67]
    v_mfma_f32_32x32x16_bf16 v[68:83], v[28:31], v[24:27], v[68:83]
    v_mfma_f32_32x32x16_bf16 v[84:99], v[32:35], v[20:23], v[84:99]
    v_mfma_f32_32x32x16_bf16 v[100:115], v[32:35], v[24:27], v[100:115]
    s_waitcnt lgkmcnt(0)
    s_waitcnt vmcnt(6)
    s_barrier
    ds_read_b128 v[20:23], v122 offset:32768
    ds_read_b128 v[24:27], v122 offset:36864
    ds_read_b64_tr_b16 v[28:29], v130 offset:32768
    ds_read_b64_tr_b16 v[30:31], v130 offset:33792
    ds_read_b64_tr_b16 v[32:33], v131 offset:32768
    ds_read_b64_tr_b16 v[34:35], v131 offset:33792
    v_mfma_f32_32x32x16_bf16 v[52:67], v[44:47], v[36:39], v[52:67]
    s_add_u32 m0, s33, 49152
    s_add_u32 s34, s24, 512
    buffer_load_dwordx4 v16, s[4:7], s34 offen lds
    v_mfma_f32_32x32x16_bf16 v[68:83], v[44:47], v[40:43], v[68:83]
    s_add_u32 m0, s33, 57344
    s_add_u32 s34, s24, 66048
    buffer_load_dwordx4 v16, s[4:7], s34 offen lds
    v_mfma_f32_32x32x16_bf16 v[84:99], v[48:51], v[36:39], v[84:99]
    s_add_u32 m0, s33, 65536
    s_add_u32 s34, s25, 917504
    buffer_load_dwordx4 v17, s[8:11], s34 offen lds
    v_mfma_f32_32x32x16_bf16 v[100:115], v[48:51], v[40:43], v[100:115]
    s_add_u32 m0, s33, 73728
    s_add_u32 s34, s25, 1032192
    buffer_load_dwordx4 v17, s[8:11], s34 offen lds
    s_waitcnt lgkmcnt(0)
    ds_read_b128 v[36:39], v123 offset:32768
    ds_read_b128 v[40:43], v123 offset:36864
    ds_read_b64_tr_b16 v[44:45], v130 offset:36864
    ds_read_b64_tr_b16 v[46:47], v130 offset:37888
    ds_read_b64_tr_b16 v[48:49], v131 offset:36864
    ds_read_b64_tr_b16 v[50:51], v131 offset:37888
    v_mfma_f32_32x32x16_bf16 v[52:67], v[28:31], v[20:23], v[52:67]
    s_add_u32 m0, s33, 81920
    s_add_u32 s34, s26, 917504
    buffer_load_dwordx4 v17, s[12:15], s34 offen lds
    v_mfma_f32_32x32x16_bf16 v[68:83], v[28:31], v[24:27], v[68:83]
    s_add_u32 m0, s33, 90112
    s_add_u32 s34, s26, 1032192
    buffer_load_dwordx4 v17, s[12:15], s34 offen lds
    v_mfma_f32_32x32x16_bf16 v[84:99], v[32:35], v[20:23], v[84:99]
    v_mfma_f32_32x32x16_bf16 v[100:115], v[32:35], v[24:27], v[100:115]
    s_waitcnt lgkmcnt(0)
    ds_read_b128 v[20:23], v124 offset:32768
    ds_read_b128 v[24:27], v124 offset:36864
    ds_read_b64_tr_b16 v[28:29], v130 offset:40960
    ds_read_b64_tr_b16 v[30:31], v130 offset:41984
    ds_read_b64_tr_b16 v[32:33], v131 offset:40960
    ds_read_b64_tr_b16 v[34:35], v131 offset:41984
    v_mfma_f32_32x32x16_bf16 v[52:67], v[44:47], v[36:39], v[52:67]
    v_mfma_f32_32x32x16_bf16 v[68:83], v[44:47], v[40:43], v[68:83]
    v_mfma_f32_32x32x16_bf16 v[84:99], v[48:51], v[36:39], v[84:99]
    v_mfma_f32_32x32x16_bf16 v[100:115], v[48:51], v[40:43], v[100:115]
    s_waitcnt lgkmcnt(0)
    ds_read_b128 v[36:39], v125 offset:32768
    ds_read_b128 v[40:43], v125 offset:36864
    ds_read_b64_tr_b16 v[44:45], v130 offset:45056
    ds_read_b64_tr_b16 v[46:47], v130 offset:46080
    ds_read_b64_tr_b16 v[48:49], v131 offset:45056
    ds_read_b64_tr_b16 v[50:51], v131 offset:46080
    v_mfma_f32_32x32x16_bf16 v[52:67], v[28:31], v[20:23], v[52:67]
    v_mfma_f32_32x32x16_bf16 v[68:83], v[28:31], v[24:27], v[68:83]
    v_mfma_f32_32x32x16_bf16 v[84:99], v[32:35], v[20:23], v[84:99]
    v_mfma_f32_32x32x16_bf16 v[100:115], v[32:35], v[24:27], v[100:115]
    s_waitcnt lgkmcnt(0)
    s_waitcnt vmcnt(6)
    s_barrier
    ds_read_b128 v[20:23], v116 offset:0
    ds_read_b128 v[24:27], v116 offset:4096
    ds_read_b64_tr_b16 v[28:29], v120 offset:0
    ds_read_b64_tr_b16 v[30:31], v120 offset:1024
    ds_read_b64_tr_b16 v[32:33], v121 offset:0
    ds_read_b64_tr_b16 v[34:35], v121 offset:1024
    v_mfma_f32_32x32x16_bf16 v[52:67], v[44:47], v[36:39], v[52:67]
    s_add_u32 m0, s33, 98304
    s_add_u32 s34, s24, 640
    buffer_load_dwordx4 v16, s[4:7], s34 offen lds
    v_mfma_f32_32x32x16_bf16 v[68:83], v[44:47], v[40:43], v[68:83]
    s_add_u32 m0, s33, 106496
    s_add_u32 s34, s24, 66176
    buffer_load_dwordx4 v16, s[4:7], s34 offen lds
    v_mfma_f32_32x32x16_bf16 v[84:99], v[48:51], v[36:39], v[84:99]
    s_add_u32 m0, s33, 114688
    s_add_u32 s34, s25, 1146880
    buffer_load_dwordx4 v17, s[8:11], s34 offen lds
    v_mfma_f32_32x32x16_bf16 v[100:115], v[48:51], v[40:43], v[100:115]
    s_add_u32 m0, s33, 122880
    s_add_u32 s34, s25, 1261568
    buffer_load_dwordx4 v17, s[8:11], s34 offen lds
    s_waitcnt lgkmcnt(0)
    ds_read_b128 v[36:39], v117 offset:0
    ds_read_b128 v[40:43], v117 offset:4096
    ds_read_b64_tr_b16 v[44:45], v120 offset:4096
    ds_read_b64_tr_b16 v[46:47], v120 offset:5120
    ds_read_b64_tr_b16 v[48:49], v121 offset:4096
    ds_read_b64_tr_b16 v[50:51], v121 offset:5120
    v_mfma_f32_32x32x16_bf16 v[52:67], v[28:31], v[20:23], v[52:67]
    s_add_u32 m0, s33, 131072
    s_add_u32 s34, s26, 1146880
    buffer_load_dwordx4 v17, s[12:15], s34 offen lds
    v_mfma_f32_32x32x16_bf16 v[68:83], v[28:31], v[24:27], v[68:83]
    s_add_u32 m0, s33, 139264
    s_add_u32 s34, s26, 1261568
    buffer_load_dwordx4 v17, s[12:15], s34 offen lds
    v_mfma_f32_32x32x16_bf16 v[84:99], v[32:35], v[20:23], v[84:99]
    v_mfma_f32_32x32x16_bf16 v[100:115], v[32:35], v[24:27], v[100:115]
    s_waitcnt lgkmcnt(0)
    ds_read_b128 v[20:23], v118 offset:0
    ds_read_b128 v[24:27], v118 offset:4096
    ds_read_b64_tr_b16 v[28:29], v120 offset:8192
    ds_read_b64_tr_b16 v[30:31], v120 offset:9216
    ds_read_b64_tr_b16 v[32:33], v121 offset:8192
    ds_read_b64_tr_b16 v[34:35], v121 offset:9216
    v_mfma_f32_32x32x16_bf16 v[52:67], v[44:47], v[36:39], v[52:67]
    v_mfma_f32_32x32x16_bf16 v[68:83], v[44:47], v[40:43], v[68:83]
    v_mfma_f32_32x32x16_bf16 v[84:99], v[48:51], v[36:39], v[84:99]
    v_mfma_f32_32x32x16_bf16 v[100:115], v[48:51], v[40:43], v[100:115]
    s_waitcnt lgkmcnt(0)
    ds_read_b128 v[36:39], v119 offset:0
    ds_read_b128 v[40:43], v119 offset:4096
    ds_read_b64_tr_b16 v[44:45], v120 offset:12288
    ds_read_b64_tr_b16 v[46:47], v120 offset:13312
    ds_read_b64_tr_b16 v[48:49], v121 offset:12288
    ds_read_b64_tr_b16 v[50:51], v121 offset:13312
    v_mfma_f32_32x32x16_bf16 v[52:67], v[28:31], v[20:23], v[52:67]
    v_mfma_f32_32x32x16_bf16 v[68:83], v[28:31], v[24:27], v[68:83]
    v_mfma_f32_32x32x16_bf16 v[84:99], v[32:35], v[20:23], v[84:99]
    v_mfma_f32_32x32x16_bf16 v[100:115], v[32:35], v[24:27], v[100:115]
    s_waitcnt lgkmcnt(0)
    s_waitcnt vmcnt(6)
    s_barrier
    ds_read_b128 v[20:23], v116 offset:49152
    ds_read_b128 v[24:27], v116 offset:53248
    ds_read_b64_tr_b16 v[28:29], v120 offset:49152
    ds_read_b64_tr_b16 v[30:31], v120 offset:50176
    ds_read_b64_tr_b16 v[32:33], v121 offset:49152
    ds_read_b64_tr_b16 v[34:35], v121 offset:50176
    v_mfma_f32_32x32x16_bf16 v[52:67], v[44:47], v[36:39], v[52:67]
    s_add_u32 m0, s33, 0
    s_add_u32 s34, s24, 768
    buffer_load_dwordx4 v16, s[4:7], s34 offen lds
    v_mfma_f32_32x32x16_bf16 v[68:83], v[44:47], v[40:43], v[68:83]
    s_add_u32 m0, s33, 8192
    s_add_u32 s34, s24, 66304
    buffer_load_dwordx4 v16, s[4:7], s34 offen lds
    v_mfma_f32_32x32x16_bf16 v[84:99], v[48:51], v[36:39], v[84:99]
    s_add_u32 m0, s33, 16384
    s_add_u32 s34, s25, 1376256
    buffer_load_dwordx4 v17, s[8:11], s34 offen lds
    v_mfma_f32_32x32x16_bf16 v[100:115], v[48:51], v[40:43], v[100:115]
    s_add_u32 m0, s33, 24576
    s_add_u32 s34, s25, 1490944
    buffer_load_dwordx4 v17, s[8:11], s34 offen lds
    s_waitcnt lgkmcnt(0)
    ds_read_b128 v[36:39], v117 offset:49152
    ds_read_b128 v[40:43], v117 offset:53248
    ds_read_b64_tr_b16 v[44:45], v120 offset:53248
    ds_read_b64_tr_b16 v[46:47], v120 offset:54272
    ds_read_b64_tr_b16 v[48:49], v121 offset:53248
    ds_read_b64_tr_b16 v[50:51], v121 offset:54272
    v_mfma_f32_32x32x16_bf16 v[52:67], v[28:31], v[20:23], v[52:67]
    s_add_u32 m0, s33, 32768
    s_add_u32 s34, s26, 1376256
    buffer_load_dwordx4 v17, s[12:15], s34 offen lds
    v_mfma_f32_32x32x16_bf16 v[68:83], v[28:31], v[24:27], v[68:83]
    s_add_u32 m0, s33, 40960
    s_add_u32 s34, s26, 1490944
    buffer_load_dwordx4 v17, s[12:15], s34 offen lds
    v_mfma_f32_32x32x16_bf16 v[84:99], v[32:35], v[20:23], v[84:99]
    v_mfma_f32_32x32x16_bf16 v[100:115], v[32:35], v[24:27], v[100:115]
    s_waitcnt lgkmcnt(0)
    ds_read_b128 v[20:23], v118 offset:49152
    ds_read_b128 v[24:27], v118 offset:53248
    ds_read_b64_tr_b16 v[28:29], v120 offset:57344
    ds_read_b64_tr_b16 v[30:31], v120 offset:58368
    ds_read_b64_tr_b16 v[32:33], v121 offset:57344
    ds_read_b64_tr_b16 v[34:35], v121 offset:58368
    v_mfma_f32_32x32x16_bf16 v[52:67], v[44:47], v[36:39], v[52:67]
    v_mfma_f32_32x32x16_bf16 v[68:83], v[44:47], v[40:43], v[68:83]
    v_mfma_f32_32x32x16_bf16 v[84:99], v[48:51], v[36:39], v[84:99]
    v_mfma_f32_32x32x16_bf16 v[100:115], v[48:51], v[40:43], v[100:115]
    s_waitcnt lgkmcnt(0)
    ds_read_b128 v[36:39], v119 offset:49152
    ds_read_b128 v[40:43], v119 offset:53248
    ds_read_b64_tr_b16 v[44:45], v120 offset:61440
    ds_read_b64_tr_b16 v[46:47], v120 offset:62464
    ds_read_b64_tr_b16 v[48:49], v121 offset:61440
    ds_read_b64_tr_b16 v[50:51], v121 offset:62464
    v_mfma_f32_32x32x16_bf16 v[52:67], v[28:31], v[20:23], v[52:67]
    v_mfma_f32_32x32x16_bf16 v[68:83], v[28:31], v[24:27], v[68:83]
    v_mfma_f32_32x32x16_bf16 v[84:99], v[32:35], v[20:23], v[84:99]
    v_mfma_f32_32x32x16_bf16 v[100:115], v[32:35], v[24:27], v[100:115]
    s_waitcnt lgkmcnt(0)
    s_waitcnt vmcnt(6)
    s_barrier
    ds_read_b128 v[20:23], v122 offset:32768
    ds_read_b128 v[24:27], v122 offset:36864
    ds_read_b64_tr_b16 v[28:29], v130 offset:32768
    ds_read_b64_tr_b16 v[30:31], v130 offset:33792
    ds_read_b64_tr_b16 v[32:33], v131 offset:32768
    ds_read_b64_tr_b16 v[34:35], v131 offset:33792
    v_mfma_f32_32x32x16_bf16 v[52:67], v[44:47], v[36:39], v[52:67]
    s_add_u32 m0, s33, 49152
    s_add_u32 s34, s24, 896
    buffer_load_dwordx4 v16, s[4:7], s34 offen lds
    v_mfma_f32_32x32x16_bf16 v[68:83], v[44:47], v[40:43], v[68:83]
    s_add_u32 m0, s33, 57344
    s_add_u32 s34, s24, 66432
    buffer_load_dwordx4 v16, s[4:7], s34 offen lds
    v_mfma_f32_32x32x16_bf16 v[84:99], v[48:51], v[36:39], v[84:99]
    s_add_u32 m0, s33, 65536
    s_add_u32 s34, s25, 1605632
    buffer_load_dwordx4 v17, s[8:11], s34 offen lds
    v_mfma_f32_32x32x16_bf16 v[100:115], v[48:51], v[40:43], v[100:115]
    s_add_u32 m0, s33, 73728
    s_add_u32 s34, s25, 1720320
    buffer_load_dwordx4 v17, s[8:11], s34 offen lds
    s_waitcnt lgkmcnt(0)
    ds_read_b128 v[36:39], v123 offset:32768
    ds_read_b128 v[40:43], v123 offset:36864
    ds_read_b64_tr_b16 v[44:45], v130 offset:36864
    ds_read_b64_tr_b16 v[46:47], v130 offset:37888
    ds_read_b64_tr_b16 v[48:49], v131 offset:36864
    ds_read_b64_tr_b16 v[50:51], v131 offset:37888
    v_mfma_f32_32x32x16_bf16 v[52:67], v[28:31], v[20:23], v[52:67]
    s_add_u32 m0, s33, 81920
    s_add_u32 s34, s26, 1605632
    buffer_load_dwordx4 v17, s[12:15], s34 offen lds
    v_mfma_f32_32x32x16_bf16 v[68:83], v[28:31], v[24:27], v[68:83]
    s_add_u32 m0, s33, 90112
    s_add_u32 s34, s26, 1720320
    buffer_load_dwordx4 v17, s[12:15], s34 offen lds
    v_mfma_f32_32x32x16_bf16 v[84:99], v[32:35], v[20:23], v[84:99]
    v_mfma_f32_32x32x16_bf16 v[100:115], v[32:35], v[24:27], v[100:115]
    s_waitcnt lgkmcnt(0)
    ds_read_b128 v[20:23], v124 offset:32768
    ds_read_b128 v[24:27], v124 offset:36864
    ds_read_b64_tr_b16 v[28:29], v130 offset:40960
    ds_read_b64_tr_b16 v[30:31], v130 offset:41984
    ds_read_b64_tr_b16 v[32:33], v131 offset:40960
    ds_read_b64_tr_b16 v[34:35], v131 offset:41984
    v_mfma_f32_32x32x16_bf16 v[52:67], v[44:47], v[36:39], v[52:67]
    v_mfma_f32_32x32x16_bf16 v[68:83], v[44:47], v[40:43], v[68:83]
    v_mfma_f32_32x32x16_bf16 v[84:99], v[48:51], v[36:39], v[84:99]
    v_mfma_f32_32x32x16_bf16 v[100:115], v[48:51], v[40:43], v[100:115]
    s_waitcnt lgkmcnt(0)
    ds_read_b128 v[36:39], v125 offset:32768
    ds_read_b128 v[40:43], v125 offset:36864
    ds_read_b64_tr_b16 v[44:45], v130 offset:45056
    ds_read_b64_tr_b16 v[46:47], v130 offset:46080
    ds_read_b64_tr_b16 v[48:49], v131 offset:45056
    ds_read_b64_tr_b16 v[50:51], v131 offset:46080
    v_mfma_f32_32x32x16_bf16 v[52:67], v[28:31], v[20:23], v[52:67]
    v_mfma_f32_32x32x16_bf16 v[68:83], v[28:31], v[24:27], v[68:83]
    v_mfma_f32_32x32x16_bf16 v[84:99], v[32:35], v[20:23], v[84:99]
    v_mfma_f32_32x32x16_bf16 v[100:115], v[32:35], v[24:27], v[100:115]
    s_waitcnt lgkmcnt(0)
    s_waitcnt vmcnt(6)
    s_barrier
    ds_read_b128 v[20:23], v116 offset:0
    ds_read_b128 v[24:27], v116 offset:4096
    ds_read_b64_tr_b16 v[28:29], v120 offset:0
    ds_read_b64_tr_b16 v[30:31], v120 offset:1024
    ds_read_b64_tr_b16 v[32:33], v121 offset:0
    ds_read_b64_tr_b16 v[34:35], v121 offset:1024
    v_mfma_f32_32x32x16_bf16 v[52:67], v[44:47], v[36:39], v[52:67]
    v_mfma_f32_32x32x16_bf16 v[68:83], v[44:47], v[40:43], v[68:83]
    v_mfma_f32_32x32x16_bf16 v[84:99], v[48:51], v[36:39], v[84:99]
    v_mfma_f32_32x32x16_bf16 v[100:115], v[48:51], v[40:43], v[100:115]
    s_waitcnt lgkmcnt(0)
    ds_read_b128 v[36:39], v117 offset:0
    ds_read_b128 v[40:43], v117 offset:4096
    ds_read_b64_tr_b16 v[44:45], v120 offset:4096
    ds_read_b64_tr_b16 v[46:47], v120 offset:5120
    ds_read_b64_tr_b16 v[48:49], v121 offset:4096
    ds_read_b64_tr_b16 v[50:51], v121 offset:5120
    v_mfma_f32_32x32x16_bf16 v[52:67], v[28:31], v[20:23], v[52:67]
    v_mfma_f32_32x32x16_bf16 v[68:83], v[28:31], v[24:27], v[68:83]
    v_mfma_f32_32x32x16_bf16 v[84:99], v[32:35], v[20:23], v[84:99]
    v_mfma_f32_32x32x16_bf16 v[100:115], v[32:35], v[24:27], v[100:115]
    s_waitcnt lgkmcnt(0)
    ds_read_b128 v[20:23], v118 offset:0
    ds_read_b128 v[24:27], v118 offset:4096
    ds_read_b64_tr_b16 v[28:29], v120 offset:8192
    ds_read_b64_tr_b16 v[30:31], v120 offset:9216
    ds_read_b64_tr_b16 v[32:33], v121 offset:8192
    ds_read_b64_tr_b16 v[34:35], v121 offset:9216
    v_mfma_f32_32x32x16_bf16 v[52:67], v[44:47], v[36:39], v[52:67]
    v_mfma_f32_32x32x16_bf16 v[68:83], v[44:47], v[40:43], v[68:83]
    v_mfma_f32_32x32x16_bf16 v[84:99], v[48:51], v[36:39], v[84:99]
    v_mfma_f32_32x32x16_bf16 v[100:115], v[48:51], v[40:43], v[100:115]
    s_waitcnt lgkmcnt(0)
    ds_read_b128 v[36:39], v119 offset:0
    ds_read_b128 v[40:43], v119 offset:4096
    ds_read_b64_tr_b16 v[44:45], v120 offset:12288
    ds_read_b64_tr_b16 v[46:47], v120 offset:13312
    ds_read_b64_tr_b16 v[48:49], v121 offset:12288
    ds_read_b64_tr_b16 v[50:51], v121 offset:13312
    v_mfma_f32_32x32x16_bf16 v[52:67], v[28:31], v[20:23], v[52:67]
    v_mfma_f32_32x32x16_bf16 v[68:83], v[28:31], v[24:27], v[68:83]
    v_mfma_f32_32x32x16_bf16 v[84:99], v[32:35], v[20:23], v[84:99]
    v_mfma_f32_32x32x16_bf16 v[100:115], v[32:35], v[24:27], v[100:115]
    s_waitcnt lgkmcnt(0)
    s_waitcnt vmcnt(0)
    s_barrier
    ds_read_b128 v[20:23], v116 offset:49152
    ds_read_b128 v[24:27], v116 offset:53248
    ds_read_b64_tr_b16 v[28:29], v120 offset:49152
    ds_read_b64_tr_b16 v[30:31], v120 offset:50176
    ds_read_b64_tr_b16 v[32:33], v121 offset:49152
    ds_read_b64_tr_b16 v[34:35], v121 offset:50176
    v_mfma_f32_32x32x16_bf16 v[52:67], v[44:47], v[36:39], v[52:67]
    v_mfma_f32_32x32x16_bf16 v[68:83], v[44:47], v[40:43], v[68:83]
    v_mfma_f32_32x32x16_bf16 v[84:99], v[48:51], v[36:39], v[84:99]
    v_mfma_f32_32x32x16_bf16 v[100:115], v[48:51], v[40:43], v[100:115]
    s_waitcnt lgkmcnt(0)
    ds_read_b128 v[36:39], v117 offset:49152
    ds_read_b128 v[40:43], v117 offset:53248
    ds_read_b64_tr_b16 v[44:45], v120 offset:53248
    ds_read_b64_tr_b16 v[46:47], v120 offset:54272
    ds_read_b64_tr_b16 v[48:49], v121 offset:53248
    ds_read_b64_tr_b16 v[50:51], v121 offset:54272
    v_mfma_f32_32x32x16_bf16 v[52:67], v[28:31], v[20:23], v[52:67]
    v_mfma_f32_32x32x16_bf16 v[68:83], v[28:31], v[24:27], v[68:83]
    v_mfma_f32_32x32x16_bf16 v[84:99], v[32:35], v[20:23], v[84:99]
    v_mfma_f32_32x32x16_bf16 v[100:115], v[32:35], v[24:27], v[100:115]
    s_waitcnt lgkmcnt(0)
    ds_read_b128 v[20:23], v118 offset:49152
    ds_read_b128 v[24:27], v118 offset:53248
    ds_read_b64_tr_b16 v[28:29], v120 offset:57344
    ds_read_b64_tr_b16 v[30:31], v120 offset:58368
    ds_read_b64_tr_b16 v[32:33], v121 offset:57344
    ds_read_b64_tr_b16 v[34:35], v121 offset:58368
    v_mfma_f32_32x32x16_bf16 v[52:67], v[44:47], v[36:39], v[52:67]
    v_mfma_f32_32x32x16_bf16 v[68:83], v[44:47], v[40:43], v[68:83]
    v_mfma_f32_32x32x16_bf16 v[84:99], v[48:51], v[36:39], v[84:99]
    v_mfma_f32_32x32x16_bf16 v[100:115], v[48:51], v[40:43], v[100:115]
    s_waitcnt lgkmcnt(0)
    ds_read_b128 v[36:39], v119 offset:49152
    ds_read_b128 v[40:43], v119 offset:53248
    ds_read_b64_tr_b16 v[44:45], v120 offset:61440
    ds_read_b64_tr_b16 v[46:47], v120 offset:62464
    ds_read_b64_tr_b16 v[48:49], v121 offset:61440
    ds_read_b64_tr_b16 v[50:51], v121 offset:62464
    v_mfma_f32_32x32x16_bf16 v[52:67], v[28:31], v[20:23], v[52:67]
    v_mfma_f32_32x32x16_bf16 v[68:83], v[28:31], v[24:27], v[68:83]
    v_mfma_f32_32x32x16_bf16 v[84:99], v[32:35], v[20:23], v[84:99]
    v_mfma_f32_32x32x16_bf16 v[100:115], v[32:35], v[24:27], v[100:115]
    s_waitcnt lgkmcnt(0)
    v_mfma_f32_32x32x16_bf16 v[52:67], v[44:47], v[36:39], v[52:67]
    v_mfma_f32_32x32x16_bf16 v[68:83], v[44:47], v[40:43], v[68:83]
    v_mfma_f32_32x32x16_bf16 v[84:99], v[48:51], v[36:39], v[84:99]
    v_mfma_f32_32x32x16_bf16 v[100:115], v[48:51], v[40:43], v[100:115]
    s_nop 15
    v_lshlrev_b32 v134, 5, v4
    v_lshl_add_u32 v134, v5, 4, v134
    s_mul_i32 s34, s39, 458752
    s_mul_i32 s54, s30, 229376
    s_add_u32 s34, s34, s54
    s_lshl_b32 s54, s38, 13
    s_add_u32 s34, s34, s54
    s_lshl_b32 s54, s29, 11
    s_add_u32 s34, s34, s54
    v_max_f32 v52, 0, v52
    v_mul_f32 v52, v52, v84
    v_max_f32 v53, 0, v53
    v_mul_f32 v53, v53, v85
    v_max_f32 v54, 0, v54
    v_mul_f32 v54, v54, v86
    v_max_f32 v55, 0, v55
    v_mul_f32 v55, v55, v87
    v_max_f32 v56, 0, v56
    v_mul_f32 v56, v56, v88
    v_max_f32 v57, 0, v57
    v_mul_f32 v57, v57, v89
    v_max_f32 v58, 0, v58
    v_mul_f32 v58, v58, v90
    v_max_f32 v59, 0, v59
    v_mul_f32 v59, v59, v91
    v_max_f32 v60, 0, v60
    v_mul_f32 v60, v60, v92
    v_max_f32 v61, 0, v61
    v_mul_f32 v61, v61, v93
    v_max_f32 v62, 0, v62
    v_mul_f32 v62, v62, v94
    v_max_f32 v63, 0, v63
    v_mul_f32 v63, v63, v95
    v_max_f32 v64, 0, v64
    v_mul_f32 v64, v64, v96
    v_max_f32 v65, 0, v65
    v_mul_f32 v65, v65, v97
    v_max_f32 v66, 0, v66
    v_mul_f32 v66, v66, v98
    v_max_f32 v67, 0, v67
    v_mul_f32 v67, v67, v99
    s_add_u32 s54, s34, 0
    v_cvt_pk_bf16_f32 v20, v52, v53
    v_cvt_pk_bf16_f32 v21, v54, v55
    v_cvt_pk_bf16_f32 v22, v56, v57
    v_cvt_pk_bf16_f32 v23, v58, v59
    buffer_store_dwordx4 v[20:23], v134, s[16:19], s54 offen offset:0
    v_cvt_pk_bf16_f32 v24, v60, v61
    v_cvt_pk_bf16_f32 v25, v62, v63
    v_cvt_pk_bf16_f32 v26, v64, v65
    v_cvt_pk_bf16_f32 v27, v66, v67
    buffer_store_dwordx4 v[24:27], v134, s[16:19], s54 offen offset:1024
    v_max_f32 v68, 0, v68
    v_mul_f32 v68, v68, v100
    v_max_f32 v69, 0, v69
    v_mul_f32 v69, v69, v101
    v_max_f32 v70, 0, v70
    v_mul_f32 v70, v70, v102
    v_max_f32 v71, 0, v71
    v_mul_f32 v71, v71, v103
    v_max_f32 v72, 0, v72
    v_mul_f32 v72, v72, v104
    v_max_f32 v73, 0, v73
    v_mul_f32 v73, v73, v105
    v_max_f32 v74, 0, v74
    v_mul_f32 v74, v74, v106
    v_max_f32 v75, 0, v75
    v_mul_f32 v75, v75, v107
    v_max_f32 v76, 0, v76
    v_mul_f32 v76, v76, v108
    v_max_f32 v77, 0, v77
    v_mul_f32 v77, v77, v109
    v_max_f32 v78, 0, v78
    v_mul_f32 v78, v78, v110
    v_max_f32 v79, 0, v79
    v_mul_f32 v79, v79, v111
    v_max_f32 v80, 0, v80
    v_mul_f32 v80, v80, v112
    v_max_f32 v81, 0, v81
    v_mul_f32 v81, v81, v113
    v_max_f32 v82, 0, v82
    v_mul_f32 v82, v82, v114
    v_max_f32 v83, 0, v83
    v_mul_f32 v83, v83, v115
    s_add_u32 s54, s34, 114688
    v_cvt_pk_bf16_f32 v28, v68, v69
    v_cvt_pk_bf16_f32 v29, v70, v71
    v_cvt_pk_bf16_f32 v30, v72, v73
    v_cvt_pk_bf16_f32 v31, v74, v75
    buffer_store_dwordx4 v[28:31], v134, s[16:19], s54 offen offset:0
    v_cvt_pk_bf16_f32 v32, v76, v77
    v_cvt_pk_bf16_f32 v33, v78, v79
    v_cvt_pk_bf16_f32 v34, v80, v81
    v_cvt_pk_bf16_f32 v35, v82, v83
    buffer_store_dwordx4 v[32:35], v134, s[16:19], s54 offen offset:1024
.end_40:
    s_endpgm
.globl k_down_kernel
.p2align 8
.type k_down_kernel,@function
k_down_kernel:
    s_cmp_ge_u32 s2, 256
    s_cbranch_scc1 .end_41
    s_load_dwordx2 s[40:41], s[0:1], 72
    s_load_dwordx2 s[42:43], s[0:1], 96
    s_load_dwordx2 s[46:47], s[0:1], 112
    s_and_b32 s35, s2, 7
    s_lshr_b32 s36, s2, 3
    s_lshl_b32 s39, s35, 2
    s_lshr_b32 s37, s36, 3
    s_add_u32 s39, s39, s37
    s_and_b32 s38, s36, 7
    v_and_b32 v1, 63, v0
    v_lshrrev_b32 v2, 6, v0
    s_nop 0
    v_readfirstlane_b32 s28, v2
    s_mov_b32 s29, 0
    v_lshrrev_b32 v16, 3, v1
    s_lshl_b32 s90, s29, 3
    v_add_u32 v16, s90, v16
    v_bfe_u32 v10, v16, 1, 3
    v_and_b32 v11, 7, v1
    v_xor_b32 v10, v10, v11
    v_lshrrev_b32 v11, 5, v16
    s_mov_b32 s90, 114688
    v_mul_lo_u32 v11, v11, s90
    v_and_b32 v16, 31, v16
    v_lshl_add_u32 v16, v16, 5, v11
    v_and_b32 v11, 1, v10
    v_lshl_add_u32 v16, v11, 4, v16
    v_lshrrev_b32 v10, 1, v10
    v_lshl_add_u32 v16, v10, 10, v16
    v_xor_b32 v18, 0x800, v16
    v_lshrrev_b32 v17, 3, v1
    s_mul_i32 s90, s29, 8
    v_add_u32 v17, s90, v17
    v_bfe_u32 v10, v17, 1, 1
    v_lshlrev_b32 v10, 2, v10
    s_mov_b32 s90, 1024
    v_mul_lo_u32 v17, v17, s90
    v_and_b32 v11, 7, v1
    v_xor_b32 v10, v10, v11
    v_lshl_add_u32 v17, v10, 4, v17
    s_mul_i32 s24, s39, 229376
    s_lshl_b32 s54, s28, 12
    s_add_u32 s24, s24, s54
    s_lshl_b32 s25, s28, 16
    s_lshl_b32 s54, s38, 7
    s_add_u32 s25, s25, s54
    s_lshl_b32 s33, s28, 15
    s_waitcnt lgkmcnt(0)
    s_add_u32 s4, s46, 0x4c00000
    s_addc_u32 s5, s47, 0
    s_and_b32 s5, s5, 0xffff
    s_mov_b32 s6, 0x700000
    s_mov_b32 s7, 0x20000
    s_mov_b32 s8, s40
    s_and_b32 s9, s41, 0xffff
    s_mov_b32 s10, 0x1c0000
    s_mov_b32 s11, 0x20000
    s_add_u32 m0, s33, 0
    s_add_u32 s34, s24, 0
    buffer_load_dwordx4 v16, s[4:7], s34 offen lds
    s_add_u32 m0, s33, 1024
    s_add_u32 s34, s24, 256
    buffer_load_dwordx4 v18, s[4:7], s34 offen lds
    s_add_u32 m0, s33, 2048
    s_add_u32 s34, s24, 512
    buffer_load_dwordx4 v16, s[4:7], s34 offen lds
    s_add_u32 m0, s33, 3072
    s_add_u32 s34, s24, 768
    buffer_load_dwordx4 v18, s[4:7], s34 offen lds
    s_add_u32 m0, s33, 4096
    s_add_u32 s34, s24, 114688
    buffer_load_dwordx4 v16, s[4:7], s34 offen lds
    s_add_u32 m0, s33, 5120
    s_add_u32 s34, s24, 114944
    buffer_load_dwordx4 v18, s[4:7], s34 offen lds
    s_add_u32 m0, s33, 6144
    s_add_u32 s34, s24, 115200
    buffer_load_dwordx4 v16, s[4:7], s34 offen lds
    s_add_u32 m0, s33, 7168
    s_add_u32 s34, s24, 115456
    buffer_load_dwordx4 v18, s[4:7], s34 offen lds
    s_add_u32 m0, s33, 8192
    s_add_u32 s34, s25, 0
    buffer_load_dwordx4 v17, s[8:11], s34 offen lds
    s_add_u32 m0, s33, 9216
    s_add_u32 s34, s25, 8192
    buffer_load_dwordx4 v17, s[8:11], s34 offen lds
    s_add_u32 m0, s33, 10240
    s_add_u32 s34, s25, 16384
    buffer_load_dwordx4 v17, s[8:11], s34 offen lds
    s_add_u32 m0, s33, 11264
    s_add_u32 s34, s25, 24576
    buffer_load_dwordx4 v17, s[8:11], s34 offen lds
    s_add_u32 m0, s33, 12288
    s_add_u32 s34, s25, 32768
    buffer_load_dwordx4 v17, s[8:11], s34 offen lds
    s_add_u32 m0, s33, 13312
    s_add_u32 s34, s25, 40960
    buffer_load_dwordx4 v17, s[8:11], s34 offen lds
    s_add_u32 m0, s33, 14336
    s_add_u32 s34, s25, 49152
    buffer_load_dwordx4 v17, s[8:11], s34 offen lds
    s_add_u32 m0, s33, 15360
    s_add_u32 s34, s25, 57344
    buffer_load_dwordx4 v17, s[8:11], s34 offen lds
    s_add_u32 m0, s33, 16384
    s_add_u32 s34, s24, 16384
    buffer_load_dwordx4 v16, s[4:7], s34 offen lds
    s_add_u32 m0, s33, 17408
    s_add_u32 s34, s24, 16640
    buffer_load_dwordx4 v18, s[4:7], s34 offen lds
    s_add_u32 m0, s33, 18432
    s_add_u32 s34, s24, 16896
    buffer_load_dwordx4 v16, s[4:7], s34 offen lds
    s_add_u32 m0, s33, 19456
    s_add_u32 s34, s24, 17152
    buffer_load_dwordx4 v18, s[4:7], s34 offen lds
    s_add_u32 m0, s33, 20480
    s_add_u32 s34, s24, 131072
    buffer_load_dwordx4 v16, s[4:7], s34 offen lds
    s_add_u32 m0, s33, 21504
    s_add_u32 s34, s24, 131328
    buffer_load_dwordx4 v18, s[4:7], s34 offen lds
    s_add_u32 m0, s33, 22528
    s_add_u32 s34, s24, 131584
    buffer_load_dwordx4 v16, s[4:7], s34 offen lds
    s_add_u32 m0, s33, 23552
    s_add_u32 s34, s24, 131840
    buffer_load_dwordx4 v18, s[4:7], s34 offen lds
    s_add_u32 m0, s33, 24576
    s_add_u32 s34, s25, 262144
    buffer_load_dwordx4 v17, s[8:11], s34 offen lds
    s_add_u32 m0, s33, 25600
    s_add_u32 s34, s25, 270336
    buffer_load_dwordx4 v17, s[8:11], s34 offen lds
    s_add_u32 m0, s33, 26624
    s_add_u32 s34, s25, 278528
    buffer_load_dwordx4 v17, s[8:11], s34 offen lds
    s_add_u32 m0, s33, 27648
    s_add_u32 s34, s25, 286720
    buffer_load_dwordx4 v17, s[8:11], s34 offen lds
    s_add_u32 m0, s33, 28672
    s_add_u32 s34, s25, 294912
    buffer_load_dwordx4 v17, s[8:11], s34 offen lds
    s_add_u32 m0, s33, 29696
    s_add_u32 s34, s25, 303104
    buffer_load_dwordx4 v17, s[8:11], s34 offen lds
    s_add_u32 m0, s33, 30720
    s_add_u32 s34, s25, 311296
    buffer_load_dwordx4 v17, s[8:11], s34 offen lds
    s_add_u32 m0, s33, 31744
    s_add_u32 s34, s25, 319488
    buffer_load_dwordx4 v17, s[8:11], s34 offen lds
    s_mov_b32 s16, s42
    s_and_b32 s17, s43, 0xffff
    s_mov_b32 s18, 0x200000
    s_mov_b32 s19, 0x20000
    s_add_u32 s12, s46, 0x4400000
    s_addc_u32 s13, s47, 0
    s_and_b32 s13, s13, 0xffff
    s_mov_b32 s14, 0x400000
    s_mov_b32 s15, 0x20000
    s_mov_b32 s20, s46
    s_and_b32 s21, s47, 0xffff
    s_mov_b32 s22, 0x3000
    s_mov_b32 s23, 0x20000
    v_and_b32 v4, 31, v1
    v_lshrrev_b32 v5, 5, v1
    v_bfe_u32 v6, v1, 2, 2
    v_and_b32 v7, 3, v1
    v_bfe_u32 v8, v1, 4, 1
    v_bfe_u32 v20, v4, 1, 3
    v_xor_b32 v20, v20, v5
    v_lshlrev_b32 v20, 4, v20
    v_lshl_add_u32 v20, v4, 7, v20
    v_add_u32 v20, s33, v20
    v_xor_b32 v21, 32, v20
    v_xor_b32 v22, 64, v20
    v_xor_b32 v23, 96, v20
    v_lshl_add_u32 v24, v5, 2, v6
    v_mul_u32_u24 v24, 128, v24
    v_lshrrev_b32 v10, 1, v6
    v_xor_b32 v10, 0, v10
    v_lshl_add_u32 v24, v10, 6, v24
    v_lshl_add_u32 v24, v8, 5, v24
    v_lshl_add_u32 v24, v7, 3, v24
    v_add_u32 v24, 0x2000, v24
    v_add_u32 v24, s33, v24
    v_lshl_add_u32 v25, v5, 2, v6
    v_mul_u32_u24 v25, 128, v25
    v_lshrrev_b32 v10, 1, v6
    v_xor_b32 v10, 1, v10
    v_lshl_add_u32 v25, v10, 6, v25
    v_lshl_add_u32 v25, v8, 5, v25
    v_lshl_add_u32 v25, v7, 3, v25
    v_add_u32 v25, 0x2000, v25
    v_add_u32 v25, s33, v25
    s_waitcnt vmcnt(16)
    ds_read_b128 v[28:31], v20 offset:0
    ds_read_b128 v[32:35], v20 offset:4096
    ds_read_b64_tr_b16 v[36:37], v24 offset:0
    ds_read_b64_tr_b16 v[38:39], v24 offset:1024
    ds_read_b64_tr_b16 v[40:41], v25 offset:0
    ds_read_b64_tr_b16 v[42:43], v25 offset:1024
    s_waitcnt lgkmcnt(0)
    ds_read_b128 v[44:47], v21 offset:0
    ds_read_b128 v[48:51], v21 offset:4096
    ds_read_b64_tr_b16 v[52:53], v24 offset:2048
    ds_read_b64_tr_b16 v[54:55], v24 offset:3072
    ds_read_b64_tr_b16 v[56:57], v25 offset:2048
    ds_read_b64_tr_b16 v[58:59], v25 offset:3072
    v_mfma_f32_32x32x16_bf16 v[60:75], v[36:39], v[28:31], 0
    v_mfma_f32_32x32x16_bf16 v[76:91], v[36:39], v[32:35], 0
    v_mfma_f32_32x32x16_bf16 v[92:107], v[40:43], v[28:31], 0
    v_mfma_f32_32x32x16_bf16 v[108:123], v[40:43], v[32:35], 0
    s_waitcnt lgkmcnt(0)
    ds_read_b128 v[28:31], v22 offset:0
    ds_read_b128 v[32:35], v22 offset:4096
    ds_read_b64_tr_b16 v[36:37], v24 offset:4096
    ds_read_b64_tr_b16 v[38:39], v24 offset:5120
    ds_read_b64_tr_b16 v[40:41], v25 offset:4096
    ds_read_b64_tr_b16 v[42:43], v25 offset:5120
    v_mfma_f32_32x32x16_bf16 v[60:75], v[52:55], v[44:47], v[60:75]
    v_mfma_f32_32x32x16_bf16 v[76:91], v[52:55], v[48:51], v[76:91]
    v_mfma_f32_32x32x16_bf16 v[92:107], v[56:59], v[44:47], v[92:107]
    v_mfma_f32_32x32x16_bf16 v[108:123], v[56:59], v[48:51], v[108:123]
    s_waitcnt lgkmcnt(0)
    ds_read_b128 v[44:47], v23 offset:0
    ds_read_b128 v[48:51], v23 offset:4096
    ds_read_b64_tr_b16 v[52:53], v24 offset:6144
    ds_read_b64_tr_b16 v[54:55], v24 offset:7168
    ds_read_b64_tr_b16 v[56:57], v25 offset:6144
    ds_read_b64_tr_b16 v[58:59], v25 offset:7168
    v_mfma_f32_32x32x16_bf16 v[60:75], v[36:39], v[28:31], v[60:75]
    v_mfma_f32_32x32x16_bf16 v[76:91], v[36:39], v[32:35], v[76:91]
    v_mfma_f32_32x32x16_bf16 v[92:107], v[40:43], v[28:31], v[92:107]
    v_mfma_f32_32x32x16_bf16 v[108:123], v[40:43], v[32:35], v[108:123]
    s_waitcnt lgkmcnt(0)
    v_mfma_f32_32x32x16_bf16 v[60:75], v[52:55], v[44:47], v[60:75]
    v_mfma_f32_32x32x16_bf16 v[76:91], v[52:55], v[48:51], v[76:91]
    v_mfma_f32_32x32x16_bf16 v[92:107], v[56:59], v[44:47], v[92:107]
    v_mfma_f32_32x32x16_bf16 v[108:123], v[56:59], v[48:51], v[108:123]
    s_add_u32 m0, s33, 0
    s_add_u32 s34, s24, 32768
    buffer_load_dwordx4 v16, s[4:7], s34 offen lds
    s_add_u32 m0, s33, 1024
    s_add_u32 s34, s24, 33024
    buffer_load_dwordx4 v18, s[4:7], s34 offen lds
    s_add_u32 m0, s33, 2048
    s_add_u32 s34, s24, 33280
    buffer_load_dwordx4 v16, s[4:7], s34 offen lds
    s_add_u32 m0, s33, 3072
    s_add_u32 s34, s24, 33536
    buffer_load_dwordx4 v18, s[4:7], s34 offen lds
    s_add_u32 m0, s33, 4096
    s_add_u32 s34, s24, 147456
    buffer_load_dwordx4 v16, s[4:7], s34 offen lds
    s_add_u32 m0, s33, 5120
    s_add_u32 s34, s24, 147712
    buffer_load_dwordx4 v18, s[4:7], s34 offen lds
    s_add_u32 m0, s33, 6144
    s_add_u32 s34, s24, 147968
    buffer_load_dwordx4 v16, s[4:7], s34 offen lds
    s_add_u32 m0, s33, 7168
    s_add_u32 s34, s24, 148224
    buffer_load_dwordx4 v18, s[4:7], s34 offen lds
    s_add_u32 m0, s33, 8192
    s_add_u32 s34, s25, 524288
    buffer_load_dwordx4 v17, s[8:11], s34 offen lds
    s_add_u32 m0, s33, 9216
    s_add_u32 s34, s25, 532480
    buffer_load_dwordx4 v17, s[8:11], s34 offen lds
    s_add_u32 m0, s33, 10240
    s_add_u32 s34, s25, 540672
    buffer_load_dwordx4 v17, s[8:11], s34 offen lds
    s_add_u32 m0, s33, 11264
    s_add_u32 s34, s25, 548864
    buffer_load_dwordx4 v17, s[8:11], s34 offen lds
    s_add_u32 m0, s33, 12288
    s_add_u32 s34, s25, 557056
    buffer_load_dwordx4 v17, s[8:11], s34 offen lds
    s_add_u32 m0, s33, 13312
    s_add_u32 s34, s25, 565248
    buffer_load_dwordx4 v17, s[8:11], s34 offen lds
    s_add_u32 m0, s33, 14336
    s_add_u32 s34, s25, 573440
    buffer_load_dwordx4 v17, s[8:11], s34 offen lds
    s_add_u32 m0, s33, 15360
    s_add_u32 s34, s25, 581632
    buffer_load_dwordx4 v17, s[8:11], s34 offen lds
    s_waitcnt vmcnt(16)
    ds_read_b128 v[28:31], v20 offset:16384
    ds_read_b128 v[32:35], v20 offset:20480
    ds_read_b64_tr_b16 v[36:37], v24 offset:16384
    ds_read_b64_tr_b16 v[38:39], v24 offset:17408
    ds_read_b64_tr_b16 v[40:41], v25 offset:16384
    ds_read_b64_tr_b16 v[42:43], v25 offset:17408
    s_waitcnt lgkmcnt(0)
    ds_read_b128 v[44:47], v21 offset:16384
    ds_read_b128 v[48:51], v21 offset:20480
    ds_read_b64_tr_b16 v[52:53], v24 offset:18432
    ds_read_b64_tr_b16 v[54:55], v24 offset:19456
    ds_read_b64_tr_b16 v[56:57], v25 offset:18432
    ds_read_b64_tr_b16 v[58:59], v25 offset:19456
    v_mfma_f32_32x32x16_bf16 v[60:75], v[36:39], v[28:31], v[60:75]
    v_mfma_f32_32x32x16_bf16 v[76:91], v[36:39], v[32:35], v[76:91]
    v_mfma_f32_32x32x16_bf16 v[92:107], v[40:43], v[28:31], v[92:107]
    v_mfma_f32_32x32x16_bf16 v[108:123], v[40:43], v[32:35], v[108:123]
    s_waitcnt lgkmcnt(0)
    ds_read_b128 v[28:31], v22 offset:16384
    ds_read_b128 v[32:35], v22 offset:20480
    ds_read_b64_tr_b16 v[36:37], v24 offset:20480
    ds_read_b64_tr_b16 v[38:39], v24 offset:21504
    ds_read_b64_tr_b16 v[40:41], v25 offset:20480
    ds_read_b64_tr_b16 v[42:43], v25 offset:21504
    v_mfma_f32_32x32x16_bf16 v[60:75], v[52:55], v[44:47], v[60:75]
    v_mfma_f32_32x32x16_bf16 v[76:91], v[52:55], v[48:51], v[76:91]
    v_mfma_f32_32x32x16_bf16 v[92:107], v[56:59], v[44:47], v[92:107]
    v_mfma_f32_32x32x16_bf16 v[108:123], v[56:59], v[48:51], v[108:123]
    s_waitcnt lgkmcnt(0)
    ds_read_b128 v[44:47], v23 offset:16384
    ds_read_b128 v[48:51], v23 offset:20480
    ds_read_b64_tr_b16 v[52:53], v24 offset:22528
    ds_read_b64_tr_b16 v[54:55], v24 offset:23552
    ds_read_b64_tr_b16 v[56:57], v25 offset:22528
    ds_read_b64_tr_b16 v[58:59], v25 offset:23552
    v_mfma_f32_32x32x16_bf16 v[60:75], v[36:39], v[28:31], v[60:75]
    v_mfma_f32_32x32x16_bf16 v[76:91], v[36:39], v[32:35], v[76:91]
    v_mfma_f32_32x32x16_bf16 v[92:107], v[40:43], v[28:31], v[92:107]
    v_mfma_f32_32x32x16_bf16 v[108:123], v[40:43], v[32:35], v[108:123]
    s_waitcnt lgkmcnt(0)
    v_mfma_f32_32x32x16_bf16 v[60:75], v[52:55], v[44:47], v[60:75]
    v_mfma_f32_32x32x16_bf16 v[76:91], v[52:55], v[48:51], v[76:91]
    v_mfma_f32_32x32x16_bf16 v[92:107], v[56:59], v[44:47], v[92:107]
    v_mfma_f32_32x32x16_bf16 v[108:123], v[56:59], v[48:51], v[108:123]
    s_add_u32 m0, s33, 16384
    s_add_u32 s34, s24, 49152
    buffer_load_dwordx4 v16, s[4:7], s34 offen lds
    s_add_u32 m0, s33, 17408
    s_add_u32 s34, s24, 49408
    buffer_load_dwordx4 v18, s[4:7], s34 offen lds
    s_add_u32 m0, s33, 18432
    s_add_u32 s34, s24, 49664
    buffer_load_dwordx4 v16, s[4:7], s34 offen lds
    s_add_u32 m0, s33, 19456
    s_add_u32 s34, s24, 49920
    buffer_load_dwordx4 v18, s[4:7], s34 offen lds
    s_add_u32 m0, s33, 20480
    s_add_u32 s34, s24, 163840
    buffer_load_dwordx4 v16, s[4:7], s34 offen lds
    s_add_u32 m0, s33, 21504
    s_add_u32 s34, s24, 164096
    buffer_load_dwordx4 v18, s[4:7], s34 offen lds
    s_add_u32 m0, s33, 22528
    s_add_u32 s34, s24, 164352
    buffer_load_dwordx4 v16, s[4:7], s34 offen lds
    s_add_u32 m0, s33, 23552
    s_add_u32 s34, s24, 164608
    buffer_load_dwordx4 v18, s[4:7], s34 offen lds
    s_add_u32 m0, s33, 24576
    s_add_u32 s34, s25, 786432
    buffer_load_dwordx4 v17, s[8:11], s34 offen lds
    s_add_u32 m0, s33, 25600
    s_add_u32 s34, s25, 794624
    buffer_load_dwordx4 v17, s[8:11], s34 offen lds
    s_add_u32 m0, s33, 26624
    s_add_u32 s34, s25, 802816
    buffer_load_dwordx4 v17, s[8:11], s34 offen lds
    s_add_u32 m0, s33, 27648
    s_add_u32 s34, s25, 811008
    buffer_load_dwordx4 v17, s[8:11], s34 offen lds
    s_add_u32 m0, s33, 28672
    s_add_u32 s34, s25, 819200
    buffer_load_dwordx4 v17, s[8:11], s34 offen lds
    s_add_u32 m0, s33, 29696
    s_add_u32 s34, s25, 827392
    buffer_load_dwordx4 v17, s[8:11], s34 offen lds
    s_add_u32 m0, s33, 30720
    s_add_u32 s34, s25, 835584
    buffer_load_dwordx4 v17, s[8:11], s34 offen lds
    s_add_u32 m0, s33, 31744
    s_add_u32 s34, s25, 843776
    buffer_load_dwordx4 v17, s[8:11], s34 offen lds
    s_waitcnt vmcnt(16)
    ds_read_b128 v[28:31], v20 offset:0
    ds_read_b128 v[32:35], v20 offset:4096
    ds_read_b64_tr_b16 v[36:37], v24 offset:0
    ds_read_b64_tr_b16 v[38:39], v24 offset:1024
    ds_read_b64_tr_b16 v[40:41], v25 offset:0
    ds_read_b64_tr_b16 v[42:43], v25 offset:1024
    s_waitcnt lgkmcnt(0)
    ds_read_b128 v[44:47], v21 offset:0
    ds_read_b128 v[48:51], v21 offset:4096
    ds_read_b64_tr_b16 v[52:53], v24 offset:2048
    ds_read_b64_tr_b16 v[54:55], v24 offset:3072
    ds_read_b64_tr_b16 v[56:57], v25 offset:2048
    ds_read_b64_tr_b16 v[58:59], v25 offset:3072
    v_mfma_f32_32x32x16_bf16 v[60:75], v[36:39], v[28:31], v[60:75]
    v_mfma_f32_32x32x16_bf16 v[76:91], v[36:39], v[32:35], v[76:91]
    v_mfma_f32_32x32x16_bf16 v[92:107], v[40:43], v[28:31], v[92:107]
    v_mfma_f32_32x32x16_bf16 v[108:123], v[40:43], v[32:35], v[108:123]
    s_waitcnt lgkmcnt(0)
    ds_read_b128 v[28:31], v22 offset:0
    ds_read_b128 v[32:35], v22 offset:4096
    ds_read_b64_tr_b16 v[36:37], v24 offset:4096
    ds_read_b64_tr_b16 v[38:39], v24 offset:5120
    ds_read_b64_tr_b16 v[40:41], v25 offset:4096
    ds_read_b64_tr_b16 v[42:43], v25 offset:5120
    v_mfma_f32_32x32x16_bf16 v[60:75], v[52:55], v[44:47], v[60:75]
    v_mfma_f32_32x32x16_bf16 v[76:91], v[52:55], v[48:51], v[76:91]
    v_mfma_f32_32x32x16_bf16 v[92:107], v[56:59], v[44:47], v[92:107]
    v_mfma_f32_32x32x16_bf16 v[108:123], v[56:59], v[48:51], v[108:123]
    s_waitcnt lgkmcnt(0)
    ds_read_b128 v[44:47], v23 offset:0
    ds_read_b128 v[48:51], v23 offset:4096
    ds_read_b64_tr_b16 v[52:53], v24 offset:6144
    ds_read_b64_tr_b16 v[54:55], v24 offset:7168
    ds_read_b64_tr_b16 v[56:57], v25 offset:6144
    ds_read_b64_tr_b16 v[58:59], v25 offset:7168
    v_mfma_f32_32x32x16_bf16 v[60:75], v[36:39], v[28:31], v[60:75]
    v_mfma_f32_32x32x16_bf16 v[76:91], v[36:39], v[32:35], v[76:91]
    v_mfma_f32_32x32x16_bf16 v[92:107], v[40:43], v[28:31], v[92:107]
    v_mfma_f32_32x32x16_bf16 v[108:123], v[40:43], v[32:35], v[108:123]
    s_waitcnt lgkmcnt(0)
    v_mfma_f32_32x32x16_bf16 v[60:75], v[52:55], v[44:47], v[60:75]
    v_mfma_f32_32x32x16_bf16 v[76:91], v[52:55], v[48:51], v[76:91]
    v_mfma_f32_32x32x16_bf16 v[92:107], v[56:59], v[44:47], v[92:107]
    v_mfma_f32_32x32x16_bf16 v[108:123], v[56:59], v[48:51], v[108:123]
    s_add_u32 m0, s33, 0
    s_add_u32 s34, s24, 65536
    buffer_load_dwordx4 v16, s[4:7], s34 offen lds
    s_add_u32 m0, s33, 1024
    s_add_u32 s34, s24, 65792
    buffer_load_dwordx4 v18, s[4:7], s34 offen lds
    s_add_u32 m0, s33, 2048
    s_add_u32 s34, s24, 66048
    buffer_load_dwordx4 v16, s[4:7], s34 offen lds
    s_add_u32 m0, s33, 3072
    s_add_u32 s34, s24, 66304
    buffer_load_dwordx4 v18, s[4:7], s34 offen lds
    s_add_u32 m0, s33, 4096
    s_add_u32 s34, s24, 180224
    buffer_load_dwordx4 v16, s[4:7], s34 offen lds
    s_add_u32 m0, s33, 5120
    s_add_u32 s34, s24, 180480
    buffer_load_dwordx4 v18, s[4:7], s34 offen lds
    s_add_u32 m0, s33, 6144
    s_add_u32 s34, s24, 180736
    buffer_load_dwordx4 v16, s[4:7], s34 offen lds
    s_add_u32 m0, s33, 7168
    s_add_u32 s34, s24, 180992
    buffer_load_dwordx4 v18, s[4:7], s34 offen lds
    s_add_u32 m0, s33, 8192
    s_add_u32 s34, s25, 1048576
    buffer_load_dwordx4 v17, s[8:11], s34 offen lds
    s_add_u32 m0, s33, 9216
    s_add_u32 s34, s25, 1056768
    buffer_load_dwordx4 v17, s[8:11], s34 offen lds
    s_add_u32 m0, s33, 10240
    s_add_u32 s34, s25, 1064960
    buffer_load_dwordx4 v17, s[8:11], s34 offen lds
    s_add_u32 m0, s33, 11264
    s_add_u32 s34, s25, 1073152
    buffer_load_dwordx4 v17, s[8:11], s34 offen lds
    s_add_u32 m0, s33, 12288
    s_add_u32 s34, s25, 1081344
    buffer_load_dwordx4 v17, s[8:11], s34 offen lds
    s_add_u32 m0, s33, 13312
    s_add_u32 s34, s25, 1089536
    buffer_load_dwordx4 v17, s[8:11], s34 offen lds
    s_add_u32 m0, s33, 14336
    s_add_u32 s34, s25, 1097728
    buffer_load_dwordx4 v17, s[8:11], s34 offen lds
    s_add_u32 m0, s33, 15360
    s_add_u32 s34, s25, 1105920
    buffer_load_dwordx4 v17, s[8:11], s34 offen lds
    s_waitcnt vmcnt(16)
    ds_read_b128 v[28:31], v20 offset:16384
    ds_read_b128 v[32:35], v20 offset:20480
    ds_read_b64_tr_b16 v[36:37], v24 offset:16384
    ds_read_b64_tr_b16 v[38:39], v24 offset:17408
    ds_read_b64_tr_b16 v[40:41], v25 offset:16384
    ds_read_b64_tr_b16 v[42:43], v25 offset:17408
    s_waitcnt lgkmcnt(0)
    ds_read_b128 v[44:47], v21 offset:16384
    ds_read_b128 v[48:51], v21 offset:20480
    ds_read_b64_tr_b16 v[52:53], v24 offset:18432
    ds_read_b64_tr_b16 v[54:55], v24 offset:19456
    ds_read_b64_tr_b16 v[56:57], v25 offset:18432
    ds_read_b64_tr_b16 v[58:59], v25 offset:19456
    v_mfma_f32_32x32x16_bf16 v[60:75], v[36:39], v[28:31], v[60:75]
    v_mfma_f32_32x32x16_bf16 v[76:91], v[36:39], v[32:35], v[76:91]
    v_mfma_f32_32x32x16_bf16 v[92:107], v[40:43], v[28:31], v[92:107]
    v_mfma_f32_32x32x16_bf16 v[108:123], v[40:43], v[32:35], v[108:123]
    s_waitcnt lgkmcnt(0)
    ds_read_b128 v[28:31], v22 offset:16384
    ds_read_b128 v[32:35], v22 offset:20480
    ds_read_b64_tr_b16 v[36:37], v24 offset:20480
    ds_read_b64_tr_b16 v[38:39], v24 offset:21504
    ds_read_b64_tr_b16 v[40:41], v25 offset:20480
    ds_read_b64_tr_b16 v[42:43], v25 offset:21504
    v_mfma_f32_32x32x16_bf16 v[60:75], v[52:55], v[44:47], v[60:75]
    v_mfma_f32_32x32x16_bf16 v[76:91], v[52:55], v[48:51], v[76:91]
    v_mfma_f32_32x32x16_bf16 v[92:107], v[56:59], v[44:47], v[92:107]
    v_mfma_f32_32x32x16_bf16 v[108:123], v[56:59], v[48:51], v[108:123]
    s_waitcnt lgkmcnt(0)
    ds_read_b128 v[44:47], v23 offset:16384
    ds_read_b128 v[48:51], v23 offset:20480
    ds_read_b64_tr_b16 v[52:53], v24 offset:22528
    ds_read_b64_tr_b16 v[54:55], v24 offset:23552
    ds_read_b64_tr_b16 v[56:57], v25 offset:22528
    ds_read_b64_tr_b16 v[58:59], v25 offset:23552
    v_mfma_f32_32x32x16_bf16 v[60:75], v[36:39], v[28:31], v[60:75]
    v_mfma_f32_32x32x16_bf16 v[76:91], v[36:39], v[32:35], v[76:91]
    v_mfma_f32_32x32x16_bf16 v[92:107], v[40:43], v[28:31], v[92:107]
    v_mfma_f32_32x32x16_bf16 v[108:123], v[40:43], v[32:35], v[108:123]
    s_waitcnt lgkmcnt(0)
    v_mfma_f32_32x32x16_bf16 v[60:75], v[52:55], v[44:47], v[60:75]
    v_mfma_f32_32x32x16_bf16 v[76:91], v[52:55], v[48:51], v[76:91]
    v_mfma_f32_32x32x16_bf16 v[92:107], v[56:59], v[44:47], v[92:107]
    v_mfma_f32_32x32x16_bf16 v[108:123], v[56:59], v[48:51], v[108:123]
    s_add_u32 m0, s33, 16384
    s_add_u32 s34, s24, 81920
    buffer_load_dwordx4 v16, s[4:7], s34 offen lds
    s_add_u32 m0, s33, 17408
    s_add_u32 s34, s24, 82176
    buffer_load_dwordx4 v18, s[4:7], s34 offen lds
    s_add_u32 m0, s33, 18432
    s_add_u32 s34, s24, 82432
    buffer_load_dwordx4 v16, s[4:7], s34 offen lds
    s_add_u32 m0, s33, 19456
    s_add_u32 s34, s24, 82688
    buffer_load_dwordx4 v18, s[4:7], s34 offen lds
    s_add_u32 m0, s33, 20480
    s_add_u32 s34, s24, 196608
    buffer_load_dwordx4 v16, s[4:7], s34 offen lds
    s_add_u32 m0, s33, 21504
    s_add_u32 s34, s24, 196864
    buffer_load_dwordx4 v18, s[4:7], s34 offen lds
    s_add_u32 m0, s33, 22528
    s_add_u32 s34, s24, 197120
    buffer_load_dwordx4 v16, s[4:7], s34 offen lds
    s_add_u32 m0, s33, 23552
    s_add_u32 s34, s24, 197376
    buffer_load_dwordx4 v18, s[4:7], s34 offen lds
    s_add_u32 m0, s33, 24576
    s_add_u32 s34, s25, 1310720
    buffer_load_dwordx4 v17, s[8:11], s34 offen lds
    s_add_u32 m0, s33, 25600
    s_add_u32 s34, s25, 1318912
    buffer_load_dwordx4 v17, s[8:11], s34 offen lds
    s_add_u32 m0, s33, 26624
    s_add_u32 s34, s25, 1327104
    buffer_load_dwordx4 v17, s[8:11], s34 offen lds
    s_add_u32 m0, s33, 27648
    s_add_u32 s34, s25, 1335296
    buffer_load_dwordx4 v17, s[8:11], s34 offen lds
    s_add_u32 m0, s33, 28672
    s_add_u32 s34, s25, 1343488
    buffer_load_dwordx4 v17, s[8:11], s34 offen lds
    s_add_u32 m0, s33, 29696
    s_add_u32 s34, s25, 1351680
    buffer_load_dwordx4 v17, s[8:11], s34 offen lds
    s_add_u32 m0, s33, 30720
    s_add_u32 s34, s25, 1359872
    buffer_load_dwordx4 v17, s[8:11], s34 offen lds
    s_add_u32 m0, s33, 31744
    s_add_u32 s34, s25, 1368064
    buffer_load_dwordx4 v17, s[8:11], s34 offen lds
    s_waitcnt vmcnt(16)
    ds_read_b128 v[28:31], v20 offset:0
    ds_read_b128 v[32:35], v20 offset:4096
    ds_read_b64_tr_b16 v[36:37], v24 offset:0
    ds_read_b64_tr_b16 v[38:39], v24 offset:1024
    ds_read_b64_tr_b16 v[40:41], v25 offset:0
    ds_read_b64_tr_b16 v[42:43], v25 offset:1024
    s_waitcnt lgkmcnt(0)
    ds_read_b128 v[44:47], v21 offset:0
    ds_read_b128 v[48:51], v21 offset:4096
    ds_read_b64_tr_b16 v[52:53], v24 offset:2048
    ds_read_b64_tr_b16 v[54:55], v24 offset:3072
    ds_read_b64_tr_b16 v[56:57], v25 offset:2048
    ds_read_b64_tr_b16 v[58:59], v25 offset:3072
    v_mfma_f32_32x32x16_bf16 v[60:75], v[36:39], v[28:31], v[60:75]
    v_mfma_f32_32x32x16_bf16 v[76:91], v[36:39], v[32:35], v[76:91]
    v_mfma_f32_32x32x16_bf16 v[92:107], v[40:43], v[28:31], v[92:107]
    v_mfma_f32_32x32x16_bf16 v[108:123], v[40:43], v[32:35], v[108:123]
    s_waitcnt lgkmcnt(0)
    ds_read_b128 v[28:31], v22 offset:0
    ds_read_b128 v[32:35], v22 offset:4096
    ds_read_b64_tr_b16 v[36:37], v24 offset:4096
    ds_read_b64_tr_b16 v[38:39], v24 offset:5120
    ds_read_b64_tr_b16 v[40:41], v25 offset:4096
    ds_read_b64_tr_b16 v[42:43], v25 offset:5120
    v_mfma_f32_32x32x16_bf16 v[60:75], v[52:55], v[44:47], v[60:75]
    v_mfma_f32_32x32x16_bf16 v[76:91], v[52:55], v[48:51], v[76:91]
    v_mfma_f32_32x32x16_bf16 v[92:107], v[56:59], v[44:47], v[92:107]
    v_mfma_f32_32x32x16_bf16 v[108:123], v[56:59], v[48:51], v[108:123]
    s_waitcnt lgkmcnt(0)
    ds_read_b128 v[44:47], v23 offset:0
    ds_read_b128 v[48:51], v23 offset:4096
    ds_read_b64_tr_b16 v[52:53], v24 offset:6144
    ds_read_b64_tr_b16 v[54:55], v24 offset:7168
    ds_read_b64_tr_b16 v[56:57], v25 offset:6144
    ds_read_b64_tr_b16 v[58:59], v25 offset:7168
    v_mfma_f32_32x32x16_bf16 v[60:75], v[36:39], v[28:31], v[60:75]
    v_mfma_f32_32x32x16_bf16 v[76:91], v[36:39], v[32:35], v[76:91]
    v_mfma_f32_32x32x16_bf16 v[92:107], v[40:43], v[28:31], v[92:107]
    v_mfma_f32_32x32x16_bf16 v[108:123], v[40:43], v[32:35], v[108:123]
    s_waitcnt lgkmcnt(0)
    v_mfma_f32_32x32x16_bf16 v[60:75], v[52:55], v[44:47], v[60:75]
    v_mfma_f32_32x32x16_bf16 v[76:91], v[52:55], v[48:51], v[76:91]
    v_mfma_f32_32x32x16_bf16 v[92:107], v[56:59], v[44:47], v[92:107]
    v_mfma_f32_32x32x16_bf16 v[108:123], v[56:59], v[48:51], v[108:123]
    s_add_u32 m0, s33, 0
    s_add_u32 s34, s24, 98304
    buffer_load_dwordx4 v16, s[4:7], s34 offen lds
    s_add_u32 m0, s33, 1024
    s_add_u32 s34, s24, 98560
    buffer_load_dwordx4 v18, s[4:7], s34 offen lds
    s_add_u32 m0, s33, 2048
    s_add_u32 s34, s24, 98816
    buffer_load_dwordx4 v16, s[4:7], s34 offen lds
    s_add_u32 m0, s33, 3072
    s_add_u32 s34, s24, 99072
    buffer_load_dwordx4 v18, s[4:7], s34 offen lds
    s_add_u32 m0, s33, 4096
    s_add_u32 s34, s24, 212992
    buffer_load_dwordx4 v16, s[4:7], s34 offen lds
    s_add_u32 m0, s33, 5120
    s_add_u32 s34, s24, 213248
    buffer_load_dwordx4 v18, s[4:7], s34 offen lds
    s_add_u32 m0, s33, 6144
    s_add_u32 s34, s24, 213504
    buffer_load_dwordx4 v16, s[4:7], s34 offen lds
    s_add_u32 m0, s33, 7168
    s_add_u32 s34, s24, 213760
    buffer_load_dwordx4 v18, s[4:7], s34 offen lds
    s_add_u32 m0, s33, 8192
    s_add_u32 s34, s25, 1572864
    buffer_load_dwordx4 v17, s[8:11], s34 offen lds
    s_add_u32 m0, s33, 9216
    s_add_u32 s34, s25, 1581056
    buffer_load_dwordx4 v17, s[8:11], s34 offen lds
    s_add_u32 m0, s33, 10240
    s_add_u32 s34, s25, 1589248
    buffer_load_dwordx4 v17, s[8:11], s34 offen lds
    s_add_u32 m0, s33, 11264
    s_add_u32 s34, s25, 1597440
    buffer_load_dwordx4 v17, s[8:11], s34 offen lds
    s_add_u32 m0, s33, 12288
    s_add_u32 s34, s25, 1605632
    buffer_load_dwordx4 v17, s[8:11], s34 offen lds
    s_add_u32 m0, s33, 13312
    s_add_u32 s34, s25, 1613824
    buffer_load_dwordx4 v17, s[8:11], s34 offen lds
    s_add_u32 m0, s33, 14336
    s_add_u32 s34, s25, 1622016
    buffer_load_dwordx4 v17, s[8:11], s34 offen lds
    s_add_u32 m0, s33, 15360
    s_add_u32 s34, s25, 1630208
    buffer_load_dwordx4 v17, s[8:11], s34 offen lds
    s_waitcnt vmcnt(16)
    ds_read_b128 v[28:31], v20 offset:16384
    ds_read_b128 v[32:35], v20 offset:20480
    ds_read_b64_tr_b16 v[36:37], v24 offset:16384
    ds_read_b64_tr_b16 v[38:39], v24 offset:17408
    ds_read_b64_tr_b16 v[40:41], v25 offset:16384
    ds_read_b64_tr_b16 v[42:43], v25 offset:17408
    s_waitcnt lgkmcnt(0)
    ds_read_b128 v[44:47], v21 offset:16384
    ds_read_b128 v[48:51], v21 offset:20480
    ds_read_b64_tr_b16 v[52:53], v24 offset:18432
    ds_read_b64_tr_b16 v[54:55], v24 offset:19456
    ds_read_b64_tr_b16 v[56:57], v25 offset:18432
    ds_read_b64_tr_b16 v[58:59], v25 offset:19456
    v_mfma_f32_32x32x16_bf16 v[60:75], v[36:39], v[28:31], v[60:75]
    v_mfma_f32_32x32x16_bf16 v[76:91], v[36:39], v[32:35], v[76:91]
    v_mfma_f32_32x32x16_bf16 v[92:107], v[40:43], v[28:31], v[92:107]
    v_mfma_f32_32x32x16_bf16 v[108:123], v[40:43], v[32:35], v[108:123]
    s_waitcnt lgkmcnt(0)
    ds_read_b128 v[28:31], v22 offset:16384
    ds_read_b128 v[32:35], v22 offset:20480
    ds_read_b64_tr_b16 v[36:37], v24 offset:20480
    ds_read_b64_tr_b16 v[38:39], v24 offset:21504
    ds_read_b64_tr_b16 v[40:41], v25 offset:20480
    ds_read_b64_tr_b16 v[42:43], v25 offset:21504
    v_mfma_f32_32x32x16_bf16 v[60:75], v[52:55], v[44:47], v[60:75]
    v_mfma_f32_32x32x16_bf16 v[76:91], v[52:55], v[48:51], v[76:91]
    v_mfma_f32_32x32x16_bf16 v[92:107], v[56:59], v[44:47], v[92:107]
    v_mfma_f32_32x32x16_bf16 v[108:123], v[56:59], v[48:51], v[108:123]
    s_waitcnt lgkmcnt(0)
    ds_read_b128 v[44:47], v23 offset:16384
    ds_read_b128 v[48:51], v23 offset:20480
    ds_read_b64_tr_b16 v[52:53], v24 offset:22528
    ds_read_b64_tr_b16 v[54:55], v24 offset:23552
    ds_read_b64_tr_b16 v[56:57], v25 offset:22528
    ds_read_b64_tr_b16 v[58:59], v25 offset:23552
    v_mfma_f32_32x32x16_bf16 v[60:75], v[36:39], v[28:31], v[60:75]
    v_mfma_f32_32x32x16_bf16 v[76:91], v[36:39], v[32:35], v[76:91]
    v_mfma_f32_32x32x16_bf16 v[92:107], v[40:43], v[28:31], v[92:107]
    v_mfma_f32_32x32x16_bf16 v[108:123], v[40:43], v[32:35], v[108:123]
    s_waitcnt lgkmcnt(0)
    v_mfma_f32_32x32x16_bf16 v[60:75], v[52:55], v[44:47], v[60:75]
    v_mfma_f32_32x32x16_bf16 v[76:91], v[52:55], v[48:51], v[76:91]
    v_mfma_f32_32x32x16_bf16 v[92:107], v[56:59], v[44:47], v[92:107]
    v_mfma_f32_32x32x16_bf16 v[108:123], v[56:59], v[48:51], v[108:123]
    s_waitcnt vmcnt(0)
    ds_read_b128 v[28:31], v20 offset:0
    ds_read_b128 v[32:35], v20 offset:4096
    ds_read_b64_tr_b16 v[36:37], v24 offset:0
    ds_read_b64_tr_b16 v[38:39], v24 offset:1024
    ds_read_b64_tr_b16 v[40:41], v25 offset:0
    ds_read_b64_tr_b16 v[42:43], v25 offset:1024
    s_waitcnt lgkmcnt(0)
    ds_read_b128 v[44:47], v21 offset:0
    ds_read_b128 v[48:51], v21 offset:4096
    ds_read_b64_tr_b16 v[52:53], v24 offset:2048
    ds_read_b64_tr_b16 v[54:55], v24 offset:3072
    ds_read_b64_tr_b16 v[56:57], v25 offset:2048
    ds_read_b64_tr_b16 v[58:59], v25 offset:3072
    v_mfma_f32_32x32x16_bf16 v[60:75], v[36:39], v[28:31], v[60:75]
    v_mfma_f32_32x32x16_bf16 v[76:91], v[36:39], v[32:35], v[76:91]
    v_mfma_f32_32x32x16_bf16 v[92:107], v[40:43], v[28:31], v[92:107]
    v_mfma_f32_32x32x16_bf16 v[108:123], v[40:43], v[32:35], v[108:123]
    s_waitcnt lgkmcnt(0)
    ds_read_b128 v[28:31], v22 offset:0
    ds_read_b128 v[32:35], v22 offset:4096
    ds_read_b64_tr_b16 v[36:37], v24 offset:4096
    ds_read_b64_tr_b16 v[38:39], v24 offset:5120
    ds_read_b64_tr_b16 v[40:41], v25 offset:4096
    ds_read_b64_tr_b16 v[42:43], v25 offset:5120
    v_mfma_f32_32x32x16_bf16 v[60:75], v[52:55], v[44:47], v[60:75]
    v_mfma_f32_32x32x16_bf16 v[76:91], v[52:55], v[48:51], v[76:91]
    v_mfma_f32_32x32x16_bf16 v[92:107], v[56:59], v[44:47], v[92:107]
    v_mfma_f32_32x32x16_bf16 v[108:123], v[56:59], v[48:51], v[108:123]
    s_waitcnt lgkmcnt(0)
    ds_read_b128 v[44:47], v23 offset:0
    ds_read_b128 v[48:51], v23 offset:4096
    ds_read_b64_tr_b16 v[52:53], v24 offset:6144
    ds_read_b64_tr_b16 v[54:55], v24 offset:7168
    ds_read_b64_tr_b16 v[56:57], v25 offset:6144
    ds_read_b64_tr_b16 v[58:59], v25 offset:7168
    v_mfma_f32_32x32x16_bf16 v[60:75], v[36:39], v[28:31], v[60:75]
    v_mfma_f32_32x32x16_bf16 v[76:91], v[36:39], v[32:35], v[76:91]
    v_mfma_f32_32x32x16_bf16 v[92:107], v[40:43], v[28:31], v[92:107]
    v_mfma_f32_32x32x16_bf16 v[108:123], v[40:43], v[32:35], v[108:123]
    s_waitcnt lgkmcnt(0)
    v_mfma_f32_32x32x16_bf16 v[60:75], v[52:55], v[44:47], v[60:75]
    v_mfma_f32_32x32x16_bf16 v[76:91], v[52:55], v[48:51], v[76:91]
    v_mfma_f32_32x32x16_bf16 v[92:107], v[56:59], v[44:47], v[92:107]
    v_mfma_f32_32x32x16_bf16 v[108:123], v[56:59], v[48:51], v[108:123]
    s_nop 15
    s_barrier
    v_lshlrev_b32 v26, 4, v1
    s_lshl_b32 s54, s28, 14
    v_add_u32 v27, s54, v26
    ds_write_b128 v27, v[60:63] offset:0
    ds_write_b128 v27, v[64:67] offset:1024
    ds_write_b128 v27, v[68:71] offset:2048
    ds_write_b128 v27, v[72:75] offset:3072
    ds_write_b128 v27, v[76:79] offset:4096
    ds_write_b128 v27, v[80:83] offset:5120
    ds_write_b128 v27, v[84:87] offset:6144
    ds_write_b128 v27, v[88:91] offset:7168
    ds_write_b128 v27, v[92:95] offset:8192
    ds_write_b128 v27, v[96:99] offset:9216
    ds_write_b128 v27, v[100:103] offset:10240
    ds_write_b128 v27, v[104:107] offset:11264
    ds_write_b128 v27, v[108:111] offset:12288
    ds_write_b128 v27, v[112:115] offset:13312
    ds_write_b128 v27, v[116:119] offset:14336
    ds_write_b128 v27, v[120:123] offset:15360
    s_waitcnt lgkmcnt(0)
    s_barrier
    s_lshl_b32 s54, s28, 12
    v_add_u32 v27, s54, v26
    s_lshr_b32 s29, s28, 1
    s_and_b32 s30, s28, 1
    s_lshl_b32 s54, s39, 6
    s_lshl_b32 s55, s30, 5
    s_add_u32 s54, s54, s55
    s_lshl_b32 s55, s38, 6
    s_lshl_b32 s56, s29, 5
    s_add_u32 s55, s55, s56
    s_lshl_b32 s56, s54, 11
    s_lshl_b32 s57, s55, 2
    s_add_u32 s56, s56, s57
    s_add_u32 s57, s57, 10240
    s_lshr_b32 s58, s56, 1
    v_lshlrev_b32 v10, 11, v4
    v_lshl_add_u32 v10, v5, 4, v10
    v_lshlrev_b32 v11, 4, v5
    v_lshrrev_b32 v12, 1, v10
    buffer_load_dwordx4 v[28:31], v10, s[12:15], s56 offen offset:0
    buffer_load_dwordx4 v[44:47], v11, s[20:23], s57 offen offset:0
    buffer_load_dwordx4 v[32:35], v10, s[12:15], s56 offen offset:32
    buffer_load_dwordx4 v[48:51], v11, s[20:23], s57 offen offset:32
    buffer_load_dwordx4 v[36:39], v10, s[12:15], s56 offen offset:64
    buffer_load_dwordx4 v[52:55], v11, s[20:23], s57 offen offset:64
    buffer_load_dwordx4 v[40:43], v10, s[12:15], s56 offen offset:96
    buffer_load_dwordx4 v[56:59], v11, s[20:23], s57 offen offset:96
    ds_read_b128 v[60:63], v27 offset:0
    ds_read_b128 v[64:67], v27 offset:1024
    ds_read_b128 v[68:71], v27 offset:2048
    ds_read_b128 v[72:75], v27 offset:3072
    ds_read_b128 v[76:79], v27 offset:16384
    ds_read_b128 v[80:83], v27 offset:17408
    ds_read_b128 v[84:87], v27 offset:18432
    ds_read_b128 v[88:91], v27 offset:19456
    ds_read_b128 v[92:95], v27 offset:32768
    ds_read_b128 v[96:99], v27 offset:33792
    ds_read_b128 v[100:103], v27 offset:34816
    ds_read_b128 v[104:107], v27 offset:35840
    s_waitcnt lgkmcnt(0)
    ds_read_b128 v[108:111], v27 offset:49152
    ds_read_b128 v[112:115], v27 offset:50176
    ds_read_b128 v[116:119], v27 offset:51200
    ds_read_b128 v[120:123], v27 offset:52224
    s_waitcnt lgkmcnt(0)
    v_add_f32 v60, v60, v76
    v_add_f32 v61, v61, v77
    v_add_f32 v62, v62, v78
    v_add_f32 v63, v63, v79
    v_add_f32 v64, v64, v80
    v_add_f32 v65, v65, v81
    v_add_f32 v66, v66, v82
    v_add_f32 v67, v67, v83
    v_add_f32 v68, v68, v84
    v_add_f32 v69, v69, v85
    v_add_f32 v70, v70, v86
    v_add_f32 v71, v71, v87
    v_add_f32 v72, v72, v88
    v_add_f32 v73, v73, v89
    v_add_f32 v74, v74, v90
    v_add_f32 v75, v75, v91
    v_add_f32 v60, v60, v92
    v_add_f32 v61, v61, v93
    v_add_f32 v62, v62, v94
    v_add_f32 v63, v63, v95
    v_add_f32 v64, v64, v96
    v_add_f32 v65, v65, v97
    v_add_f32 v66, v66, v98
    v_add_f32 v67, v67, v99
    v_add_f32 v68, v68, v100
    v_add_f32 v69, v69, v101
    v_add_f32 v70, v70, v102
    v_add_f32 v71, v71, v103
    v_add_f32 v72, v72, v104
    v_add_f32 v73, v73, v105
    v_add_f32 v74, v74, v106
    v_add_f32 v75, v75, v107
    v_add_f32 v60, v60, v108
    v_add_f32 v61, v61, v109
    v_add_f32 v62, v62, v110
    v_add_f32 v63, v63, v111
    v_add_f32 v64, v64, v112
    v_add_f32 v65, v65, v113
    v_add_f32 v66, v66, v114
    v_add_f32 v67, v67, v115
    v_add_f32 v68, v68, v116
    v_add_f32 v69, v69, v117
    v_add_f32 v70, v70, v118
    v_add_f32 v71, v71, v119
    v_add_f32 v72, v72, v120
    v_add_f32 v73, v73, v121
    v_add_f32 v74, v74, v122
    v_add_f32 v75, v75, v123
    s_waitcnt vmcnt(0)
    v_fmac_f32 v28, v60, v44
    v_fmac_f32 v29, v61, v45
    v_fmac_f32 v30, v62, v46
    v_fmac_f32 v31, v63, v47
    v_fmac_f32 v32, v64, v48
    v_fmac_f32 v33, v65, v49
    v_fmac_f32 v34, v66, v50
    v_fmac_f32 v35, v67, v51
    v_fmac_f32 v36, v68, v52
    v_fmac_f32 v37, v69, v53
    v_fmac_f32 v38, v70, v54
    v_fmac_f32 v39, v71, v55
    v_fmac_f32 v40, v72, v56
    v_fmac_f32 v41, v73, v57
    v_fmac_f32 v42, v74, v58
    v_fmac_f32 v43, v75, v59
    v_cvt_pk_bf16_f32 v76, v28, v29
    v_cvt_pk_bf16_f32 v77, v30, v31
    buffer_store_dwordx2 v[76:77], v12, s[16:19], s58 offen offset:0
    v_cvt_pk_bf16_f32 v78, v32, v33
    v_cvt_pk_bf16_f32 v79, v34, v35
    buffer_store_dwordx2 v[78:79], v12, s[16:19], s58 offen offset:16
    v_cvt_pk_bf16_f32 v80, v36, v37
    v_cvt_pk_bf16_f32 v81, v38, v39
    buffer_store_dwordx2 v[80:81], v12, s[16:19], s58 offen offset:32
    v_cvt_pk_bf16_f32 v82, v40, v41
    v_cvt_pk_bf16_f32 v83, v42, v43
    buffer_store_dwordx2 v[82:83], v12, s[16:19], s58 offen offset:48
.end_41:
    s_endpgm
.section .rodata,"a"
.p2align 6
.amdhsa_kernel k_kv_kernel
  .amdhsa_next_free_vgpr 256
  .amdhsa_next_free_sgpr 102
  .amdhsa_accum_offset 256
  .amdhsa_group_segment_fixed_size 0
  .amdhsa_kernarg_size 120
  .amdhsa_user_sgpr_count 2
  .amdhsa_user_sgpr_kernarg_segment_ptr 1
  .amdhsa_system_sgpr_workgroup_id_x 1
.end_amdhsa_kernel
.p2align 6
.amdhsa_kernel k_attn_kernel
  .amdhsa_next_free_vgpr 256
  .amdhsa_next_free_sgpr 102
  .amdhsa_accum_offset 256
  .amdhsa_group_segment_fixed_size 0
  .amdhsa_kernarg_size 120
  .amdhsa_user_sgpr_count 2
  .amdhsa_user_sgpr_kernarg_segment_ptr 1
  .amdhsa_system_sgpr_workgroup_id_x 1
.end_amdhsa_kernel
.p2align 6
.amdhsa_kernel k_oproj_kernel
  .amdhsa_next_free_vgpr 129
  .amdhsa_next_free_sgpr 102
  .amdhsa_accum_offset 132
  .amdhsa_group_segment_fixed_size 0
  .amdhsa_kernarg_size 120
  .amdhsa_user_sgpr_count 2
  .amdhsa_user_sgpr_kernarg_segment_ptr 1
  .amdhsa_system_sgpr_workgroup_id_x 1
.end_amdhsa_kernel
.p2align 6
.amdhsa_kernel k_ln2_kernel
  .amdhsa_next_free_vgpr 92
  .amdhsa_next_free_sgpr 102
  .amdhsa_accum_offset 92
  .amdhsa_group_segment_fixed_size 0
  .amdhsa_kernarg_size 120
  .amdhsa_user_sgpr_count 2
  .amdhsa_user_sgpr_kernarg_segment_ptr 1
  .amdhsa_system_sgpr_workgroup_id_x 1
.end_amdhsa_kernel
.p2align 6
.amdhsa_kernel k_gu_kernel
  .amdhsa_next_free_vgpr 135
  .amdhsa_next_free_sgpr 102
  .amdhsa_accum_offset 136
  .amdhsa_group_segment_fixed_size 0
  .amdhsa_kernarg_size 120
  .amdhsa_user_sgpr_count 2
  .amdhsa_user_sgpr_kernarg_segment_ptr 1
  .amdhsa_system_sgpr_workgroup_id_x 1
.end_amdhsa_kernel
.p2align 6
.amdhsa_kernel k_down_kernel
  .amdhsa_next_free_vgpr 124
  .amdhsa_next_free_sgpr 102
  .amdhsa_accum_offset 124
  .amdhsa_group_segment_fixed_size 0
  .amdhsa_kernarg_size 120
  .amdhsa_user_sgpr_count 2
  .amdhsa_user_sgpr_kernarg_segment_ptr 1
  .amdhsa_system_sgpr_workgroup_id_x 1
.end_amdhsa_kernel
```
